```python
import torch

def _softmax(x, axis=-1):
    return torch.softmax(x, dim=axis)

def _gelu(x):
    return torch.nn.functional.gelu(x, approximate='tanh')

def _silu(x):
    return torch.nn.functional.silu(x)

def _sigmoid(x):
    return torch.sigmoid(x)

def _layernorm(x, axis=-1, eps=1e-05):
    m = x.mean(dim=axis, keepdim=True)
    v = x.var(dim=axis, keepdim=True, unbiased=False)
    return (x - m) / torch.sqrt(v + eps)

def _scatter_add(tgt, idx, src, axis=0):
    return tgt.clone().index_add_(axis, idx, src)

def _segment_sum(src, seg, n):
    out = torch.zeros((n,) + src.shape[1:], dtype=src.dtype)
    return out.index_add_(0, seg, src)

def _pad(x, pw):
    flat = tuple((v for pair in reversed(pw) for v in pair))
    return torch.nn.functional.pad(x, flat)
kernel_name = 'standalone__conformer_family_branchformer__speech'

def setup_inputs():

    _w = lambda a: (lambda t: t.to(torch.bfloat16) if t.is_floating_point() else t)(torch.as_tensor(a))
    B, T, D, K = (2, 4000, 144, 3)
    s = float(D) ** (-0.5)
    return {'x': _w((lambda *s: torch.randn(*s, dtype=torch.bfloat16) * 0.05)(B, T, D)), 'w_q': _w((lambda *s: torch.randn(*s, dtype=torch.bfloat16) * 1.6)(D, D) * s), 'w_k': _w((lambda *s: torch.randn(*s, dtype=torch.bfloat16) * 1.6)(D, D) * s), 'w_v': _w((lambda *s: torch.randn(*s, dtype=torch.bfloat16) * 0.4)(D, D) * s), 'w_ao': _w((lambda *s: torch.randn(*s, dtype=torch.bfloat16) * 0.4)(D, D) * s), 'w_up': _w((lambda *s: torch.randn(*s, dtype=torch.bfloat16) * 0.8)(D, 2 * D) * s), 'dw': _w((lambda *s: torch.randn(*s, dtype=torch.bfloat16) * 0.8)(K, D) * (1.0 / K)), 'w_dn': _w((lambda *s: torch.randn(*s, dtype=torch.bfloat16) * 0.4)(D, D) * s), 'w_merge': _w((lambda *s: torch.randn(*s, dtype=torch.bfloat16) * 0.4)(2 * D, D) * s)}

def reference(x, w_q, w_k, w_v, w_ao, w_up, dw, w_dn, w_merge):
    B, T, D = x.shape
    K = dw.shape[0]
    xa = _layernorm(x, axis=-1)
    q = torch.einsum('btd,de->bte', xa, w_q)
    k = torch.einsum('btd,de->bte', xa, w_k)
    v = torch.einsum('btd,de->bte', xa, w_v)
    logits = torch.einsum('btd,bsd->bts', q, k) * float(D) ** (-0.5)
    attn = _softmax(logits, axis=-1)
    ya = torch.einsum('bts,bsd->btd', attn, v)
    ya = torch.einsum('btd,de->bte', ya, w_ao)
    xc = _layernorm(x, axis=-1)
    h = _gelu(torch.einsum('btd,de->bte', xc, w_up))
    u = h[..., :D].clone()
    g = _layernorm(h[..., D:], axis=-1)
    pad = K // 2
    gp = _pad(g, ((0, 0), (pad, pad), (0, 0)))
    conv = torch.zeros_like(g)
    for i in range(K):
        conv = conv + gp[:, i:i + T, :] * dw[i][None, None, :]
    yc = torch.einsum('btd,de->bte', u * conv, w_dn)
    merged = torch.concatenate([ya, yc], axis=-1)
    out = torch.einsum('btf,fd->btd', merged, w_merge)
    return x + out
```

```asm
; @launch grid=(256,1,1) block=(256,1,1) lds=163840
.amdgcn_target "amdgcn-amd-amdhsa--gfx950"
.text
.p2align 12
.globl standalone__conformer_family_branchformer__speech_kernel
.p2align 8
.type standalone__conformer_family_branchformer__speech_kernel,@function
standalone__conformer_family_branchformer__speech_kernel:
    s_cmp_ge_u32 s2, 256
    s_cbranch_scc1 L_end
    s_load_dwordx16 s[16:31], s[0:1], 0
    s_load_dwordx8 s[32:39], s[0:1], 64
    s_memrealtime s[100:101]
    v_lshrrev_b32 v8, 6, v0
    v_and_b32 v3, 63, v0
    v_readfirstlane_b32 s3, v8
    s_lshr_b32 s60, s2, 3
    s_sub_u32 s61, s60, 23
    s_lshl_b32 s61, s61, 13
    s_or_b32 s62, s61, s3
    s_cmp_ge_u32 s62, 49952
    s_cbranch_scc1 L_nocp
    s_bitcmp1_b32 s62, 0
    s_cbranch_scc1 L_nocp
    s_bitcmp1_b32 s62, 1
    s_cbranch_scc1 L_nocp
    s_getpc_b64 s[12:13]
L_pc:
    v_lshl_add_u32 v12, v3, 7, s61
    v_min_u32 v12, 49952, v12
    global_load_dword v19, v12, s[12:13]
L_nocp:
    v_lshrrev_b32 v2, 4, v3
    v_and_b32 v1, 15, v3
    v_mul_u32_u24 v9, 288, v1
    v_lshl_add_u32 v10, v2, 4, v9
    v_lshl_add_u32 v11, v2, 3, v9
    s_bfe_u32 s93, s2, 0x10002
    s_xor_b32 s5, s93, s2
    s_and_b32 s5, s5, 1
    s_lshl1_add_u32 s4, s60, s5
    s_and_b32 s5, s2, 1
    s_bfe_u32 s6, s2, 0x10001
    s_mov_b32 s42, 1152000
    s_mul_i32 s65, s6, s42
    s_lshl1_add_u32 s67, s4, s5
    s_xor_b32 s66, s67, 1
    s_cmp_ge_u32 s3, 2
    s_cselect_b32 s72, s67, s66
    s_and_b32 s73, s3, 1
    s_lshl1_add_u32 s74, s72, s73
    s_mul_i32 s62, s74, 4608
    s_mov_b32 s43, 0x20000
    s_cmp_ge_u32 s60, 23
    s_cselect_b32 s14, 1, s3
    s_cmp_lg_u32 s14, 0
    s_cbranch_scc1 L_nopa
    s_mov_b32 s50, 41468
    s_cmp_ge_u32 s60, 6
    s_cselect_b32 s15, 6, 0
    s_cmp_ge_u32 s60, 12
    s_cselect_b32 s15, 12, s15
    s_cselect_b32 s50, 82940, s50
    s_sub_u32 s15, s60, s15
    s_lshl_b32 s15, s15, 13
    v_lshl_add_u32 v12, v3, 7, s15
    v_min_u32 v12, s50, v12
    s_cmp_ge_u32 s60, 6
    s_waitcnt lgkmcnt(0)
    s_cselect_b32 s48, s20, s18
    s_cselect_b32 s49, s21, s19
    s_cmp_ge_u32 s60, 12
    s_cselect_b32 s48, s26, s48
    s_cselect_b32 s49, s27, s49
    global_load_dword v19, v12, s[48:49]
L_nopa:
    s_cmp_ge_u32 s4, 63
    s_waitcnt lgkmcnt(0)
    s_cbranch_scc1 L_roleW
    s_add_u32 s40, s16, s65
    s_addc_u32 s41, s17, 0
    buffer_load_dwordx4 v[20:23], v10, s[40:43], s62 offen offset:0
    buffer_load_dwordx4 v[24:27], v10, s[40:43], s62 offen offset:64
    buffer_load_dwordx4 v[28:31], v10, s[40:43], s62 offen offset:128
    buffer_load_dwordx4 v[32:35], v10, s[40:43], s62 offen offset:192
    buffer_load_dwordx2 v[36:37], v11, s[40:43], s62 offen offset:256
    v_lshlrev_b32 v239, 4, v3
    v_and_b32 v243, 3, v3
    s_mov_b32 s51, 0x20000
    v_bfe_u32 v240, v3, 2, 2
    v_and_b32 v241, 1, v2
    v_lshrrev_b32 v242, 1, v2
    v_lshl_add_u32 v244, v241, 3, v240
    v_lshl_add_u32 v244, v242, 2, v244
    v_lshlrev_b32 v17, 1, v241
    v_xor_b32 v17, v17, v243
    v_mul_u32_u24 v228, 288, v244
    v_lshl_add_u32 v18, v17, 4, v228
    v_lshl_add_u32 v18, v8, 6, v18
    s_mul_i32 s64, s3, 9216
    s_mov_b32 s40, s18
    s_mov_b32 s41, s19
    s_mov_b32 s42, 41472
    s_mov_b32 s50, s42
    s_mov_b32 s48, s20
    s_mov_b32 s49, s21
    v_lshrrev_b32 v9, 1, v3
    v_and_b32 v10, 0x13, v9
    v_and_b32 v11, 4, v9
    v_lshl_add_u32 v10, v11, 1, v10
    v_bfe_u32 v11, v9, 3, 1
    v_lshl_add_u32 v10, v11, 2, v10
    v_mul_u32_u24 v10, 288, v10
    v_and_b32 v11, 1, v3
    v_lshl_add_u32 v245, v11, 4, v10
    v_add_u32 v229, v245, v10
    v_add_u32 v228, v18, v228
    s_lshl_b32 s14, s3, 10
    s_lshl_b32 s15, s3, 11
    s_add_u32 s60, s65, 4096
    s_add_u32 s56, s38, s60
    s_addc_u32 s57, s39, 0
    s_mov_b32 s58, 1152000
    s_mov_b32 s59, 0x20000
    s_mov_b32 s75, 0xffff0000
    s_mul_i32 s68, s67, 9216
    s_add_u32 s69, s68, 4096
    s_add_u32 s70, s68, 8192
    s_mul_i32 s60, s73, 28
    v_xor_b32 v9, s60, v1
    v_lshlrev_b32 v10, 3, v241
    v_xor_b32 v10, v9, v10
    v_lshl_add_u32 v10, v2, 5, v10
    v_lshlrev_b32 v4, 4, v10
    v_mul_u32_u24 v10, 40, v242
    v_xor_b32 v10, v9, v10
    v_lshlrev_b32 v5, 4, v10
    v_sub_u32 v9, 0, v2
    v_xor_b32 v9, v9, v243
    v_and_b32 v9, 3, v9
    v_mul_u32_u24 v10, 288, v244
    v_lshl_add_u32 v218, v9, 4, v10
    v_add_u32 v219, 3584, v218
    v_lshrrev_b32 v10, 2, v3
    v_mul_u32_u24 v10, 288, v10
    v_lshl_add_u32 v220, v9, 4, v10
    v_bfe_u32 v9, v3, 1, 4
    v_xor_b32 v10, v3, v2
    v_and_b32 v10, 1, v10
    v_lshlrev_b32 v10, 4, v10
    v_mul_u32_u24 v11, 288, v9
    v_add_u32 v10, 256, v10
    v_add_u32 v222, v10, v11
    v_lshlrev_b32 v9, 4, v242
    v_xor_b32 v9, v9, v245
    v_add_u32 v221, 256, v9
    v_xor_b32 v10, v241, v242
    v_lshl_add_u32 v10, v240, 1, v10
    v_lshl_add_u32 v10, v242, 3, v10
    v_lshl_add_u32 v10, v10, 5, s64
    v_lshlrev_b32 v9, 3, v243
    v_add_u32 v6, v9, v10
    v_bfrev_b32 v11, v243
    v_lshrrev_b32 v11, 27, v11
    v_add_u32 v212, v11, v10
    v_lshl_add_u32 v10, v244, 5, v9
    v_add_u32 v217, 119808, v10
    v_lshl_add_u32 v10, v241, 2, v240
    v_lshl_add_u32 v10, v242, 4, v10
    v_lshl_add_u32 v11, v10, 5, v9
    v_add_u32 v216, 115712, v11
    v_lshl_add_u32 v9, v242, 4, v1
    v_lshlrev_b32 v9, 4, v9
    s_add_u32 s61, s64, 36864
    v_add_u32 v204, s61, v239
    v_lshl_add_u32 v10, v241, 3, v9
    v_add_u32 v207, s61, v10
    v_mul_u32_u24 v10, 9216, v241
    v_add_u32 v10, 36864, v10
    v_add_u32 v205, v9, v10
    v_add_u32 v206, s14, v205
    s_mov_b32 s60, 0x3f803f80
    v_mov_b32 v40, s60
    v_mov_b32 v41, s60
    v_mov_b32 v42, s60
    v_mov_b32 v43, s60
    s_mov_b32 s44, s26
    s_mov_b32 s45, s27
    s_mov_b32 s46, 82944
    s_mov_b32 s47, 0x20000
    s_mul_i32 s71, s3, 18432
    s_mul_i32 s72, s5, 288
    s_sub_u32 s72, 288, s72
    s_add_u32 s71, s71, s72
    s_lshl2_add_u32 s7, s5, s3
    s_sub_u32 s0, s100, 1000
    s_subb_u32 s1, s101, 0
    s_mul_i32 s60, s7, 9216
    s_sub_u32 s96, 1155072, s60
    s_sub_u32 s60, s60, 3072
    s_ashr_i32 s61, s60, 31
    s_add_u32 s8, s56, s60
    s_addc_u32 s9, s57, s61
    s_mov_b32 s90, s8
    s_mov_b32 s91, s9
    s_mov_b32 s11, 0x20000
    s_lshl_b32 s63, s3, 1
    s_xor_b32 s63, s63, s73
    s_lshl_b32 s63, s63, 10
    v_add_u32 v6, 120832, v6
    v_add_u32 v251, 41984, v217
    v_add_u32 v250, 41984, v216
    s_xor_b32 s18, s63, 0
    s_add_u32 s18, s18, 3072
    s_xor_b32 s19, s63, 1024
    s_add_u32 s19, s19, 2048
    s_xor_b32 s20, s63, 2048
    s_add_u32 s20, s20, 1024
    s_xor_b32 s21, s63, 3072
    s_xor_b32 s22, s63, 4096
    s_add_u32 s22, s22, 3072
    s_xor_b32 s23, s63, 5120
    s_add_u32 s23, s23, 2048
    s_xor_b32 s24, s63, 6144
    s_add_u32 s24, s24, 1024
    s_xor_b32 s25, s63, 7168
    s_movk_i32 s26, 11264
    s_mov_b32 s52, s38
    s_mov_b32 s53, s39
    s_mov_b32 s54, 10027008
    s_mov_b32 s55, 0x20000
    s_lshl_b32 s77, s6, 15
    s_add_u32 s77, s77, 7471104
    s_lshl_b32 s79, s74, 7
    s_add_u32 s79, s79, s77
    s_lshl_b32 s78, s6, 7
    s_add_u32 s78, s78, s67
    s_lshl2_add_u32 s78, s78, s3
    s_lshl_b32 s78, s78, 7
    s_add_u32 s78, s78, 7536640
    s_cmp_ge_u32 s3, 2
    s_cselect_b32 s79, s79, 0x7fff0000
    v_mov_b32 v38, s100
    v_mov_b32 v39, s101
    v_lshlrev_b32 v231, 3, v3
    v_cmp_gt_u32 vcc, 16, v3
    v_mov_b32 v9, 0x7fff0000
    v_lshrrev_b32 v10, 2, v1
    v_cndmask_b32 v238, v9, v231, vcc
    v_sub_u32 v9, 0, v10
    v_xor_b32 v9, v9, v2
    v_and_b32 v9, 3, v9
    v_lshlrev_b32 v9, 4, v9
    v_lshl_add_u32 v9, v1, 6, v9
    v_add_u32 v192, 81920, v9
    v_sub_u32 v9, 0, v10
    v_xor_b32 v9, v9, v242
    v_and_b32 v9, 3, v9
    v_lshl_add_u32 v9, v1, 2, v9
    v_lshl_add_u32 v9, v241, 6, v9
    s_add_u32 s60, s15, 73728
    v_lshl_add_u32 v223, v9, 4, s60
    v_xor_b32 v213, 32, v223
    v_lshrrev_b32 v9, 3, v1
    v_xor_b32 v9, v9, v242
    v_lshlrev_b32 v9, 1, v9
    v_add_u32 v9, v9, v241
    v_lshl_add_u32 v9, v1, 2, v9
    v_lshlrev_b32 v9, 3, v9
    v_add_u32 v193, 114688, v9
    v_xor_b32 v9, v241, v242
    v_and_b32 v10, 31, v3
    v_lshl_add_u32 v9, v10, 1, v9
    s_add_u32 s60, s14, 110592
    v_lshl_add_u32 v224, v9, 4, s60
    v_and_b32 v9, 30, v3
    v_and_b32 v10, 1, v3
    v_lshlrev_b32 v9, 3, v9
    v_lshl_add_u32 v9, s7, 1, v9
    v_min_u32 v9, 248, v9
    v_add_u32 v9, v9, v10
    v_lshl_add_u32 v255, v9, 7, s77
    s_lshr_b32 s60, s3, 1
    s_lshl_b32 s60, s60, 10
    s_lshl_b32 s61, s73, 8
    s_add_u32 s60, s60, s61
    s_add_u32 s60, s60, 98304
    v_lshl_add_u32 v9, v242, 5, v1
    v_lshl_add_u32 v9, v9, 1, v241
    v_lshl_add_u32 v226, v9, 3, s60
    s_add_u32 s60, s15, 81920
    v_add_u32 v225, s60, v239
    s_lshl2_add_u32 s60, s3, 100352
    v_add_u32 v194, s60, v239
    v_mul_u32_u24 v9, 12, v241
    v_and_b32 v10, 31, v3
    v_xor_b32 v10, v10, v9
    v_mul_u32_u24 v11, 40, v242
    v_xor_b32 v10, v10, v11
    v_lshl_add_u32 v232, v10, 4, s64
    v_lshl_add_u32 v10, v242, 2, v240
    v_lshl_add_u32 v10, v241, 4, v10
    v_xor_b32 v10, v10, v9
    v_bfe_u32 v11, v3, 1, 1
    v_mul_u32_u24 v11, 40, v11
    v_xor_b32 v10, v10, v11
    v_lshlrev_b32 v10, 1, v10
    v_and_or_b32 v10, v3, 1, v10
    v_lshl_add_u32 v234, v10, 3, s64
    s_add_u32 m0, s64, 0
    s_movk_i32 s61, 0
    buffer_load_dwordx4 v18, s[40:43], s61 offen offset:0 lds
    s_movk_i32 s61, 3584
    buffer_load_dwordx4 v18, s[40:43], s61 offen offset:1024 lds
    s_movk_i32 s61, 7168
    buffer_load_dwordx4 v18, s[40:43], s61 offen offset:2048 lds
    s_movk_i32 s61, 10752
    buffer_load_dwordx4 v18, s[40:43], s61 offen offset:3072 lds
    s_add_u32 m0, s64, 4096
    s_movk_i32 s61, 18432
    buffer_load_dwordx4 v18, s[40:43], s61 offen offset:0 lds
    s_movk_i32 s61, 22016
    buffer_load_dwordx4 v18, s[40:43], s61 offen offset:1024 lds
    v_mov_b32 v8, 0
    v_mov_b32 v9, 0
    s_mov_b64 exec, 0
    s_cmp_eq_u32 s5, 0
    s_cbranch_scc1 L_wk0
    s_cmp_eq_u32 s3, 0
    s_cbranch_scc1 L_padm0
    s_cmp_eq_u32 s3, 1
    s_cbranch_scc1 L_padm1
    s_cmp_eq_u32 s3, 2
    s_cbranch_scc1 L_padm6
    s_branch L_padm2
L_wk0:
    s_cmp_eq_u32 s3, 0
    s_cbranch_scc1 L_padm0
    s_cmp_eq_u32 s3, 1
    s_cbranch_scc1 L_padm1
    s_cmp_eq_u32 s3, 2
    s_cbranch_scc1 L_padm6
    s_branch L_padx
L_walked0:
    s_mov_b64 exec, -1
    s_mov_b64 exec, 0
    s_cmp_eq_u32 s5, 0
    s_cbranch_scc1 L_wk1
    s_cmp_eq_u32 s3, 0
    s_cbranch_scc1 L_padm3
    s_cmp_eq_u32 s3, 1
    s_cbranch_scc1 L_padm4
    s_cmp_eq_u32 s3, 2
    s_cbranch_scc1 L_padm5
    s_branch L_walked1
L_wk1:
    s_cmp_eq_u32 s3, 0
    s_cbranch_scc1 L_padg0
    s_cmp_eq_u32 s3, 1
    s_cbranch_scc1 L_padg1
    s_cmp_eq_u32 s3, 2
    s_cbranch_scc1 L_padg2
    s_branch L_padg3
L_walked1:
    s_mov_b64 exec, -1
    s_mov_b64 exec, 0
    s_cmp_eq_u32 s5, 0
    s_cbranch_scc0 L_walked2
    s_cmp_eq_u32 s3, 0
    s_cbranch_scc1 L_pady
    s_cmp_eq_u32 s3, 1
    s_cbranch_scc1 L_walked2
    s_cmp_eq_u32 s3, 2
    s_cbranch_scc1 L_walked2
    s_branch L_walked2
L_walked2:
    s_mov_b64 exec, -1
    s_waitcnt vmcnt(6)
    v_mfma_f32_16x16x16_bf16 v[152:155], v[40:41], v[36:37], 0
    v_dot2c_f32_bf16 v8, v20, v20
    v_dot2c_f32_bf16 v9, v21, v21
    v_dot2c_f32_bf16 v8, v22, v22
    s_add_u32 m0, s64, 4096
    s_movk_i32 s61, 25600
    buffer_load_dwordx4 v18, s[40:43], s61 offen offset:2048 lds
    v_dot2c_f32_bf16 v9, v23, v23
    v_dot2c_f32_bf16 v8, v24, v24
    v_dot2c_f32_bf16 v9, v25, v25
    v_dot2c_f32_bf16 v8, v26, v26
    v_mfma_f32_16x16x32_bf16 v[152:155], v[40:43], v[20:23], v[152:155]
    v_dot2c_f32_bf16 v9, v27, v27
    v_dot2c_f32_bf16 v8, v28, v28
    v_mfma_f32_16x16x32_bf16 v[152:155], v[40:43], v[24:27], v[152:155]
    v_dot2c_f32_bf16 v9, v29, v29
    v_dot2c_f32_bf16 v8, v30, v30
    v_mfma_f32_16x16x32_bf16 v[152:155], v[40:43], v[28:31], v[152:155]
    v_dot2c_f32_bf16 v9, v31, v31
    s_movk_i32 s61, 29184
    buffer_load_dwordx4 v18, s[40:43], s61 offen offset:3072 lds
    v_dot2c_f32_bf16 v8, v32, v32
    v_mfma_f32_16x16x32_bf16 v[152:155], v[40:43], v[32:35], v[152:155]
    v_dot2c_f32_bf16 v9, v33, v33
    v_dot2c_f32_bf16 v8, v34, v34
    v_dot2c_f32_bf16 v9, v35, v35
    v_dot2c_f32_bf16 v8, v36, v36
    v_dot2c_f32_bf16 v9, v37, v37
    v_cmp_eq_u32 vcc, 3, v2
    s_nop 1
    v_add_f32 v8, v8, v9
    v_mov_b32 v14, v8
    s_nop 1
    v_permlane16_swap_b32 v14, v8
    s_add_u32 m0, s64, 8192
    s_mov_b32 s61, 36864
    buffer_load_dwordx4 v18, s[40:43], s61 offen offset:0 lds
    v_add_f32 v8, v8, v14
    v_mov_b32 v14, v8
    s_nop 1
    v_permlane32_swap_b32 v14, v8
    v_add_f32 v8, v8, v14
    v_mul_f32 v152, 0x3be38e39, v152
    v_mul_f32 v8, 0x3be38e39, v8
    v_fma_f32 v8, -v152, v152, v8
    v_max_f32 v8, 0, v8
    v_add_f32 v8, 0x3727c5ac, v8
    v_rsq_f32 v12, v8
    s_nop 0
    v_mul_f32 v10, -v152, v12
    v_lshlrev_b32 v14, 16, v36
    s_cmp_lg_u32 s3, 1
    s_cbranch_scc1 L_k1
    s_mov_b32 m0, 119552
    s_mov_b32 s61, 36864
    buffer_load_dwordx4 v245, s[40:43], s61 offen offset:256 lds
L_k1:
    s_add_u32 m0, s14, 115456
    s_nop 0
    buffer_load_dwordx4 v245, s[40:43], s64 offen offset:256 lds
    v_and_b32 v15, s75, v36
    v_pk_fma_f32 v[14:15], v[14:15], v[12:13], v[10:11] op_sel_hi:[1,0,0]
    v_cvt_pk_bf16_f32 v36, v14, v15
    v_lshlrev_b32 v16, 16, v37
    v_and_b32 v17, s75, v37
    v_pk_fma_f32 v[16:17], v[16:17], v[12:13], v[10:11] op_sel_hi:[1,0,0]
    v_cvt_pk_bf16_f32 v37, v16, v17
    v_and_b32 v157, 0xffff, v37
    v_or_b32 v157, 0x3f800000, v157
    v_mov_b32 v156, v36
    v_cndmask_b32 v157, v37, v157, vcc
    v_mov_b32 v158, v36
    s_cmp_lg_u32 s3, 1
    s_cbranch_scc1 L_k2
    s_mov_b32 m0, 114688
    s_mov_b32 s62, 36864
    buffer_load_dwordx4 v222, s[48:51], s62 offen lds
L_k2:
    s_add_u32 m0, s14, 110592
    s_nop 0
    buffer_load_dwordx4 v221, s[48:51], s64 offen lds
    v_mov_b32 v159, v157
    v_lshlrev_b32 v14, 16, v20
    v_and_b32 v15, s75, v20
    v_pk_fma_f32 v[14:15], v[14:15], v[12:13], v[10:11] op_sel_hi:[1,0,0]
    v_cvt_pk_bf16_f32 v20, v14, v15
    v_permlane16_swap_b32 v156, v158
    v_permlane16_swap_b32 v157, v159
    ds_write_b64 v207, v[36:37] offset:4096
    v_lshlrev_b32 v16, 16, v21
    v_and_b32 v17, s75, v21
    v_pk_fma_f32 v[16:17], v[16:17], v[12:13], v[10:11] op_sel_hi:[1,0,0]
    v_cvt_pk_bf16_f32 v21, v16, v17
    s_add_u32 m0, s64, 81920
    s_lshl_b32 s62, s3, 6
    s_add_u32 s62, s62, 36864
    buffer_load_dwordx4 v220, s[48:51], s62 offen lds
    v_lshlrev_b32 v14, 16, v22
    v_and_b32 v15, s75, v22
    v_pk_fma_f32 v[14:15], v[14:15], v[12:13], v[10:11] op_sel_hi:[1,0,0]
    v_cvt_pk_bf16_f32 v22, v14, v15
    v_lshlrev_b32 v16, 16, v23
    v_and_b32 v17, s75, v23
    v_pk_fma_f32 v[16:17], v[16:17], v[12:13], v[10:11] op_sel_hi:[1,0,0]
    v_cvt_pk_bf16_f32 v23, v16, v17
    ds_write_b128 v204, v[20:23] offset:0
    v_lshlrev_b32 v14, 16, v24
    v_and_b32 v15, s75, v24
    v_pk_fma_f32 v[14:15], v[14:15], v[12:13], v[10:11] op_sel_hi:[1,0,0]
    s_add_u32 m0, s15, 73728
    s_add_u32 s62, s64, 0
    buffer_load_dwordx4 v218, s[48:51], s62 offen lds
    v_cvt_pk_bf16_f32 v24, v14, v15
    v_lshlrev_b32 v16, 16, v25
    v_and_b32 v17, s75, v25
    v_pk_fma_f32 v[16:17], v[16:17], v[12:13], v[10:11] op_sel_hi:[1,0,0]
    v_cvt_pk_bf16_f32 v25, v16, v17
    v_lshlrev_b32 v14, 16, v26
    v_and_b32 v15, s75, v26
    v_pk_fma_f32 v[14:15], v[14:15], v[12:13], v[10:11] op_sel_hi:[1,0,0]
    v_cvt_pk_bf16_f32 v26, v14, v15
    v_lshlrev_b32 v16, 16, v27
    v_and_b32 v17, s75, v27
    v_pk_fma_f32 v[16:17], v[16:17], v[12:13], v[10:11] op_sel_hi:[1,0,0]
    v_cvt_pk_bf16_f32 v27, v16, v17
    s_cmp_lt_u32 s3, 2
    s_cbranch_scc1 L_k4
    buffer_store_dwordx4 v[156:159], v5, s[56:59], s70 offen sc1
    buffer_store_dwordx4 v[20:23], v4, s[56:59], s68 offen offset:0 sc1
    buffer_store_dwordx4 v[24:27], v4, s[56:59], s68 offen offset:2048 sc1
L_k4:
    ds_write_b128 v204, v[24:27] offset:1024
    v_lshlrev_b32 v14, 16, v28
    v_and_b32 v15, s75, v28
    v_pk_fma_f32 v[14:15], v[14:15], v[12:13], v[10:11] op_sel_hi:[1,0,0]
    v_cvt_pk_bf16_f32 v28, v14, v15
    v_lshlrev_b32 v16, 16, v29
    v_and_b32 v17, s75, v29
    v_pk_fma_f32 v[16:17], v[16:17], v[12:13], v[10:11] op_sel_hi:[1,0,0]
    v_cvt_pk_bf16_f32 v29, v16, v17
    v_lshlrev_b32 v14, 16, v30
    v_and_b32 v15, s75, v30
    v_pk_fma_f32 v[14:15], v[14:15], v[12:13], v[10:11] op_sel_hi:[1,0,0]
    v_cvt_pk_bf16_f32 v30, v14, v15
    v_lshlrev_b32 v16, 16, v31
    v_and_b32 v17, s75, v31
    v_pk_fma_f32 v[16:17], v[16:17], v[12:13], v[10:11] op_sel_hi:[1,0,0]
    v_cvt_pk_bf16_f32 v31, v16, v17
    ds_write_b128 v204, v[28:31] offset:2048
    v_lshlrev_b32 v14, 16, v32
    v_and_b32 v15, s75, v32
    v_pk_fma_f32 v[14:15], v[14:15], v[12:13], v[10:11] op_sel_hi:[1,0,0]
    v_cvt_pk_bf16_f32 v32, v14, v15
    v_lshlrev_b32 v16, 16, v33
    v_and_b32 v17, s75, v33
    v_pk_fma_f32 v[16:17], v[16:17], v[12:13], v[10:11] op_sel_hi:[1,0,0]
    v_cvt_pk_bf16_f32 v33, v16, v17
    v_lshlrev_b32 v14, 16, v34
    v_and_b32 v15, s75, v34
    v_pk_fma_f32 v[14:15], v[14:15], v[12:13], v[10:11] op_sel_hi:[1,0,0]
    v_cvt_pk_bf16_f32 v34, v14, v15
    v_lshlrev_b32 v16, 16, v35
    v_and_b32 v17, s75, v35
    v_pk_fma_f32 v[16:17], v[16:17], v[12:13], v[10:11] op_sel_hi:[1,0,0]
    v_cvt_pk_bf16_f32 v35, v16, v17
    s_cmp_lt_u32 s3, 2
    s_cbranch_scc1 L_k5
    buffer_store_dwordx4 v[28:31], v4, s[56:59], s69 offen offset:0 sc1
    buffer_store_dwordx4 v[32:35], v4, s[56:59], s69 offen offset:2048 sc1
L_k5:
    s_cmp_ge_u32 s3, 2
    s_cbranch_scc1 L_xs
    s_waitcnt vmcnt(3)
L_xs:
    s_waitcnt vmcnt(8)
    ds_write_b128 v204, v[32:35] offset:3072
    ds_read_b64_tr_b16 v[44:45], v212 offset:0
    ds_read_b64_tr_b16 v[46:47], v212 offset:512
    ds_read_b64_tr_b16 v[48:49], v212 offset:1024
    ds_read_b64_tr_b16 v[50:51], v212 offset:1536
    ds_read_b64_tr_b16 v[52:53], v212 offset:2048
    ds_read_b64_tr_b16 v[54:55], v212 offset:2560
    ds_read_b64_tr_b16 v[56:57], v212 offset:3072
    ds_read_b64_tr_b16 v[58:59], v212 offset:3584
    ds_read_b64_tr_b16 v[60:61], v212 offset:4096
    ds_read_b64_tr_b16 v[62:63], v212 offset:4608
    ds_read_b64_tr_b16 v[64:65], v212 offset:5120
    ds_read_b64_tr_b16 v[66:67], v212 offset:5632
    ds_read_b64_tr_b16 v[68:69], v212 offset:6144
    ds_read_b64_tr_b16 v[70:71], v212 offset:6656
    ds_read_b64_tr_b16 v[72:73], v212 offset:7168
    ds_read_b64_tr_b16 v[74:75], v212 offset:7680
    ds_read_b64_tr_b16 v[76:77], v212 offset:8192
    ds_read_b64_tr_b16 v[78:79], v212 offset:8704
    buffer_load_dwordx4 v219, s[48:51], s62 offen offset:1024 lds
    s_waitcnt lgkmcnt(14)
    s_barrier
    ds_read_b128 a[180:183], v205 offset:0
    ds_read_b128 a[184:187], v205 offset:512
    ds_read_b128 a[188:191], v205 offset:1024
    ds_read_b128 a[192:195], v205 offset:1536
    ds_read_b128 a[196:199], v205 offset:2048
    ds_read_b64_tr_b16 v[96:97], v217
    ds_read_b128 a[200:203], v205 offset:2560
    ds_read_b128 a[204:207], v205 offset:3072
    ds_read_b128 a[208:211], v205 offset:3584
    ds_read_b128 a[212:215], v205 offset:4096
    s_add_u32 m0, s15, 82944
    s_add_u32 s62, s64, 64
    buffer_load_dwordx4 v218, s[48:51], s62 offen lds
    s_waitcnt lgkmcnt(9)
    v_mfma_f32_32x32x16_bf16 v[152:167], v[44:47], a[180:183], 0
    ds_read_b64_tr_b16 v[80:81], v216 offset:0
    ds_read_b64_tr_b16 v[82:83], v216 offset:256
    ds_read_b64_tr_b16 v[84:85], v216 offset:1024
    s_waitcnt lgkmcnt(11)
    v_mfma_f32_32x32x16_bf16 v[152:167], v[48:51], a[184:187], v[152:167]
    buffer_load_dwordx4 v219, s[48:51], s62 offen offset:1024 lds
    ds_read_b64_tr_b16 v[86:87], v216 offset:1280
    ds_read_b64_tr_b16 v[88:89], v216 offset:2048
    ds_read_b64_tr_b16 v[90:91], v216 offset:2304
    s_waitcnt lgkmcnt(13)
    v_mfma_f32_32x32x16_bf16 v[152:167], v[52:55], a[188:191], v[152:167]
L_padm0:
    s_cbranch_execz L_walked0
    ds_read_b64_tr_b16 v[92:93], v216 offset:3072
    ds_read_b64_tr_b16 v[94:95], v216 offset:3328
    ds_read_b128 a[216:219], v205 offset:18432
    s_waitcnt lgkmcnt(13)
    v_mfma_f32_16x16x16_bf16 v[184:187], v[96:97], v[36:37], 0
    s_add_u32 m0, s15, 92160
    s_add_u32 s62, s64, 128
    buffer_load_dwordx4 v218, s[48:51], s62 offen lds
    ds_read_b128 a[220:223], v205 offset:18944
    v_mfma_f32_32x32x16_bf16 v[152:167], v[56:59], a[192:195], v[152:167]
    ds_read_b128 a[224:227], v205 offset:19456
    ds_read_b128 a[228:231], v205 offset:19968
    ds_read_b128 a[232:235], v205 offset:20480
    v_mfma_f32_32x32x16_bf16 v[152:167], v[60:63], a[196:199], v[152:167]
    buffer_load_dwordx4 v219, s[48:51], s62 offen offset:1024 lds
    ds_read_b128 a[236:239], v205 offset:20992
    ds_read_b128 a[240:243], v205 offset:21504
    ds_read_b128 a[244:247], v205 offset:22016
    s_waitcnt lgkmcnt(14)
    v_mfma_f32_32x32x16_bf16 v[152:167], v[64:67], a[200:203], v[152:167]
    ds_read_b128 a[248:251], v205 offset:22528
    v_mfma_f32_32x32x16_bf16 v[152:167], v[68:71], a[204:207], v[152:167]
    s_add_u32 m0, s15, 101376
    s_add_u32 s62, s64, 192
    buffer_load_dwordx4 v218, s[48:51], s62 offen lds
    v_mfma_f32_32x32x16_bf16 v[152:167], v[72:75], a[208:211], v[152:167]
    v_mfma_f32_32x32x16_bf16 v[152:167], v[76:79], a[212:215], v[152:167]
    buffer_load_dwordx4 v219, s[48:51], s62 offen offset:1024 lds
    v_mfma_f32_16x16x32_bf16 v[184:187], v[80:83], v[20:23], v[184:187]
    s_waitcnt vmcnt(7)
    buffer_store_dwordx2 v[38:39], v238, s[52:55], s79 offen sc1
    s_waitcnt lgkmcnt(13)
    v_mfma_f32_16x16x32_bf16 v[184:187], v[84:87], v[24:27], v[184:187]
    s_waitcnt lgkmcnt(11)
    v_mfma_f32_16x16x32_bf16 v[184:187], v[88:91], v[28:31], v[184:187]
    s_waitcnt lgkmcnt(9)
    v_mfma_f32_16x16x32_bf16 v[184:187], v[92:95], v[32:35], v[184:187]
    s_waitcnt lgkmcnt(8)
    v_mfma_f32_32x32x16_bf16 v[168:183], v[44:47], a[216:219], 0
    s_waitcnt lgkmcnt(7)
    v_mfma_f32_32x32x16_bf16 v[168:183], v[48:51], a[220:223], v[168:183]
    v_cvt_pk_bf16_f32 v152, v152, v153
    v_cvt_pk_bf16_f32 v153, v154, v155
    v_cvt_pk_bf16_f32 v154, v156, v157
    s_waitcnt lgkmcnt(6)
    v_mfma_f32_32x32x16_bf16 v[168:183], v[52:55], a[224:227], v[168:183]
    v_cvt_pk_bf16_f32 v155, v158, v159
    ds_write_b128 v206, v[152:155] offset:5120
    v_cvt_pk_bf16_f32 v156, v160, v161
    s_waitcnt lgkmcnt(6)
    v_mfma_f32_32x32x16_bf16 v[168:183], v[56:59], a[228:231], v[168:183]
    v_cvt_pk_bf16_f32 v157, v162, v163
    v_cvt_pk_bf16_f32 v158, v164, v165
    v_cvt_pk_bf16_f32 v159, v166, v167
    s_waitcnt lgkmcnt(5)
    v_mfma_f32_32x32x16_bf16 v[168:183], v[60:63], a[232:235], v[168:183]
    ds_write_b128 v206, v[156:159] offset:5632
    v_cvt_pk_bf16_f32 v184, v184, v185
    v_cvt_pk_bf16_f32 v185, v186, v187
    s_waitcnt lgkmcnt(5)
    v_mfma_f32_32x32x16_bf16 v[168:183], v[64:67], a[236:239], v[168:183]
    ds_write_b64 v207, v[184:185] offset:4608
    s_waitcnt lgkmcnt(5)
    v_mfma_f32_32x32x16_bf16 v[168:183], v[68:71], a[240:243], v[168:183]
    s_waitcnt lgkmcnt(4)
    v_mfma_f32_32x32x16_bf16 v[168:183], v[72:75], a[244:247], v[168:183]
    s_waitcnt lgkmcnt(3)
    v_mfma_f32_32x32x16_bf16 v[168:183], v[76:79], a[248:251], v[168:183]
    s_waitcnt vmcnt(1)
    ds_read_b128 v[98:101], v223 offset:0
    ds_read_b128 v[102:105], v213 offset:0
    ds_read_b128 v[106:109], v223 offset:9216
    ds_read_b128 v[110:113], v213 offset:9216
    ds_read_b128 v[114:117], v223 offset:18432
    ds_read_b128 v[118:121], v213 offset:18432
    ds_read_b128 v[122:125], v223 offset:27648
    ds_read_b128 v[126:129], v213 offset:27648
    ds_read_b128 v[130:133], v224
    s_nop 1
    v_cvt_pk_bf16_f32 v168, v168, v169
    v_cvt_pk_bf16_f32 v169, v170, v171
    v_cvt_pk_bf16_f32 v170, v172, v173
    v_cvt_pk_bf16_f32 v171, v174, v175
    ds_write_b128 v206, v[168:171] offset:23552
    s_cmp_lg_u32 s3, 0
    s_cbranch_scc1 L_k3
    s_mov_b32 m0, 161536
    s_add_u32 s62, s72, 73728
    buffer_load_dwordx4 v229, s[44:47], s62 offen offset:256 lds
L_k3:
    s_add_u32 m0, s14, 157440
    s_nop 0
    buffer_load_dwordx4 v229, s[44:47], s71 offen offset:256 lds
    v_cvt_pk_bf16_f32 v172, v176, v177
    v_cvt_pk_bf16_f32 v173, v178, v179
    v_cvt_pk_bf16_f32 v174, v180, v181
    v_cvt_pk_bf16_f32 v175, v182, v183
    ds_write_b128 v206, v[172:175] offset:24064
    s_add_u32 m0, s64, 120832
    s_add_u32 s62, s72, 0
    buffer_load_dwordx4 v228, s[44:47], s62 offen offset:0 lds
    s_waitcnt lgkmcnt(0)
    s_barrier
    ds_read_b64 v[96:97], v207 offset:4608
    ds_read_b64 v[150:151], v193
    ds_read_b128 v[80:83], v204 offset:5120
    ds_read_b128 v[134:137], v192 offset:0
    ds_read_b128 v[84:87], v204 offset:6144
    ds_read_b128 v[138:141], v192 offset:9216
    ds_read_b128 v[88:91], v204 offset:7168
    ds_read_b128 v[142:145], v192 offset:18432
    ds_read_b128 v[92:95], v204 offset:8192
    ds_read_b128 v[146:149], v192 offset:27648
    ds_read_b128 a[72:75], v205 offset:5120
    ds_read_b128 a[76:79], v205 offset:5632
    ds_read_b128 a[80:83], v205 offset:6144
    ds_read_b128 a[84:87], v205 offset:6656
    s_waitcnt lgkmcnt(12)
    v_mfma_f32_16x16x16_bf16 v[76:79], v[150:151], v[96:97], 0
    ds_read_b128 a[88:91], v205 offset:7168
    s_waitcnt lgkmcnt(4)
    v_mfma_f32_32x32x16_bf16 v[44:59], v[98:101], a[72:75], 0
    ds_read_b128 a[92:95], v205 offset:7680
    ds_read_b128 a[96:99], v205 offset:8192
    ds_read_b128 a[100:103], v205 offset:8704
    s_add_u32 s62, s72, 8192
    buffer_load_dwordx4 v228, s[44:47], s62 offen offset:1024 lds
    v_and_b32 v5, 0x1f0, v239
    v_add_u32 v5, 100352, v5
    v_mfma_f32_16x16x32_bf16 v[76:79], v[134:137], v[80:83], v[76:79]
    ds_read_b128 a[104:107], v205 offset:4608
    v_mfma_f32_16x16x32_bf16 v[76:79], v[138:141], v[84:87], v[76:79]
    ds_read_b128 a[108:111], v205 offset:23552
    s_waitcnt lgkmcnt(8)
    v_mfma_f32_32x32x16_bf16 v[44:59], v[102:105], a[76:79], v[44:59]
    ds_read_b128 a[112:115], v205 offset:24064
    ds_read_b128 a[116:119], v205 offset:24576
    ds_read_b128 a[120:123], v205 offset:25088
    v_lshrrev_b32 v18, 5, v3
    v_lshlrev_b32 v18, 4, v18
    v_mfma_f32_16x16x32_bf16 v[76:79], v[142:145], v[88:91], v[76:79]
    ds_read_b128 a[124:127], v205 offset:25600
    v_mfma_f32_16x16x32_bf16 v[76:79], v[146:149], v[92:95], v[76:79]
    ds_read_b128 a[128:131], v205 offset:26112
    s_waitcnt lgkmcnt(12)
    v_mfma_f32_32x32x16_bf16 v[44:59], v[106:109], a[80:83], v[44:59]
    ds_read_b128 a[132:135], v205 offset:26624
    ds_read_b128 a[136:139], v205 offset:27136
    ds_read_b128 a[140:143], v205 offset:23040
    s_add_u32 s62, s72, 16384
    buffer_load_dwordx4 v228, s[44:47], s62 offen offset:2048 lds
    v_lshrrev_b32 v18, v18, -1
    v_add_u32 v4, 81920, v239
    s_waitcnt lgkmcnt(14)
    v_mfma_f32_32x32x16_bf16 v[44:59], v[110:113], a[84:87], v[44:59]
    v_mov_b32 v14, v79
    v_mov_b32 v17, v79
    v_mov_b32 v16, 0x3df6384f
    s_nop 0
    v_permlane32_swap_b32 v17, v14
    v_cmp_eq_u32 vcc, s3, v2
    s_waitcnt lgkmcnt(13)
    v_mfma_f32_32x32x16_bf16 v[44:59], v[114:117], a[88:91], v[44:59]
    s_add_u32 s62, s72, 24576
    buffer_load_dwordx4 v228, s[44:47], s62 offen offset:3072 lds
    v_mov_b32 v17, v14
    v_mul_f32 v12, v76, v76
    v_mul_f32 v13, v77, v77
    v_permlane16_swap_b32 v17, v14
    v_fmac_f32 v12, v78, v78
    s_waitcnt lgkmcnt(12)
    v_mfma_f32_32x32x16_bf16 v[44:59], v[118:121], a[92:95], v[44:59]
    v_mul_f32 v14, 0xbdf6384f, v14
    ds_write_b32 v204, v14
    v_fmac_f32 v13, v79, v79
    v_fma_f32 v76, v76, v16, v14
    v_fma_f32 v77, v77, v16, v14
    s_waitcnt lgkmcnt(12)
    v_mfma_f32_32x32x16_bf16 v[44:59], v[122:125], a[96:99], v[44:59]
    s_add_u32 m0, s64, 124928
    s_add_u32 s62, s72, 36864
    buffer_load_dwordx4 v228, s[44:47], s62 offen offset:0 lds
    v_fma_f32 v78, v78, v16, v14
    v_fma_f32 v79, v79, v16, v14
    v_add_f32 v12, v12, v13
    v_cvt_pk_bf16_f32 v76, v76, v77
    v_cvt_pk_bf16_f32 v77, v78, v79
    s_waitcnt lgkmcnt(11)
    v_mfma_f32_32x32x16_bf16 v[44:59], v[126:129], a[100:103], v[44:59]
    buffer_load_dwordx2 v[188:189], v255, s[52:55], 0 offen sc1
    v_mov_b32 v17, v12
    s_nop 1
    v_permlane16_swap_b32 v17, v12
    v_add_f32 v12, v12, v17
    v_mov_b32 v17, v12
    s_nop 1
    v_permlane32_swap_b32 v17, v12
    s_waitcnt lgkmcnt(10)
    v_mfma_f32_32x32x16_bf16 v[44:59], v[130:133], a[104:107], v[44:59]
    s_add_u32 s62, s72, 45056
    buffer_load_dwordx4 v228, s[44:47], s62 offen offset:1024 lds
    v_add_f32 v12, v12, v17
    v_cndmask_b32 v12, 0, v12, vcc
    v_xor_b32 v152, s63, v4
    v_xor_b32 v153, 1024, v152
    v_xor_b32 v154, 2048, v152
    s_waitcnt lgkmcnt(0)
    s_barrier
    ds_read_b32 v184, v205 offset:0
    ds_read_b32 v186, v205 offset:18432
    v_mfma_f32_32x32x16_bf16 v[60:75], v[98:101], a[108:111], 0
    ds_write_b64 v226, v[76:77]
    v_xor_b32 v155, 3072, v152
    v_xor_b32 v156, 4096, v152
    v_xor_b32 v157, 5120, v152
    v_xor_b32 v158, 6144, v152
    v_mfma_f32_32x32x16_bf16 v[60:75], v[102:105], a[112:115], v[60:75]
    s_add_u32 s62, s72, 53248
    buffer_load_dwordx4 v228, s[44:47], s62 offen offset:2048 lds
    v_xor_b32 v159, 7168, v152
    v_mfma_f32_32x32x16_bf16 v[60:75], v[106:109], a[116:119], v[60:75]
    v_mul_f32 v8, v44, v44
    v_mul_f32 v9, v45, v45
    v_fmac_f32 v8, v46, v46
    v_fmac_f32 v9, v47, v47
    v_fmac_f32 v8, v48, v48
    v_mfma_f32_32x32x16_bf16 v[60:75], v[110:113], a[120:123], v[60:75]
    s_add_u32 s62, s72, 61440
    buffer_load_dwordx4 v228, s[44:47], s62 offen offset:3072 lds
    v_fmac_f32 v9, v49, v49
    v_fmac_f32 v8, v50, v50
    v_fmac_f32 v9, v51, v51
    v_fmac_f32 v8, v52, v52
    v_fmac_f32 v9, v53, v53
    v_mfma_f32_32x32x16_bf16 v[60:75], v[114:117], a[124:127], v[60:75]
    v_fmac_f32 v8, v54, v54
    v_fmac_f32 v9, v55, v55
    v_fmac_f32 v8, v56, v56
    v_fmac_f32 v9, v57, v57
    v_fmac_f32 v8, v58, v58
    v_mfma_f32_32x32x16_bf16 v[60:75], v[118:121], a[128:131], v[60:75]
    s_add_u32 m0, s64, 129024
    s_add_u32 s62, s72, 73728
    buffer_load_dwordx4 v228, s[44:47], s62 offen offset:0 lds
    v_fmac_f32 v9, v59, v59
    s_waitcnt lgkmcnt(2)
    v_fma_f32 v44, v44, v16, v184
    v_fma_f32 v45, v45, v16, v184
    v_fma_f32 v46, v46, v16, v184
    v_fma_f32 v47, v47, v16, v184
    v_mfma_f32_32x32x16_bf16 v[60:75], v[122:125], a[132:135], v[60:75]
    v_fma_f32 v48, v48, v16, v184
    v_fma_f32 v49, v49, v16, v184
    v_fma_f32 v50, v50, v16, v184
    v_fma_f32 v51, v51, v16, v184
    v_add_f32 v8, v8, v9
    v_mfma_f32_32x32x16_bf16 v[60:75], v[126:129], a[136:139], v[60:75]
    v_cvt_pk_bf16_f32 v44, v44, v45
    v_cvt_pk_bf16_f32 v45, v46, v47
    v_cvt_pk_bf16_f32 v46, v48, v49
    v_cvt_pk_bf16_f32 v47, v50, v51
    ds_write_b128 v225, v[44:47] offset:0
    v_mfma_f32_32x32x16_bf16 v[60:75], v[130:133], a[140:143], v[60:75]
    v_fma_f32 v52, v52, v16, v184
    v_fma_f32 v53, v53, v16, v184
    v_fma_f32 v54, v54, v16, v184
    v_fma_f32 v55, v55, v16, v184
    v_fma_f32 v56, v56, v16, v184
    v_fma_f32 v57, v57, v16, v184
    v_fma_f32 v58, v58, v16, v184
    v_fma_f32 v59, v59, v16, v184
    v_cvt_pk_bf16_f32 v48, v52, v53
    v_cvt_pk_bf16_f32 v49, v54, v55
    v_cvt_pk_bf16_f32 v50, v56, v57
    v_cvt_pk_bf16_f32 v51, v58, v59
    ds_write_b128 v225, v[48:51] offset:1024
    s_waitcnt vmcnt(4)
    v_subrev_co_u32 v190, vcc, s0, v188
    v_mov_b32 v191, s1
    s_nop 0
    v_subb_co_u32 v191, vcc, v189, v191, vcc
    v_lshrrev_b32 v190, 28, v190
    v_or_b32 v190, v190, v191
    v_cmp_ne_u32 vcc, 0, v190
    s_nop 0
    s_and_b32 s60, vcc_lo, 0xff
    s_cselect_b32 s10, 0, s96
    buffer_load_dwordx2 v[188:189], v255, s[52:55], 0 offen sc1
    v_pk_mul_f32 v[10:11], v[60:61], v[60:61]
    v_pk_fma_f32 v[10:11], v[62:63], v[62:63], v[10:11]
    v_pk_fma_f32 v[10:11], v[64:65], v[64:65], v[10:11]
    v_pk_fma_f32 v[10:11], v[66:67], v[66:67], v[10:11]
    v_pk_fma_f32 v[10:11], v[68:69], v[68:69], v[10:11]
    v_pk_fma_f32 v[10:11], v[70:71], v[70:71], v[10:11]
    s_add_u32 m0, s64, 0
    s_nop 0
    buffer_load_dwordx4 v239, s[8:11], s18 offen offset:0 sc1 lds
    v_pk_fma_f32 v[10:11], v[72:73], v[72:73], v[10:11]
    v_pk_fma_f32 v[10:11], v[74:75], v[74:75], v[10:11]
    s_waitcnt lgkmcnt(3)
    v_pk_fma_f32 v[60:61], v[60:61], v[16:17], v[186:187] op_sel_hi:[1,0,0]
    v_pk_fma_f32 v[62:63], v[62:63], v[16:17], v[186:187] op_sel_hi:[1,0,0]
    v_pk_fma_f32 v[64:65], v[64:65], v[16:17], v[186:187] op_sel_hi:[1,0,0]
    v_pk_fma_f32 v[66:67], v[66:67], v[16:17], v[186:187] op_sel_hi:[1,0,0]
    buffer_load_dwordx4 v239, s[8:11], s19 offen offset:1024 sc1 lds
    v_add_f32 v10, v10, v11
    v_cvt_pk_bf16_f32 v60, v60, v61
    v_cvt_pk_bf16_f32 v61, v62, v63
    v_cvt_pk_bf16_f32 v62, v64, v65
    v_cvt_pk_bf16_f32 v63, v66, v67
    ds_write_b128 v225, v[60:63] offset:8192
    buffer_load_dwordx4 v239, s[8:11], s20 offen offset:2048 sc1 lds
    v_pk_fma_f32 v[68:69], v[68:69], v[16:17], v[186:187] op_sel_hi:[1,0,0]
    v_pk_fma_f32 v[70:71], v[70:71], v[16:17], v[186:187] op_sel_hi:[1,0,0]
    v_pk_fma_f32 v[72:73], v[72:73], v[16:17], v[186:187] op_sel_hi:[1,0,0]
    v_pk_fma_f32 v[74:75], v[74:75], v[16:17], v[186:187] op_sel_hi:[1,0,0]
    v_cvt_pk_bf16_f32 v64, v68, v69
    v_cvt_pk_bf16_f32 v65, v70, v71
    buffer_load_dwordx4 v239, s[8:11], s21 offen offset:3072 sc1 lds
    v_cvt_pk_bf16_f32 v66, v72, v73
    v_cvt_pk_bf16_f32 v67, v74, v75
    ds_write_b128 v225, v[64:67] offset:9216
    v_permlane32_swap_b32 v8, v10
    s_nop 0
    v_add_f32 v8, v8, v10
    s_add_u32 m0, s64, 4096
    s_nop 0
    buffer_load_dwordx4 v239, s[8:11], s22 offen offset:0 sc1 lds
    v_add_f32 v8, v8, v12
    ds_write_b32 v194, v8
    buffer_load_dwordx4 v239, s[8:11], s23 offen offset:1024 sc1 lds
    s_waitcnt vmcnt(7)
    ds_read_b64_tr_b16 v[98:99], v6 offset:0
    ds_read_b64_tr_b16 v[100:101], v6 offset:512
    ds_read_b64_tr_b16 v[102:103], v6 offset:1024
    ds_read_b64_tr_b16 v[104:105], v6 offset:1536
    ds_read_b64_tr_b16 v[106:107], v6 offset:2048
    ds_read_b64_tr_b16 v[108:109], v6 offset:2560
    ds_read_b64_tr_b16 v[110:111], v6 offset:3072
    ds_read_b64_tr_b16 v[112:113], v6 offset:3584
    ds_read_b64_tr_b16 v[114:115], v6 offset:4096
    ds_read_b64_tr_b16 v[116:117], v6 offset:4608
    s_waitcnt lgkmcnt(10)
    s_barrier
    ds_read_b64_tr_b16 v[118:119], v6 offset:5120
    ds_read_b64_tr_b16 v[120:121], v6 offset:5632
    ds_read_b64_tr_b16 v[122:123], v6 offset:6144
    ds_read_b64_tr_b16 v[124:125], v6 offset:6656
    s_waitcnt lgkmcnt(12)
    v_mfma_f32_32x32x16_bf16 v[192:207], v[98:101], a[180:183], 0
    ds_read_b64_tr_b16 v[126:127], v6 offset:7168
    ds_read_b64_tr_b16 v[128:129], v6 offset:7680
    ds_read_b64_tr_b16 v[130:131], v6 offset:8192
    ds_read_b64_tr_b16 v[132:133], v6 offset:8704
    buffer_load_dwordx4 v239, s[8:11], s24 offen offset:2048 sc1 lds
    s_waitcnt lgkmcnt(14)
    v_mfma_f32_32x32x16_bf16 v[192:207], v[102:105], a[184:187], v[192:207]
    ds_read_b128 v[88:91], v5 offset:0
    ds_read_b128 v[92:95], v5 offset:512
    ds_read_b32 v96, v4 offset:16396
    ds_read_b32 v97, v4 offset:17420
    buffer_load_dwordx4 v239, s[8:11], s25 offen offset:3072 sc1 lds
    s_waitcnt lgkmcnt(14)
    v_mfma_f32_32x32x16_bf16 v[192:207], v[106:109], a[188:191], v[192:207]
    ds_read_b128 a[32:35], v4 offset:16384
    ds_read_b128 a[68:71], v4 offset:17408
    ds_read_b64_tr_b16 v[150:151], v251
    ds_read_b64_tr_b16 v[134:135], v250 offset:0
    s_cmp_eq_u32 s10, 0
    s_cbranch_scc1 L_try2
L_try2x:
    s_add_u32 m0, s64, 8192
    s_nop 0
    buffer_load_dwordx4 v239, s[8:11], s26 offen offset:0 sc1 lds
    v_mfma_f32_32x32x16_bf16 v[192:207], v[110:113], a[192:195], v[192:207]
    ds_read_b64_tr_b16 v[136:137], v250 offset:256
    ds_read_b64_tr_b16 v[138:139], v250 offset:1024
    ds_read_b64_tr_b16 v[140:141], v250 offset:1280
    ds_read_b64_tr_b16 v[142:143], v250 offset:2048
    s_add_u32 s8, s8, 73728
    s_addc_u32 s9, s9, 0
    s_sub_u32 s10, s10, 73728
    s_max_i32 s10, s10, 0
    s_add_u32 m0, s64, 36864
    s_nop 0
    buffer_load_dwordx4 v239, s[8:11], s18 offen offset:0 sc1 lds
    s_waitcnt lgkmcnt(14)
    v_mfma_f32_32x32x16_bf16 v[192:207], v[114:117], a[196:199], v[192:207]
    ds_read_b64_tr_b16 v[144:145], v250 offset:2304
    ds_read_b64_tr_b16 v[146:147], v250 offset:3072
    ds_read_b64_tr_b16 v[148:149], v250 offset:3328
    ds_read_b128 a[0:3], v152 offset:0
    buffer_load_dwordx4 v239, s[8:11], s19 offen offset:1024 sc1 lds
    v_mfma_f32_32x32x16_bf16 v[192:207], v[118:121], a[200:203], v[192:207]
    ds_read_b128 a[4:7], v153 offset:0
    ds_read_b128 a[8:11], v154 offset:0
    ds_read_b128 a[12:15], v155 offset:0
    ds_read_b128 a[16:19], v156 offset:0
    s_waitcnt lgkmcnt(14)
    s_mov_b32 s60, 0xbfc80dc0
    v_mov_b32 v87, 0x42700000
    v_add_f32 v88, v88, v89
    s_waitcnt lgkmcnt(13)
    v_mfma_f32_16x16x16_bf16 v[224:227], v[150:151], v[36:37], 0
    ds_read_b128 a[20:23], v157 offset:0
    v_add_f32 v92, v92, v93
    v_add_f32 v90, v90, v91
    buffer_load_dwordx4 v239, s[8:11], s20 offen offset:2048 sc1 lds
    v_mfma_f32_32x32x16_bf16 v[192:207], v[122:125], a[204:207], v[192:207]
    ds_read_b128 a[24:27], v158 offset:0
    ds_read_b128 a[28:31], v159 offset:0
    ds_read_b128 a[36:39], v152 offset:8192
    ds_read_b128 a[40:43], v153 offset:8192
    v_add_f32 v94, v94, v95
    v_add_f32 v88, v88, v90
    v_add_f32 v92, v92, v94
    v_mfma_f32_32x32x16_bf16 v[192:207], v[126:129], a[208:211], v[192:207]
    ds_read_b128 a[44:47], v154 offset:8192
    ds_read_b128 a[48:51], v155 offset:8192
    ds_read_b128 a[52:55], v156 offset:8192
    ds_read_b128 a[56:59], v157 offset:8192
    v_sqrt_f32 v88, v88
    v_sqrt_f32 v92, v92
    v_fma_f32 v88, v88, s60, v87
    buffer_load_dwordx4 v239, s[8:11], s21 offen offset:3072 sc1 lds
    v_mfma_f32_32x32x16_bf16 v[192:207], v[130:133], a[212:215], v[192:207]
    ds_read_b128 a[60:63], v158 offset:8192
    ds_read_b128 a[64:67], v159 offset:8192
    v_fma_f32 v92, v92, s60, v87
    v_cvt_pk_bf16_f32 v88, v88, v88
    v_cvt_pk_bf16_f32 v92, v92, v92
    v_mfma_f32_32x32x16_bf16 v[208:223], v[98:101], a[216:219], 0
    v_bfi_b32 v88, v18, v96, v88
    v_bfi_b32 v92, v18, v97, v92
    v_accvgpr_write_b32 a35, v88
    s_add_u32 m0, s64, 40960
    s_nop 0
    buffer_load_dwordx4 v239, s[8:11], s22 offen offset:0 sc1 lds
    v_mfma_f32_32x32x16_bf16 v[208:223], v[102:105], a[220:223], v[208:223]
    v_accvgpr_write_b32 a71, v92
    v_add_u32 v233, 73728, v232
    v_add_u32 v235, 73728, v234
    s_waitcnt lgkmcnt(14)
    v_mfma_f32_16x16x32_bf16 v[224:227], v[134:137], v[20:23], v[224:227]
    v_xor_b32 v236, 128, v234
    v_add_u32 v237, 73728, v236
    buffer_load_dwordx4 v239, s[8:11], s23 offen offset:1024 sc1 lds
    v_mfma_f32_32x32x16_bf16 v[208:223], v[106:109], a[224:227], v[208:223]
    s_mul_i32 s76, s2, 10240
    s_add_u32 s76, s76, 4849664
    s_mov_b32 s97, 0
    v_mfma_f32_32x32x16_bf16 v[208:223], v[110:113], a[228:231], v[208:223]
    buffer_load_dwordx4 v239, s[8:11], s24 offen offset:2048 sc1 lds
    s_mov_b32 s60, 0xbdd2d3e8
    v_mov_b32 v248, 0xc0135761
    v_mfma_f32_16x16x32_bf16 v[224:227], v[138:141], v[24:27], v[224:227]
    s_mul_i32 s61, s5, 5308416
    v_mov_b32 v250, -1
    v_mov_b32 v251, -1
    v_mfma_f32_32x32x16_bf16 v[208:223], v[114:117], a[232:235], v[208:223]
    buffer_load_dwordx4 v239, s[8:11], s25 offen offset:3072 sc1 lds
    s_add_u32 s61, s61, 2359296
    v_mov_b32 v252, -1
    v_mov_b32 v253, -1
    v_mul_f32 v240, v192, v192
    v_mfma_f32_32x32x16_bf16 v[208:223], v[118:121], a[236:239], v[208:223]
    s_add_u32 s61, s61, s65
    v_mul_f32 v241, v193, v193
    v_mul_f32 v242, v194, v194
    v_mul_f32 v243, v195, v195
    v_fma_f32 v240, v240, s60, v248
    v_fma_f32 v241, v241, s60, v248
    v_fma_f32 v242, v242, s60, v248
    v_mfma_f32_16x16x32_bf16 v[224:227], v[142:145], v[28:31], v[224:227]
    s_add_u32 m0, s64, 45056
    s_nop 0
    buffer_load_dwordx4 v239, s[8:11], s26 offen offset:0 sc1 lds
    s_add_u32 s44, s38, s61
    s_addc_u32 s45, s39, 0
    v_mfma_f32_32x32x16_bf16 v[208:223], v[122:125], a[240:243], v[208:223]
    s_cmp_eq_u32 s10, 0
    s_cbranch_scc1 L_poll0
L_have:
    s_waitcnt vmcnt(9)
    ds_read_b128 a[72:75], v232 offset:0
    ds_read_b128 a[76:79], v232 offset:1024
    ds_read_b128 a[80:83], v232 offset:2048
    v_fma_f32 v243, v243, s60, v248
    v_mul_f32 v240, v240, v192
    v_mul_f32 v241, v241, v193
    v_mfma_f32_32x32x16_bf16 v[208:223], v[126:129], a[244:247], v[208:223]
    ds_read_b128 a[84:87], v232 offset:3072
    ds_read_b128 a[88:91], v232 offset:4096
    ds_read_b128 a[92:95], v232 offset:5120
    v_mul_f32 v242, v242, v194
    v_mul_f32 v243, v243, v195
    v_exp_f32 v240, v240
    v_mfma_f32_16x16x32_bf16 v[224:227], v[146:149], v[32:35], v[224:227]
    ds_read_b128 a[96:99], v232 offset:6144
    v_exp_f32 v241, v241
    v_mfma_f32_32x32x16_bf16 v[208:223], v[130:133], a[248:251], v[208:223]
    ds_read_b128 a[100:103], v232 offset:7168
    ds_read_b128 a[104:107], v232 offset:8192
    v_exp_f32 v242, v242
    v_exp_f32 v243, v243
    s_mov_b32 s46, 1152000
    s_mov_b32 s47, 0x20000
    s_lshl_b32 s62, s3, 11
    s_add_u32 s62, s62, s76
    s_add_u32 s61, s76, 8192
    s_cmp_eq_u32 s3, 0
    s_cselect_b32 s61, s61, 0x7fff0000
    v_add_f32 v240, 1.0, v240
    v_add_f32 v241, 1.0, v241
    v_add_f32 v242, 1.0, v242
    v_add_f32 v243, 1.0, v243
    v_rcp_f32 v240, v240
    v_rcp_f32 v241, v241
    v_rcp_f32 v242, v242
    v_rcp_f32 v243, v243
    v_mul_f32 v192, v192, v240
    v_mul_f32 v193, v193, v241
    s_waitcnt lgkmcnt(0)
    s_barrier
    v_mfma_f32_32x32x16_bf16 v[144:159], a[72:75], a[0:3], 0
    s_add_u32 s8, s8, 73728
    s_addc_u32 s9, s9, 0
    s_sub_u32 s10, s10, 73728
    v_mul_f32 v194, v194, v242
    v_mul_f32 v195, v195, v243
    v_mul_f32 v240, v196, v196
    v_mfma_f32_32x32x16_bf16 v[144:159], a[76:79], a[4:7], v[144:159]
    s_max_i32 s10, s10, 0
    ds_read_b64_tr_b16 a[108:109], v234 offset:0
    s_add_u32 m0, s64, 73728
    v_mul_f32 v241, v197, v197
    v_mul_f32 v242, v198, v198
    v_mul_f32 v243, v199, v199
    v_mfma_f32_32x32x16_bf16 v[144:159], a[80:83], a[8:11], v[144:159]
    buffer_load_dwordx4 v239, s[8:11], s18 offen offset:0 sc1 lds
    ds_read_b64_tr_b16 a[110:111], v236 offset:0
    v_fma_f32 v240, v240, s60, v248
    v_fma_f32 v241, v241, s60, v248
    v_mfma_f32_32x32x16_bf16 v[144:159], a[84:87], a[12:15], v[144:159]
    ds_read_b64_tr_b16 a[112:113], v234 offset:1024
    ds_read_b64_tr_b16 a[114:115], v236 offset:1024
    v_fma_f32 v242, v242, s60, v248
    v_fma_f32 v243, v243, s60, v248
    v_mul_f32 v240, v240, v196
    v_mul_f32 v241, v241, v197
    v_mfma_f32_32x32x16_bf16 v[144:159], a[88:91], a[16:19], v[144:159]
    buffer_load_dwordx4 v239, s[8:11], s19 offen offset:1024 sc1 lds
    ds_read_b64_tr_b16 a[116:117], v234 offset:2048
    ds_read_b64_tr_b16 a[118:119], v236 offset:2048
    v_mul_f32 v242, v242, v198
    v_mul_f32 v243, v243, v199
    v_mfma_f32_32x32x16_bf16 v[144:159], a[92:95], a[20:23], v[144:159]
    ds_read_b64_tr_b16 a[120:121], v234 offset:3072
    ds_read_b64_tr_b16 a[122:123], v236 offset:3072
    v_exp_f32 v240, v240
    v_exp_f32 v241, v241
    v_mfma_f32_32x32x16_bf16 v[144:159], a[96:99], a[24:27], v[144:159]
    buffer_load_dwordx4 v239, s[8:11], s20 offen offset:2048 sc1 lds
    ds_read_b64_tr_b16 a[124:125], v234 offset:4096
    ds_read_b64_tr_b16 a[126:127], v236 offset:4096
    v_exp_f32 v242, v242
    v_mfma_f32_32x32x16_bf16 v[144:159], a[100:103], a[28:31], v[144:159]
    ds_read_b64_tr_b16 a[128:129], v234 offset:5120
    ds_read_b64_tr_b16 a[130:131], v236 offset:5120
    v_exp_f32 v243, v243
    v_add_f32 v240, 1.0, v240
    v_add_f32 v241, 1.0, v241
    v_mfma_f32_32x32x16_bf16 v[144:159], a[104:107], a[32:35], v[144:159]
    buffer_load_dwordx4 v239, s[8:11], s21 offen offset:3072 sc1 lds
    ds_read_b64_tr_b16 a[132:133], v234 offset:6144
    ds_read_b64_tr_b16 a[134:135], v236 offset:6144
    v_add_f32 v242, 1.0, v242
    v_add_f32 v243, 1.0, v243
    v_mfma_f32_32x32x16_bf16 v[160:175], a[72:75], a[36:39], 0
    s_add_u32 m0, s64, 77824
    ds_read_b64_tr_b16 a[136:137], v234 offset:7168
    ds_read_b64_tr_b16 a[138:139], v236 offset:7168
    v_rcp_f32 v240, v240
    v_rcp_f32 v241, v241
    v_mfma_f32_32x32x16_bf16 v[160:175], a[76:79], a[40:43], v[160:175]
    buffer_load_dwordx4 v239, s[8:11], s22 offen offset:0 sc1 lds
    ds_read_b64_tr_b16 a[140:141], v234 offset:8192
    ds_read_b64_tr_b16 a[142:143], v236 offset:8192
    v_rcp_f32 v242, v242
    v_mfma_f32_32x32x16_bf16 v[160:175], a[80:83], a[44:47], v[160:175]
    v_exp_f32 v144, v144
    v_exp_f32 v145, v145
    v_exp_f32 v152, v152
    v_exp_f32 v153, v153
    v_cvt_pk_bf16_f32 v176, v144, v145
    v_mfma_f32_32x32x16_bf16 v[160:175], a[84:87], a[48:51], v[160:175]
    v_exp_f32 v146, v146
    v_exp_f32 v147, v147
    v_cvt_pk_bf16_f32 v180, v152, v153
    v_exp_f32 v154, v154
    v_exp_f32 v155, v155
    v_mfma_f32_32x32x16_bf16 v[160:175], a[88:91], a[52:55], v[160:175]
    buffer_load_dwordx4 v239, s[8:11], s23 offen offset:1024 sc1 lds
    v_cvt_pk_bf16_f32 v177, v146, v147
    v_permlane16_swap_b32 v176, v180
    v_exp_f32 v148, v148
    v_exp_f32 v149, v149
    v_mfma_f32_32x32x16_bf16 v[160:175], a[92:95], a[56:59], v[160:175]
    buffer_load_dwordx2 v[246:247], v255, s[52:55], 0 offen sc1
    v_cvt_pk_bf16_f32 v181, v154, v155
    v_exp_f32 v156, v156
    v_exp_f32 v157, v157
    v_cvt_pk_bf16_f32 v178, v148, v149
    v_mfma_f32_32x32x16_bf16 v[160:175], a[96:99], a[60:63], v[160:175]
L_padm1:
    s_cbranch_execz L_walked0
    v_permlane16_swap_b32 v177, v181
    v_exp_f32 v150, v150
    v_exp_f32 v151, v151
    v_cvt_pk_bf16_f32 v182, v156, v157
    v_exp_f32 v158, v158
    v_mfma_f32_32x32x16_bf16 v[160:175], a[100:103], a[64:67], v[160:175]
    buffer_load_dwordx4 v239, s[8:11], s24 offen offset:2048 sc1 lds
    v_exp_f32 v159, v159
    v_cvt_pk_bf16_f32 v179, v150, v151
    v_permlane16_swap_b32 v178, v182
    v_cvt_pk_bf16_f32 v183, v158, v159
    s_nop 1
    v_permlane16_swap_b32 v179, v183
    v_mfma_f32_32x32x16_bf16 v[160:175], a[104:107], a[68:71], v[160:175]
    s_waitcnt lgkmcnt(0)
    buffer_load_dwordx4 v239, s[8:11], s25 offen offset:3072 sc1 lds
    v_rcp_f32 v243, v243
    v_mul_f32 v196, v196, v240
    v_mfma_f32_16x16x32_bf16 v[0:3], a[108:111], v[176:179], 0
    v_mul_f32 v197, v197, v241
    v_mfma_f32_16x16x32_bf16 v[36:39], a[108:111], v[180:183], 0
    s_add_u32 m0, s64, 81920
    v_mul_f32 v198, v198, v242
    v_mfma_f32_16x16x32_bf16 v[4:7], a[112:115], v[176:179], 0
    buffer_load_dwordx4 v239, s[8:11], s26 offen offset:0 sc1 lds
    v_mfma_f32_16x16x32_bf16 v[40:43], a[112:115], v[180:183], 0
    s_waitcnt vmcnt(10)
    ds_read_b128 a[72:75], v232 offset:36864
    v_mfma_f32_16x16x32_bf16 v[8:11], a[116:119], v[176:179], 0
    ds_read_b128 a[76:79], v232 offset:37888
    v_mfma_f32_16x16x32_bf16 v[44:47], a[116:119], v[180:183], 0
    ds_read_b128 a[80:83], v232 offset:38912
    v_mfma_f32_16x16x32_bf16 v[12:15], a[120:123], v[176:179], 0
    s_add_u32 s8, s8, 73728
    s_addc_u32 s9, s9, 0
    ds_read_b128 a[84:87], v232 offset:39936
    v_mfma_f32_16x16x32_bf16 v[48:51], a[120:123], v[180:183], 0
    s_sub_u32 s10, s10, 73728
    ds_read_b128 a[88:91], v232 offset:40960
    v_mfma_f32_16x16x32_bf16 v[16:19], a[124:127], v[176:179], 0
    s_max_i32 s10, s10, 0
    ds_read_b128 a[92:95], v232 offset:41984
    v_mfma_f32_16x16x32_bf16 v[52:55], a[124:127], v[180:183], 0
    s_add_u32 m0, s64, 110592
    v_exp_f32 v160, v160
    v_mfma_f32_16x16x32_bf16 v[20:23], a[128:131], v[176:179], 0
    buffer_load_dwordx4 v239, s[8:11], s18 offen offset:0 sc1 lds
    ds_read_b128 a[96:99], v232 offset:43008
    v_mfma_f32_16x16x32_bf16 v[56:59], a[128:131], v[180:183], 0
    ds_read_b128 a[100:103], v232 offset:44032
    v_exp_f32 v161, v161
    v_mfma_f32_16x16x32_bf16 v[24:27], a[132:135], v[176:179], 0
    ds_read_b128 a[104:107], v232 offset:45056
    v_exp_f32 v168, v168
    v_mfma_f32_16x16x32_bf16 v[60:63], a[132:135], v[180:183], 0
    v_exp_f32 v169, v169
    v_mfma_f32_16x16x32_bf16 v[28:31], a[136:139], v[176:179], 0
    buffer_load_dwordx4 v239, s[8:11], s19 offen offset:1024 sc1 lds
    v_mfma_f32_16x16x32_bf16 v[64:67], a[136:139], v[180:183], 0
    v_cvt_pk_bf16_f32 v184, v160, v161
    v_exp_f32 v162, v162
    v_mfma_f32_16x16x32_bf16 v[32:35], a[140:143], v[176:179], 0
    v_exp_f32 v163, v163
    v_mfma_f32_16x16x32_bf16 v[68:71], a[140:143], v[180:183], 0
    s_waitcnt lgkmcnt(0)
    v_mul_f32 v199, v199, v243
L_have4:
    s_cmp_eq_u32 s5, 0
    s_cbranch_scc1 L_gate
    v_mfma_f32_32x32x16_bf16 v[144:159], a[72:75], a[0:3], 0
    buffer_load_dwordx4 v239, s[8:11], s20 offen offset:2048 sc1 lds
    v_cvt_pk_bf16_f32 v188, v168, v169
    v_exp_f32 v170, v170
    v_mul_f32 v240, v200, v200
    v_mfma_f32_32x32x16_bf16 v[144:159], a[76:79], a[4:7], v[144:159]
    v_exp_f32 v171, v171
    v_cvt_pk_bf16_f32 v185, v162, v163
    v_permlane16_swap_b32 v184, v188
    v_mul_f32 v241, v201, v201
    v_mfma_f32_32x32x16_bf16 v[144:159], a[80:83], a[8:11], v[144:159]
    v_exp_f32 v164, v164
    v_exp_f32 v165, v165
    v_cvt_pk_bf16_f32 v189, v170, v171
    v_mul_f32 v242, v202, v202
    v_mfma_f32_32x32x16_bf16 v[144:159], a[84:87], a[12:15], v[144:159]
    buffer_load_dwordx4 v239, s[8:11], s21 offen offset:3072 sc1 lds
    v_exp_f32 v172, v172
    v_exp_f32 v173, v173
    v_mfma_f32_32x32x16_bf16 v[144:159], a[88:91], a[16:19], v[144:159]
    v_cvt_pk_bf16_f32 v186, v164, v165
    v_permlane16_swap_b32 v185, v189
    v_exp_f32 v166, v166
    v_mul_f32 v243, v203, v203
    v_mfma_f32_32x32x16_bf16 v[144:159], a[92:95], a[20:23], v[144:159]
    v_exp_f32 v167, v167
    v_cvt_pk_bf16_f32 v190, v172, v173
    v_exp_f32 v174, v174
    v_fma_f32 v240, v240, s60, v248
    v_mfma_f32_32x32x16_bf16 v[144:159], a[96:99], a[24:27], v[144:159]
    s_add_u32 m0, s64, 114688
    v_exp_f32 v175, v175
    v_cvt_pk_bf16_f32 v187, v166, v167
    v_permlane16_swap_b32 v186, v190
    v_cvt_pk_bf16_f32 v191, v174, v175
    v_mfma_f32_32x32x16_bf16 v[144:159], a[100:103], a[28:31], v[144:159]
    buffer_load_dwordx4 v239, s[8:11], s22 offen offset:0 sc1 lds
    v_permlane16_swap_b32 v187, v191
    v_fma_f32 v241, v241, s60, v248
    v_fma_f32 v242, v242, s60, v248
    v_mfma_f32_32x32x16_bf16 v[144:159], a[104:107], a[32:35], v[144:159]
    buffer_load_dwordx4 v239, s[8:11], s23 offen offset:1024 sc1 lds
    v_fma_f32 v243, v243, s60, v248
    v_mul_f32 v240, v240, v200
    v_mul_f32 v241, v241, v201
    v_mul_f32 v242, v242, v202
    v_mfma_f32_16x16x32_bf16 v[72:75], a[108:111], v[184:187], 0
    v_mul_f32 v243, v243, v203
    v_mfma_f32_16x16x32_bf16 v[108:111], a[108:111], v[188:191], 0
    ds_read_b64_tr_b16 a[108:109], v234 offset:36864
    v_mfma_f32_16x16x32_bf16 v[76:79], a[112:115], v[184:187], 0
    ds_read_b64_tr_b16 a[110:111], v236 offset:36864
    v_mfma_f32_16x16x32_bf16 v[112:115], a[112:115], v[188:191], 0
    ds_read_b64_tr_b16 a[112:113], v234 offset:37888
    v_mfma_f32_16x16x32_bf16 v[80:83], a[116:119], v[184:187], 0
    ds_read_b64_tr_b16 a[114:115], v236 offset:37888
    v_mfma_f32_16x16x32_bf16 v[116:119], a[116:119], v[188:191], 0
    v_exp_f32 v144, v144
    v_mfma_f32_16x16x32_bf16 v[84:87], a[120:123], v[184:187], 0
    v_exp_f32 v145, v145
    v_mfma_f32_16x16x32_bf16 v[120:123], a[120:123], v[188:191], 0
    buffer_load_dwordx4 v239, s[8:11], s24 offen offset:2048 sc1 lds
    v_mfma_f32_16x16x32_bf16 v[88:91], a[124:127], v[184:187], 0
    buffer_load_dwordx4 v239, s[8:11], s25 offen offset:3072 sc1 lds
    v_mfma_f32_16x16x32_bf16 v[124:127], a[124:127], v[188:191], 0
    v_exp_f32 v152, v152
    v_mfma_f32_16x16x32_bf16 v[92:95], a[128:131], v[184:187], 0
    s_add_u32 m0, s64, 118784
    v_exp_f32 v153, v153
    v_mfma_f32_16x16x32_bf16 v[128:131], a[128:131], v[188:191], 0
    s_waitcnt vmcnt(11)
    ds_read_b64_tr_b16 a[116:117], v234 offset:38912
    v_subrev_co_u32 v230, vcc, s0, v246
    v_mfma_f32_16x16x32_bf16 v[96:99], a[132:135], v[184:187], 0
    buffer_load_dwordx4 v239, s[8:11], s26 offen offset:0 sc1 lds
    v_mov_b32 v249, s1
    v_mfma_f32_16x16x32_bf16 v[132:135], a[132:135], v[188:191], 0
    ds_read_b64_tr_b16 a[118:119], v236 offset:38912
    v_subb_co_u32 v249, vcc, v247, v249, vcc
    v_lshrrev_b32 v230, 28, v230
    v_mfma_f32_16x16x32_bf16 v[100:103], a[136:139], v[184:187], 0
    ds_read_b64_tr_b16 a[120:121], v234 offset:39936
    v_or_b32 v230, v230, v249
    v_cmp_ne_u32 vcc, 0, v230
    v_mfma_f32_16x16x32_bf16 v[136:139], a[136:139], v[188:191], 0
    s_add_u32 s8, s8, 73728
    s_addc_u32 s9, s9, 0
    v_cvt_pk_bf16_f32 v176, v144, v145
    v_mfma_f32_16x16x32_bf16 v[104:107], a[140:143], v[184:187], 0
    s_sub_u32 s10, s10, 73728
    v_exp_f32 v146, v146
    v_mfma_f32_16x16x32_bf16 v[140:143], a[140:143], v[188:191], 0
    s_cbranch_vccnz L_poll4u
L_have4u:
    ds_read_b64_tr_b16 a[122:123], v236 offset:39936
    ds_read_b64_tr_b16 a[124:125], v234 offset:40960
    v_mfma_f32_32x32x16_bf16 v[160:175], a[72:75], a[36:39], 0
    s_max_i32 s10, s10, 0
    ds_read_b64_tr_b16 a[126:127], v236 offset:40960
    v_exp_f32 v147, v147
    v_cvt_pk_bf16_f32 v180, v152, v153
    v_exp_f32 v154, v154
    v_mfma_f32_32x32x16_bf16 v[160:175], a[76:79], a[40:43], v[160:175]
    s_add_u32 m0, s64, 0
    ds_read_b64_tr_b16 a[128:129], v234 offset:41984
    ds_read_b64_tr_b16 a[130:131], v236 offset:41984
    v_exp_f32 v155, v155
    v_cvt_pk_bf16_f32 v177, v146, v147
    v_permlane16_swap_b32 v176, v180
    v_mfma_f32_32x32x16_bf16 v[160:175], a[80:83], a[44:47], v[160:175]
    buffer_load_dwordx4 v239, s[8:11], s18 offen offset:0 sc1 lds
    ds_read_b64_tr_b16 a[132:133], v234 offset:43008
    v_exp_f32 v148, v148
    v_exp_f32 v149, v149
    v_mfma_f32_32x32x16_bf16 v[160:175], a[84:87], a[48:51], v[160:175]
    ds_read_b64_tr_b16 a[134:135], v236 offset:43008
    v_cvt_pk_bf16_f32 v181, v154, v155
    v_exp_f32 v156, v156
    v_exp_f32 v157, v157
    v_cvt_pk_bf16_f32 v178, v148, v149
    v_mfma_f32_32x32x16_bf16 v[160:175], a[88:91], a[52:55], v[160:175]
    buffer_load_dwordx4 v239, s[8:11], s19 offen offset:1024 sc1 lds
    ds_read_b64_tr_b16 a[136:137], v234 offset:44032
    v_permlane16_swap_b32 v177, v181
    v_exp_f32 v150, v150
    v_mfma_f32_32x32x16_bf16 v[160:175], a[92:95], a[56:59], v[160:175]
    ds_read_b64_tr_b16 a[138:139], v236 offset:44032
    ds_read_b64_tr_b16 a[140:141], v234 offset:45056
    v_exp_f32 v151, v151
    v_cvt_pk_bf16_f32 v182, v156, v157
    v_exp_f32 v158, v158
    v_mfma_f32_32x32x16_bf16 v[160:175], a[96:99], a[60:63], v[160:175]
    ds_read_b64_tr_b16 a[142:143], v236 offset:45056
    v_exp_f32 v159, v159
    v_cvt_pk_bf16_f32 v179, v150, v151
    v_permlane16_swap_b32 v178, v182
    v_cvt_pk_bf16_f32 v183, v158, v159
    v_mfma_f32_32x32x16_bf16 v[160:175], a[100:103], a[64:67], v[160:175]
    buffer_load_dwordx4 v239, s[8:11], s20 offen offset:2048 sc1 lds
    v_permlane16_swap_b32 v179, v183
    v_exp_f32 v240, v240
    v_mfma_f32_32x32x16_bf16 v[160:175], a[104:107], a[68:71], v[160:175]
    s_waitcnt vmcnt(12) lgkmcnt(0)
    v_exp_f32 v241, v241
    v_exp_f32 v242, v242
    v_exp_f32 v243, v243
    v_mfma_f32_16x16x32_bf16 v[0:3], a[108:111], v[176:179], v[0:3]
    ds_read_b128 a[72:75], v233 offset:0
    v_mfma_f32_16x16x32_bf16 v[36:39], a[108:111], v[180:183], v[36:39]
    buffer_load_dwordx4 v239, s[8:11], s21 offen offset:3072 sc1 lds
    v_mfma_f32_16x16x32_bf16 v[4:7], a[112:115], v[176:179], v[4:7]
    ds_read_b128 a[76:79], v233 offset:1024
    v_mfma_f32_16x16x32_bf16 v[40:43], a[112:115], v[180:183], v[40:43]
    ds_read_b128 a[80:83], v233 offset:2048
    v_add_f32 v240, 1.0, v240
    v_mfma_f32_16x16x32_bf16 v[8:11], a[116:119], v[176:179], v[8:11]
    ds_read_b128 a[84:87], v233 offset:3072
    v_add_f32 v241, 1.0, v241
    v_mfma_f32_16x16x32_bf16 v[44:47], a[116:119], v[180:183], v[44:47]
    s_add_u32 m0, s64, 4096
    ds_read_b128 a[88:91], v233 offset:4096
    v_add_f32 v242, 1.0, v242
    v_mfma_f32_16x16x32_bf16 v[12:15], a[120:123], v[176:179], v[12:15]
    buffer_load_dwordx4 v239, s[8:11], s22 offen offset:0 sc1 lds
    v_mfma_f32_16x16x32_bf16 v[48:51], a[120:123], v[180:183], v[48:51]
    ds_read_b128 a[92:95], v233 offset:5120
    v_add_f32 v243, 1.0, v243
    v_mfma_f32_16x16x32_bf16 v[16:19], a[124:127], v[176:179], v[16:19]
    v_rcp_f32 v240, v240
    v_mfma_f32_16x16x32_bf16 v[52:55], a[124:127], v[180:183], v[52:55]
    v_exp_f32 v160, v160
    v_mfma_f32_16x16x32_bf16 v[20:23], a[128:131], v[176:179], v[20:23]
    ds_read_b128 a[96:99], v233 offset:6144
    v_exp_f32 v161, v161
    v_mfma_f32_16x16x32_bf16 v[56:59], a[128:131], v[180:183], v[56:59]
    buffer_load_dwordx4 v239, s[8:11], s23 offen offset:1024 sc1 lds
    ds_read_b128 a[100:103], v233 offset:7168
    v_mfma_f32_16x16x32_bf16 v[24:27], a[132:135], v[176:179], v[24:27]
    ds_read_b128 a[104:107], v233 offset:8192
    v_exp_f32 v168, v168
    v_mfma_f32_16x16x32_bf16 v[60:63], a[132:135], v[180:183], v[60:63]
    v_exp_f32 v169, v169
    v_mfma_f32_16x16x32_bf16 v[28:31], a[136:139], v[176:179], v[28:31]
    v_cvt_pk_bf16_f32 v184, v160, v161
    v_exp_f32 v162, v162
    v_mfma_f32_16x16x32_bf16 v[64:67], a[136:139], v[180:183], v[64:67]
    buffer_load_dwordx4 v239, s[8:11], s24 offen offset:2048 sc1 lds
    v_mfma_f32_16x16x32_bf16 v[32:35], a[140:143], v[176:179], v[32:35]
    v_exp_f32 v163, v163
    v_mfma_f32_16x16x32_bf16 v[68:71], a[140:143], v[180:183], v[68:71]
    s_waitcnt lgkmcnt(0)
    v_rcp_f32 v241, v241
    v_mfma_f32_32x32x16_bf16 v[144:159], a[72:75], a[0:3], 0
    v_cvt_pk_bf16_f32 v188, v168, v169
    v_exp_f32 v170, v170
    v_exp_f32 v171, v171
    v_cvt_pk_bf16_f32 v185, v162, v163
    v_mfma_f32_32x32x16_bf16 v[144:159], a[76:79], a[4:7], v[144:159]
    buffer_load_dwordx4 v239, s[8:11], s25 offen offset:3072 sc1 lds
    v_permlane16_swap_b32 v184, v188
    v_exp_f32 v164, v164
    v_mfma_f32_32x32x16_bf16 v[144:159], a[80:83], a[8:11], v[144:159]
    s_add_u32 m0, s64, 8192
    v_exp_f32 v165, v165
    v_cvt_pk_bf16_f32 v189, v170, v171
    v_exp_f32 v172, v172
    v_rcp_f32 v242, v242
    v_mfma_f32_32x32x16_bf16 v[144:159], a[84:87], a[12:15], v[144:159]
    buffer_load_dwordx4 v239, s[8:11], s26 offen offset:0 sc1 lds
    v_exp_f32 v173, v173
    v_rcp_f32 v243, v243
    v_mfma_f32_32x32x16_bf16 v[144:159], a[88:91], a[16:19], v[144:159]
    s_add_u32 s8, s8, 73728
    s_addc_u32 s9, s9, 0
    v_cvt_pk_bf16_f32 v186, v164, v165
    v_permlane16_swap_b32 v185, v189
    v_exp_f32 v166, v166
    v_mfma_f32_32x32x16_bf16 v[144:159], a[92:95], a[20:23], v[144:159]
    s_sub_u32 s10, s10, 73728
    v_exp_f32 v167, v167
    v_cvt_pk_bf16_f32 v190, v172, v173
    v_exp_f32 v174, v174
    v_mul_f32 v200, v200, v240
    v_mfma_f32_32x32x16_bf16 v[144:159], a[96:99], a[24:27], v[144:159]
    s_max_i32 s10, s10, 0
    s_add_u32 m0, s64, 36864
    v_exp_f32 v175, v175
    v_cvt_pk_bf16_f32 v187, v166, v167
    v_permlane16_swap_b32 v186, v190
    v_cvt_pk_bf16_f32 v191, v174, v175
    v_mfma_f32_32x32x16_bf16 v[144:159], a[100:103], a[28:31], v[144:159]
    buffer_load_dwordx4 v239, s[8:11], s18 offen offset:0 sc1 lds
    v_permlane16_swap_b32 v187, v191
    v_mul_f32 v201, v201, v241
    v_mul_f32 v202, v202, v242
    v_mfma_f32_32x32x16_bf16 v[144:159], a[104:107], a[32:35], v[144:159]
    buffer_load_dwordx4 v239, s[8:11], s19 offen offset:1024 sc1 lds
    v_mul_f32 v203, v203, v243
    v_mul_f32 v240, v204, v204
    v_mul_f32 v241, v205, v205
    v_mul_f32 v242, v206, v206
    v_mfma_f32_16x16x32_bf16 v[72:75], a[108:111], v[184:187], v[72:75]
    v_mul_f32 v243, v207, v207
    v_mfma_f32_16x16x32_bf16 v[108:111], a[108:111], v[188:191], v[108:111]
    ds_read_b64_tr_b16 a[108:109], v235 offset:0
    v_fma_f32 v240, v240, s60, v248
    v_mfma_f32_16x16x32_bf16 v[76:79], a[112:115], v[184:187], v[76:79]
    ds_read_b64_tr_b16 a[110:111], v237 offset:0
    v_fma_f32 v241, v241, s60, v248
    v_mfma_f32_16x16x32_bf16 v[112:115], a[112:115], v[188:191], v[112:115]
    ds_read_b64_tr_b16 a[112:113], v235 offset:1024
    v_fma_f32 v242, v242, s60, v248
    v_mfma_f32_16x16x32_bf16 v[80:83], a[116:119], v[184:187], v[80:83]
    ds_read_b64_tr_b16 a[114:115], v237 offset:1024
    v_fma_f32 v243, v243, s60, v248
    v_mfma_f32_16x16x32_bf16 v[116:119], a[116:119], v[188:191], v[116:119]
    ds_read_b64_tr_b16 a[116:117], v235 offset:2048
    v_mul_f32 v240, v240, v204
    v_mfma_f32_16x16x32_bf16 v[84:87], a[120:123], v[184:187], v[84:87]
    v_exp_f32 v144, v144
    v_mfma_f32_16x16x32_bf16 v[120:123], a[120:123], v[188:191], v[120:123]
    v_exp_f32 v145, v145
    v_mfma_f32_16x16x32_bf16 v[88:91], a[124:127], v[184:187], v[88:91]
    buffer_load_dwordx4 v239, s[8:11], s20 offen offset:2048 sc1 lds
    v_mfma_f32_16x16x32_bf16 v[124:127], a[124:127], v[188:191], v[124:127]
    v_exp_f32 v152, v152
    v_mfma_f32_16x16x32_bf16 v[92:95], a[128:131], v[184:187], v[92:95]
    v_exp_f32 v153, v153
    v_mfma_f32_16x16x32_bf16 v[128:131], a[128:131], v[188:191], v[128:131]
    ds_read_b64_tr_b16 a[118:119], v237 offset:2048
    v_cvt_pk_bf16_f32 v176, v144, v145
    v_mfma_f32_16x16x32_bf16 v[96:99], a[132:135], v[184:187], v[96:99]
    buffer_load_dwordx4 v239, s[8:11], s21 offen offset:3072 sc1 lds
    v_mfma_f32_16x16x32_bf16 v[132:135], a[132:135], v[188:191], v[132:135]
    v_exp_f32 v146, v146
    v_mfma_f32_16x16x32_bf16 v[100:103], a[136:139], v[184:187], v[100:103]
    v_exp_f32 v147, v147
    v_mfma_f32_16x16x32_bf16 v[136:139], a[136:139], v[188:191], v[136:139]
    ds_read_b64_tr_b16 a[120:121], v235 offset:3072
    v_cvt_pk_bf16_f32 v180, v152, v153
    v_mfma_f32_16x16x32_bf16 v[104:107], a[140:143], v[184:187], v[104:107]
    v_exp_f32 v154, v154
    v_mfma_f32_16x16x32_bf16 v[140:143], a[140:143], v[188:191], v[140:143]
    buffer_store_dwordx4 v[250:253], v239, s[52:55], s62 offen offset:0 sc1
    v_mfma_f32_32x32x16_bf16 v[160:175], a[72:75], a[36:39], 0
    ds_read_b64_tr_b16 a[122:123], v237 offset:3072
    v_exp_f32 v155, v155
    v_cvt_pk_bf16_f32 v177, v146, v147
    v_permlane16_swap_b32 v176, v180
    v_mfma_f32_32x32x16_bf16 v[160:175], a[76:79], a[40:43], v[160:175]
    s_add_u32 m0, s64, 40960
    ds_read_b64_tr_b16 a[124:125], v235 offset:4096
    v_exp_f32 v148, v148
    v_exp_f32 v149, v149
    v_mul_f32 v241, v241, v205
    v_mfma_f32_32x32x16_bf16 v[160:175], a[80:83], a[44:47], v[160:175]
    buffer_load_dwordx4 v239, s[8:11], s22 offen offset:0 sc1 lds
    ds_read_b64_tr_b16 a[126:127], v237 offset:4096
    v_cvt_pk_bf16_f32 v181, v154, v155
    v_exp_f32 v156, v156
    v_mfma_f32_32x32x16_bf16 v[160:175], a[84:87], a[48:51], v[160:175]
    ds_read_b64_tr_b16 a[128:129], v235 offset:5120
    ds_read_b64_tr_b16 a[130:131], v237 offset:5120
    v_exp_f32 v157, v157
    v_cvt_pk_bf16_f32 v178, v148, v149
    v_permlane16_swap_b32 v177, v181
    v_mfma_f32_32x32x16_bf16 v[160:175], a[88:91], a[52:55], v[160:175]
    ds_read_b64_tr_b16 a[132:133], v235 offset:6144
    ds_read_b64_tr_b16 a[134:135], v237 offset:6144
    v_exp_f32 v150, v150
    v_exp_f32 v151, v151
    v_cvt_pk_bf16_f32 v182, v156, v157
    v_mfma_f32_32x32x16_bf16 v[160:175], a[92:95], a[56:59], v[160:175]
    buffer_load_dwordx4 v239, s[8:11], s23 offen offset:1024 sc1 lds
    ds_read_b64_tr_b16 a[136:137], v235 offset:7168
    ds_read_b64_tr_b16 a[138:139], v237 offset:7168
    ds_read_b64_tr_b16 a[140:141], v235 offset:8192
    v_exp_f32 v158, v158
    v_mfma_f32_32x32x16_bf16 v[160:175], a[96:99], a[60:63], v[160:175]
    ds_read_b64_tr_b16 a[142:143], v237 offset:8192
    v_exp_f32 v159, v159
    v_cvt_pk_bf16_f32 v179, v150, v151
    v_permlane16_swap_b32 v178, v182
    v_cvt_pk_bf16_f32 v183, v158, v159
    v_mfma_f32_32x32x16_bf16 v[160:175], a[100:103], a[64:67], v[160:175]
    buffer_load_dwordx4 v239, s[8:11], s24 offen offset:2048 sc1 lds
    v_permlane16_swap_b32 v179, v183
    v_mul_f32 v242, v242, v206
    v_mul_f32 v243, v243, v207
    v_mfma_f32_32x32x16_bf16 v[160:175], a[104:107], a[68:71], v[160:175]
    s_waitcnt vmcnt(17) lgkmcnt(0)
    v_exp_f32 v240, v240
    v_exp_f32 v241, v241
    v_exp_f32 v242, v242
    v_mfma_f32_16x16x32_bf16 v[0:3], a[108:111], v[176:179], v[0:3]
    s_lshl_b32 s68, s3, 10
    ds_read_b128 a[72:75], v233 offset:36864
    s_mul_i32 s14, s66, 9216
    v_mfma_f32_16x16x32_bf16 v[36:39], a[108:111], v[180:183], v[36:39]
    s_mul_i32 s15, s67, 9216
    ds_read_b128 a[76:79], v233 offset:37888
    s_add_u32 s14, s14, s68
    v_mfma_f32_16x16x32_bf16 v[4:7], a[112:115], v[176:179], v[4:7]
    s_add_u32 s15, s15, s68
    ds_read_b128 a[80:83], v233 offset:38912
    s_mul_i32 s72, s74, 4608
    v_mfma_f32_16x16x32_bf16 v[40:43], a[112:115], v[180:183], v[40:43]
    buffer_load_dwordx4 v239, s[8:11], s25 offen offset:3072 sc1 lds
    v_mfma_f32_16x16x32_bf16 v[8:11], a[116:119], v[176:179], v[8:11]
    s_add_u32 s72, s72, 4096
    ds_read_b128 a[84:87], v233 offset:39936
    v_bfe_u32 v244, v231, 7, 1
    v_mfma_f32_16x16x32_bf16 v[44:47], a[116:119], v[180:183], v[44:47]
    ds_read_b128 a[88:91], v233 offset:40960
    v_and_b32 v245, 0x1ff, v239
    v_mfma_f32_16x16x32_bf16 v[12:15], a[120:123], v[176:179], v[12:15]
    ds_read_b128 a[92:95], v233 offset:41984
    v_mul_u32_u24 v244, 4352, v244
    v_mfma_f32_16x16x32_bf16 v[48:51], a[120:123], v[180:183], v[48:51]
    s_add_u32 m0, s64, 45056
    ds_read_b128 a[96:99], v233 offset:43008
    v_lshrrev_b32 v246, 9, v239
    v_mfma_f32_16x16x32_bf16 v[16:19], a[124:127], v[176:179], v[16:19]
    buffer_load_dwordx4 v239, s[8:11], s26 offen offset:0 sc1 lds
    v_mfma_f32_16x16x32_bf16 v[52:55], a[124:127], v[180:183], v[52:55]
    ds_read_b128 a[100:103], v233 offset:44032
    v_lshl_add_u32 v244, v246, 8, v244
    v_mfma_f32_16x16x32_bf16 v[20:23], a[128:131], v[176:179], v[20:23]
    s_add_u32 s8, s8, 73728
    s_addc_u32 s9, s9, 0
    ds_read_b128 a[104:107], v233 offset:45056
    v_mfma_f32_16x16x32_bf16 v[56:59], a[128:131], v[180:183], v[56:59]
    v_exp_f32 v160, v160
    v_mfma_f32_16x16x32_bf16 v[24:27], a[132:135], v[176:179], v[24:27]
    v_exp_f32 v161, v161
    v_mfma_f32_16x16x32_bf16 v[60:63], a[132:135], v[180:183], v[60:63]
    s_sub_u32 s10, s10, 73728
    v_exp_f32 v168, v168
    v_mfma_f32_16x16x32_bf16 v[28:31], a[136:139], v[176:179], v[28:31]
    s_max_i32 s10, s10, 0
    v_exp_f32 v169, v169
    v_mfma_f32_16x16x32_bf16 v[64:67], a[136:139], v[180:183], v[64:67]
    s_add_u32 m0, s64, 73728
    v_cvt_pk_bf16_f32 v184, v160, v161
    v_exp_f32 v162, v162
    v_mfma_f32_16x16x32_bf16 v[32:35], a[140:143], v[176:179], v[32:35]
    v_exp_f32 v163, v163
    v_mfma_f32_16x16x32_bf16 v[68:71], a[140:143], v[180:183], v[68:71]
    s_waitcnt lgkmcnt(0)
    v_add_u32 v246, v244, v245
    v_mfma_f32_32x32x16_bf16 v[144:159], a[72:75], a[0:3], 0
    v_cvt_pk_bf16_f32 v188, v168, v169
    v_exp_f32 v170, v170
    v_exp_f32 v171, v171
    v_mfma_f32_32x32x16_bf16 v[144:159], a[76:79], a[4:7], v[144:159]
    v_cvt_pk_bf16_f32 v185, v162, v163
    v_permlane16_swap_b32 v184, v188
    v_exp_f32 v164, v164
    v_mfma_f32_32x32x16_bf16 v[144:159], a[80:83], a[8:11], v[144:159]
    buffer_load_dwordx4 v239, s[8:11], s18 offen offset:0 sc1 lds
    v_exp_f32 v165, v165
    v_exp_f32 v243, v243
    v_mfma_f32_32x32x16_bf16 v[144:159], a[84:87], a[12:15], v[144:159]
    v_cvt_pk_bf16_f32 v189, v170, v171
    v_exp_f32 v172, v172
    v_exp_f32 v173, v173
    v_cvt_pk_bf16_f32 v186, v164, v165
    v_mfma_f32_32x32x16_bf16 v[144:159], a[88:91], a[16:19], v[144:159]
    buffer_load_dwordx4 v239, s[8:11], s19 offen offset:1024 sc1 lds
    v_permlane16_swap_b32 v185, v189
    v_exp_f32 v166, v166
    v_mfma_f32_32x32x16_bf16 v[144:159], a[92:95], a[20:23], v[144:159]
    v_exp_f32 v167, v167
    v_cvt_pk_bf16_f32 v190, v172, v173
    v_exp_f32 v174, v174
    v_mfma_f32_32x32x16_bf16 v[144:159], a[96:99], a[24:27], v[144:159]
    v_exp_f32 v175, v175
    v_cvt_pk_bf16_f32 v187, v166, v167
    v_permlane16_swap_b32 v186, v190
    v_cvt_pk_bf16_f32 v191, v174, v175
    v_mfma_f32_32x32x16_bf16 v[144:159], a[100:103], a[28:31], v[144:159]
    buffer_load_dwordx4 v239, s[8:11], s20 offen offset:2048 sc1 lds
    v_permlane16_swap_b32 v187, v191
    v_add_f32 v240, 1.0, v240
    v_add_f32 v241, 1.0, v241
    v_mfma_f32_32x32x16_bf16 v[144:159], a[104:107], a[32:35], v[144:159]
    buffer_load_dwordx4 v239, s[8:11], s21 offen offset:3072 sc1 lds
    v_add_f32 v242, 1.0, v242
    v_add_f32 v243, 1.0, v243
    v_rcp_f32 v240, v240
    v_mfma_f32_16x16x32_bf16 v[72:75], a[108:111], v[184:187], v[72:75]
    v_mfma_f32_16x16x32_bf16 v[108:111], a[108:111], v[188:191], v[108:111]
    ds_read_b64_tr_b16 a[108:109], v235 offset:36864
    v_mfma_f32_16x16x32_bf16 v[76:79], a[112:115], v[184:187], v[76:79]
    ds_read_b64_tr_b16 a[110:111], v237 offset:36864
    v_mfma_f32_16x16x32_bf16 v[112:115], a[112:115], v[188:191], v[112:115]
    s_add_u32 m0, s64, 77824
    ds_read_b64_tr_b16 a[112:113], v235 offset:37888
    v_mfma_f32_16x16x32_bf16 v[80:83], a[116:119], v[184:187], v[80:83]
    buffer_load_dwordx4 v239, s[8:11], s22 offen offset:0 sc1 lds
    v_mfma_f32_16x16x32_bf16 v[116:119], a[116:119], v[188:191], v[116:119]
    v_exp_f32 v144, v144
    v_mfma_f32_16x16x32_bf16 v[84:87], a[120:123], v[184:187], v[84:87]
    v_exp_f32 v145, v145
    v_mfma_f32_16x16x32_bf16 v[120:123], a[120:123], v[188:191], v[120:123]
    v_exp_f32 v152, v152
    v_mfma_f32_16x16x32_bf16 v[88:91], a[124:127], v[184:187], v[88:91]
    v_exp_f32 v153, v153
    v_mfma_f32_16x16x32_bf16 v[124:127], a[124:127], v[188:191], v[124:127]
    ds_read_b64_tr_b16 a[114:115], v237 offset:37888
    v_cvt_pk_bf16_f32 v176, v144, v145
    v_mfma_f32_16x16x32_bf16 v[92:95], a[128:131], v[184:187], v[92:95]
    v_exp_f32 v146, v146
    v_mfma_f32_16x16x32_bf16 v[128:131], a[128:131], v[188:191], v[128:131]
    v_exp_f32 v147, v147
    v_mfma_f32_16x16x32_bf16 v[96:99], a[132:135], v[184:187], v[96:99]
    buffer_store_dwordx4 v[250:253], v239, s[52:55], s62 offen offset:1024 sc1
    v_mfma_f32_16x16x32_bf16 v[132:135], a[132:135], v[188:191], v[132:135]
    v_cvt_pk_bf16_f32 v180, v152, v153
    v_exp_f32 v154, v154
    v_mfma_f32_16x16x32_bf16 v[100:103], a[136:139], v[184:187], v[100:103]
    v_exp_f32 v155, v155
    v_mfma_f32_16x16x32_bf16 v[136:139], a[136:139], v[188:191], v[136:139]
    ds_read_b64_tr_b16 a[116:117], v235 offset:38912
    v_cvt_pk_bf16_f32 v177, v146, v147
    v_mfma_f32_16x16x32_bf16 v[104:107], a[140:143], v[184:187], v[104:107]
    v_permlane16_swap_b32 v176, v180
    v_mfma_f32_16x16x32_bf16 v[140:143], a[140:143], v[188:191], v[140:143]
    v_exp_f32 v148, v148
    v_mfma_f32_32x32x16_bf16 v[160:175], a[72:75], a[36:39], 0
    buffer_load_dwordx4 v239, s[8:11], s23 offen offset:1024 sc1 lds
    ds_read_b64_tr_b16 a[118:119], v237 offset:38912
    v_exp_f32 v149, v149
    v_cvt_pk_bf16_f32 v181, v154, v155
    v_mfma_f32_32x32x16_bf16 v[160:175], a[76:79], a[40:43], v[160:175]
    ds_read_b64_tr_b16 a[120:121], v235 offset:39936
    ds_read_b64_tr_b16 a[122:123], v237 offset:39936
    v_exp_f32 v156, v156
    v_exp_f32 v157, v157
    v_mfma_f32_32x32x16_bf16 v[160:175], a[80:83], a[44:47], v[160:175]
    buffer_load_dwordx4 v239, s[8:11], s24 offen offset:2048 sc1 lds
    ds_read_b64_tr_b16 a[124:125], v235 offset:40960
    v_cvt_pk_bf16_f32 v178, v148, v149
    v_permlane16_swap_b32 v177, v181
    v_mfma_f32_32x32x16_bf16 v[160:175], a[84:87], a[48:51], v[160:175]
    ds_read_b64_tr_b16 a[126:127], v237 offset:40960
    ds_read_b64_tr_b16 a[128:129], v235 offset:41984
    v_exp_f32 v150, v150
    v_exp_f32 v151, v151
    v_mfma_f32_32x32x16_bf16 v[160:175], a[88:91], a[52:55], v[160:175]
    ds_read_b64_tr_b16 a[130:131], v237 offset:41984
    ds_read_b64_tr_b16 a[132:133], v235 offset:43008
    ds_read_b64_tr_b16 a[134:135], v237 offset:43008
    v_cvt_pk_bf16_f32 v182, v156, v157
    v_exp_f32 v158, v158
    v_mfma_f32_32x32x16_bf16 v[160:175], a[92:95], a[56:59], v[160:175]
    buffer_load_dwordx4 v239, s[8:11], s25 offen offset:3072 sc1 lds
    ds_read_b64_tr_b16 a[136:137], v235 offset:44032
    v_exp_f32 v159, v159
    v_cvt_pk_bf16_f32 v179, v150, v151
    v_mfma_f32_32x32x16_bf16 v[160:175], a[96:99], a[60:63], v[160:175]
    s_add_u32 m0, s64, 81920
    ds_read_b64_tr_b16 a[138:139], v237 offset:44032
    ds_read_b64_tr_b16 a[140:141], v235 offset:45056
    ds_read_b64_tr_b16 a[142:143], v237 offset:45056
    v_permlane16_swap_b32 v178, v182
    v_cvt_pk_bf16_f32 v183, v158, v159
    v_mfma_f32_32x32x16_bf16 v[160:175], a[100:103], a[64:67], v[160:175]
    buffer_load_dwordx4 v239, s[8:11], s26 offen offset:0 sc1 lds
    v_permlane16_swap_b32 v179, v183
    v_rcp_f32 v241, v241
    v_mfma_f32_32x32x16_bf16 v[160:175], a[104:107], a[68:71], v[160:175]
    s_waitcnt vmcnt(20) lgkmcnt(0)
    v_rcp_f32 v242, v242
    v_rcp_f32 v243, v243
    v_mul_f32 v204, v204, v240
    v_mul_f32 v205, v205, v241
    v_mfma_f32_16x16x32_bf16 v[0:3], a[108:111], v[176:179], v[0:3]
    ds_read_b128 a[72:75], v232 offset:0
    v_mul_f32 v206, v206, v242
    v_mfma_f32_16x16x32_bf16 v[36:39], a[108:111], v[180:183], v[36:39]
    ds_read_b128 a[76:79], v232 offset:1024
    v_mul_f32 v207, v207, v243
    v_mfma_f32_16x16x32_bf16 v[4:7], a[112:115], v[176:179], v[4:7]
    ds_read_b128 a[80:83], v232 offset:2048
    v_cvt_pk_bf16_f32 v192, v192, v193
    v_mfma_f32_16x16x32_bf16 v[40:43], a[112:115], v[180:183], v[40:43]
    ds_read_b128 a[84:87], v232 offset:3072
    v_cvt_pk_bf16_f32 v193, v194, v195
    v_mfma_f32_16x16x32_bf16 v[8:11], a[116:119], v[176:179], v[8:11]
    ds_read_b128 a[88:91], v232 offset:4096
    v_cvt_pk_bf16_f32 v196, v196, v197
    v_mfma_f32_16x16x32_bf16 v[44:47], a[116:119], v[180:183], v[44:47]
    ds_read_b128 a[92:95], v232 offset:5120
    v_cvt_pk_bf16_f32 v197, v198, v199
    v_mfma_f32_16x16x32_bf16 v[12:15], a[120:123], v[176:179], v[12:15]
    ds_read_b128 a[96:99], v232 offset:6144
    v_cvt_pk_bf16_f32 v194, v200, v201
    v_mfma_f32_16x16x32_bf16 v[48:51], a[120:123], v[180:183], v[48:51]
    ds_read_b128 a[100:103], v232 offset:7168
    v_cvt_pk_bf16_f32 v195, v202, v203
    v_mfma_f32_16x16x32_bf16 v[16:19], a[124:127], v[176:179], v[16:19]
    ds_read_b128 a[104:107], v232 offset:8192
    v_cvt_pk_bf16_f32 v198, v204, v205
    v_mfma_f32_16x16x32_bf16 v[52:55], a[124:127], v[180:183], v[52:55]
    v_exp_f32 v160, v160
    v_mfma_f32_16x16x32_bf16 v[20:23], a[128:131], v[176:179], v[20:23]
    v_exp_f32 v161, v161
    v_mfma_f32_16x16x32_bf16 v[56:59], a[128:131], v[180:183], v[56:59]
L_padm2:
    s_cbranch_execz L_walked0
    v_exp_f32 v168, v168
    v_mfma_f32_16x16x32_bf16 v[24:27], a[132:135], v[176:179], v[24:27]
    s_add_u32 s8, s8, 73728
    s_addc_u32 s9, s9, 0
    v_cvt_pk_bf16_f32 v199, v206, v207
    v_mfma_f32_16x16x32_bf16 v[60:63], a[132:135], v[180:183], v[60:63]
    s_sub_u32 s10, s10, 73728
    v_exp_f32 v169, v169
    v_mfma_f32_16x16x32_bf16 v[28:31], a[136:139], v[176:179], v[28:31]
    s_max_i32 s10, s10, 0
    v_cvt_pk_bf16_f32 v184, v160, v161
    v_mfma_f32_16x16x32_bf16 v[64:67], a[136:139], v[180:183], v[64:67]
    s_add_u32 m0, s64, 110592
    v_exp_f32 v162, v162
    v_mfma_f32_16x16x32_bf16 v[32:35], a[140:143], v[176:179], v[32:35]
    v_exp_f32 v163, v163
    v_mfma_f32_16x16x32_bf16 v[68:71], a[140:143], v[180:183], v[68:71]
    s_waitcnt lgkmcnt(0)
    v_mul_f32 v240, v208, v208
    v_mfma_f32_32x32x16_bf16 v[144:159], a[72:75], a[0:3], 0
    v_cvt_pk_bf16_f32 v188, v168, v169
    v_exp_f32 v170, v170
    v_exp_f32 v171, v171
    v_cvt_pk_bf16_f32 v185, v162, v163
    v_mfma_f32_32x32x16_bf16 v[144:159], a[76:79], a[4:7], v[144:159]
    buffer_load_dwordx4 v239, s[8:11], s18 offen offset:0 sc1 lds
    v_permlane16_swap_b32 v184, v188
    v_exp_f32 v164, v164
    v_mfma_f32_32x32x16_bf16 v[144:159], a[80:83], a[8:11], v[144:159]
    v_exp_f32 v165, v165
    v_cvt_pk_bf16_f32 v189, v170, v171
    v_exp_f32 v172, v172
    v_mfma_f32_32x32x16_bf16 v[144:159], a[84:87], a[12:15], v[144:159]
    v_exp_f32 v173, v173
    v_cvt_pk_bf16_f32 v186, v164, v165
    v_permlane16_swap_b32 v185, v189
    v_mul_f32 v241, v209, v209
    v_mfma_f32_32x32x16_bf16 v[144:159], a[88:91], a[16:19], v[144:159]
    v_exp_f32 v166, v166
    v_exp_f32 v167, v167
    v_cvt_pk_bf16_f32 v190, v172, v173
    v_mul_f32 v242, v210, v210
    v_mfma_f32_32x32x16_bf16 v[144:159], a[92:95], a[20:23], v[144:159]
    buffer_store_dwordx4 v[192:195], v246, s[44:47], s14 offen offset:0 sc1
    v_exp_f32 v174, v174
    v_exp_f32 v175, v175
    v_mfma_f32_32x32x16_bf16 v[144:159], a[96:99], a[24:27], v[144:159]
    v_cvt_pk_bf16_f32 v187, v166, v167
    v_permlane16_swap_b32 v186, v190
    v_cvt_pk_bf16_f32 v191, v174, v175
    v_mul_f32 v243, v211, v211
    v_fma_f32 v240, v240, s60, v248
    v_mfma_f32_32x32x16_bf16 v[144:159], a[100:103], a[28:31], v[144:159]
    buffer_load_dwordx4 v239, s[8:11], s19 offen offset:1024 sc1 lds
    v_permlane16_swap_b32 v187, v191
    v_fma_f32 v241, v241, s60, v248
    v_fma_f32 v242, v242, s60, v248
    v_mfma_f32_32x32x16_bf16 v[144:159], a[104:107], a[32:35], v[144:159]
    buffer_load_dwordx4 v239, s[8:11], s20 offen offset:2048 sc1 lds
    v_fma_f32 v243, v243, s60, v248
    v_mul_f32 v240, v240, v208
    v_mul_f32 v241, v241, v209
    v_mul_f32 v242, v242, v210
    v_mfma_f32_16x16x32_bf16 v[72:75], a[108:111], v[184:187], v[72:75]
    v_mul_f32 v243, v243, v211
    v_mfma_f32_16x16x32_bf16 v[108:111], a[108:111], v[188:191], v[108:111]
    ds_read_b64_tr_b16 a[108:109], v234 offset:0
    v_mfma_f32_16x16x32_bf16 v[76:79], a[112:115], v[184:187], v[76:79]
    ds_read_b64_tr_b16 a[110:111], v236 offset:0
    v_mfma_f32_16x16x32_bf16 v[112:115], a[112:115], v[188:191], v[112:115]
    ds_read_b64_tr_b16 a[112:113], v234 offset:1024
    v_mfma_f32_16x16x32_bf16 v[80:83], a[116:119], v[184:187], v[80:83]
    buffer_load_dwordx4 v239, s[8:11], s21 offen offset:3072 sc1 lds
    v_mfma_f32_16x16x32_bf16 v[116:119], a[116:119], v[188:191], v[116:119]
    v_exp_f32 v144, v144
    v_mfma_f32_16x16x32_bf16 v[84:87], a[120:123], v[184:187], v[84:87]
    v_exp_f32 v145, v145
    v_mfma_f32_16x16x32_bf16 v[120:123], a[120:123], v[188:191], v[120:123]
    v_exp_f32 v152, v152
    v_mfma_f32_16x16x32_bf16 v[88:91], a[124:127], v[184:187], v[88:91]
    v_exp_f32 v153, v153
    v_mfma_f32_16x16x32_bf16 v[124:127], a[124:127], v[188:191], v[124:127]
    ds_read_b64_tr_b16 a[114:115], v236 offset:1024
    v_cvt_pk_bf16_f32 v176, v144, v145
    v_mfma_f32_16x16x32_bf16 v[92:95], a[128:131], v[184:187], v[92:95]
    v_exp_f32 v146, v146
    v_mfma_f32_16x16x32_bf16 v[128:131], a[128:131], v[188:191], v[128:131]
    v_exp_f32 v147, v147
    v_mfma_f32_16x16x32_bf16 v[96:99], a[132:135], v[184:187], v[96:99]
    buffer_store_dwordx4 v[196:199], v246, s[44:47], s14 offen offset:512 sc1
    v_mfma_f32_16x16x32_bf16 v[132:135], a[132:135], v[188:191], v[132:135]
    v_cvt_pk_bf16_f32 v180, v152, v153
    v_exp_f32 v154, v154
    v_mfma_f32_16x16x32_bf16 v[100:103], a[136:139], v[184:187], v[100:103]
    v_exp_f32 v155, v155
    v_mfma_f32_16x16x32_bf16 v[136:139], a[136:139], v[188:191], v[136:139]
    ds_read_b64_tr_b16 a[116:117], v234 offset:2048
    v_cvt_pk_bf16_f32 v177, v146, v147
    v_mfma_f32_16x16x32_bf16 v[104:107], a[140:143], v[184:187], v[104:107]
    v_permlane16_swap_b32 v176, v180
    v_mfma_f32_16x16x32_bf16 v[140:143], a[140:143], v[188:191], v[140:143]
    s_add_u32 m0, s64, 114688
    v_exp_f32 v148, v148
    v_mfma_f32_32x32x16_bf16 v[160:175], a[72:75], a[36:39], 0
    buffer_load_dwordx4 v239, s[8:11], s22 offen offset:0 sc1 lds
    ds_read_b64_tr_b16 a[118:119], v236 offset:2048
    v_exp_f32 v149, v149
    v_cvt_pk_bf16_f32 v181, v154, v155
    v_mfma_f32_32x32x16_bf16 v[160:175], a[76:79], a[40:43], v[160:175]
    ds_read_b64_tr_b16 a[120:121], v234 offset:3072
    ds_read_b64_tr_b16 a[122:123], v236 offset:3072
    v_exp_f32 v156, v156
    v_exp_f32 v157, v157
    v_mfma_f32_32x32x16_bf16 v[160:175], a[80:83], a[44:47], v[160:175]
    buffer_load_dwordx4 v239, s[8:11], s23 offen offset:1024 sc1 lds
    ds_read_b64_tr_b16 a[124:125], v234 offset:4096
    v_cvt_pk_bf16_f32 v178, v148, v149
    v_permlane16_swap_b32 v177, v181
    v_mfma_f32_32x32x16_bf16 v[160:175], a[84:87], a[48:51], v[160:175]
    ds_read_b64_tr_b16 a[126:127], v236 offset:4096
    ds_read_b64_tr_b16 a[128:129], v234 offset:5120
    v_exp_f32 v150, v150
    v_exp_f32 v151, v151
    v_mfma_f32_32x32x16_bf16 v[160:175], a[88:91], a[52:55], v[160:175]
    ds_read_b64_tr_b16 a[130:131], v236 offset:5120
    ds_read_b64_tr_b16 a[132:133], v234 offset:6144
    ds_read_b64_tr_b16 a[134:135], v236 offset:6144
    v_cvt_pk_bf16_f32 v182, v156, v157
    v_exp_f32 v158, v158
    v_mfma_f32_32x32x16_bf16 v[160:175], a[92:95], a[56:59], v[160:175]
    buffer_load_dwordx4 v239, s[8:11], s24 offen offset:2048 sc1 lds
    ds_read_b64_tr_b16 a[136:137], v234 offset:7168
    v_exp_f32 v159, v159
    v_cvt_pk_bf16_f32 v179, v150, v151
    v_mfma_f32_32x32x16_bf16 v[160:175], a[96:99], a[60:63], v[160:175]
    ds_read_b64_tr_b16 a[138:139], v236 offset:7168
    ds_read_b64_tr_b16 a[140:141], v234 offset:8192
    ds_read_b64_tr_b16 a[142:143], v236 offset:8192
    v_permlane16_swap_b32 v178, v182
    v_cvt_pk_bf16_f32 v183, v158, v159
    v_mfma_f32_32x32x16_bf16 v[160:175], a[100:103], a[64:67], v[160:175]
    buffer_load_dwordx4 v239, s[8:11], s25 offen offset:3072 sc1 lds
    v_permlane16_swap_b32 v179, v183
    v_exp_f32 v240, v240
    v_mfma_f32_32x32x16_bf16 v[160:175], a[104:107], a[68:71], v[160:175]
    s_waitcnt vmcnt(20) lgkmcnt(0)
    v_exp_f32 v241, v241
    v_exp_f32 v242, v242
    v_exp_f32 v243, v243
    v_mfma_f32_16x16x32_bf16 v[0:3], a[108:111], v[176:179], v[0:3]
    ds_read_b128 a[72:75], v232 offset:36864
    v_mfma_f32_16x16x32_bf16 v[36:39], a[108:111], v[180:183], v[36:39]
    ds_read_b128 a[76:79], v232 offset:37888
    v_mfma_f32_16x16x32_bf16 v[4:7], a[112:115], v[176:179], v[4:7]
    ds_read_b128 a[80:83], v232 offset:38912
    v_mfma_f32_16x16x32_bf16 v[40:43], a[112:115], v[180:183], v[40:43]
    buffer_store_dwordx4 v[250:253], v239, s[52:55], s61 offen sc1
    v_mfma_f32_16x16x32_bf16 v[8:11], a[116:119], v[176:179], v[8:11]
    ds_read_b128 a[84:87], v232 offset:39936
    v_add_f32 v240, 1.0, v240
    v_mfma_f32_16x16x32_bf16 v[44:47], a[116:119], v[180:183], v[44:47]
    ds_read_b128 a[88:91], v232 offset:40960
    v_add_f32 v241, 1.0, v241
    v_mfma_f32_16x16x32_bf16 v[12:15], a[120:123], v[176:179], v[12:15]
    ds_read_b128 a[92:95], v232 offset:41984
    v_add_f32 v242, 1.0, v242
    v_mfma_f32_16x16x32_bf16 v[48:51], a[120:123], v[180:183], v[48:51]
    s_add_u32 m0, s64, 118784
    ds_read_b128 a[96:99], v232 offset:43008
    v_add_f32 v243, 1.0, v243
    v_mfma_f32_16x16x32_bf16 v[16:19], a[124:127], v[176:179], v[16:19]
    buffer_load_dwordx4 v239, s[8:11], s26 offen offset:0 sc1 lds
    v_mfma_f32_16x16x32_bf16 v[52:55], a[124:127], v[180:183], v[52:55]
    v_exp_f32 v160, v160
    v_mfma_f32_16x16x32_bf16 v[20:23], a[128:131], v[176:179], v[20:23]
    v_exp_f32 v161, v161
    v_mfma_f32_16x16x32_bf16 v[56:59], a[128:131], v[180:183], v[56:59]
    ds_read_b128 a[100:103], v232 offset:44032
    v_exp_f32 v168, v168
    v_mfma_f32_16x16x32_bf16 v[24:27], a[132:135], v[176:179], v[24:27]
    s_add_u32 s8, s8, 73728
    s_addc_u32 s9, s9, 0
    ds_read_b128 a[104:107], v232 offset:45056
    v_mfma_f32_16x16x32_bf16 v[60:63], a[132:135], v[180:183], v[60:63]
    s_sub_u32 s10, s10, 73728
    v_exp_f32 v169, v169
    v_mfma_f32_16x16x32_bf16 v[28:31], a[136:139], v[176:179], v[28:31]
    s_max_i32 s10, s10, 0
    v_rcp_f32 v240, v240
    v_mfma_f32_16x16x32_bf16 v[64:67], a[136:139], v[180:183], v[64:67]
    s_add_u32 m0, s64, 0
    v_cvt_pk_bf16_f32 v184, v160, v161
    v_exp_f32 v162, v162
    v_mfma_f32_16x16x32_bf16 v[32:35], a[140:143], v[176:179], v[32:35]
    v_exp_f32 v163, v163
    v_mfma_f32_16x16x32_bf16 v[68:71], a[140:143], v[180:183], v[68:71]
    s_waitcnt lgkmcnt(0)
    v_rcp_f32 v241, v241
    v_mfma_f32_32x32x16_bf16 v[144:159], a[72:75], a[0:3], 0
    v_cvt_pk_bf16_f32 v188, v168, v169
    v_exp_f32 v170, v170
    v_exp_f32 v171, v171
    v_cvt_pk_bf16_f32 v185, v162, v163
    v_mfma_f32_32x32x16_bf16 v[144:159], a[76:79], a[4:7], v[144:159]
    v_permlane16_swap_b32 v184, v188
    v_exp_f32 v164, v164
    v_exp_f32 v165, v165
    v_mfma_f32_32x32x16_bf16 v[144:159], a[80:83], a[8:11], v[144:159]
    buffer_load_dwordx4 v239, s[8:11], s18 offen offset:0 sc1 lds
    v_cvt_pk_bf16_f32 v189, v170, v171
    v_exp_f32 v172, v172
    v_rcp_f32 v242, v242
    v_mfma_f32_32x32x16_bf16 v[144:159], a[84:87], a[12:15], v[144:159]
    v_exp_f32 v173, v173
    v_cvt_pk_bf16_f32 v186, v164, v165
    v_permlane16_swap_b32 v185, v189
    v_rcp_f32 v243, v243
    v_mfma_f32_32x32x16_bf16 v[144:159], a[88:91], a[16:19], v[144:159]
    v_exp_f32 v166, v166
    v_exp_f32 v167, v167
    v_cvt_pk_bf16_f32 v190, v172, v173
    v_mul_f32 v208, v208, v240
    v_mfma_f32_32x32x16_bf16 v[144:159], a[92:95], a[20:23], v[144:159]
    buffer_load_dwordx4 v239, s[8:11], s19 offen offset:1024 sc1 lds
    v_exp_f32 v174, v174
    v_exp_f32 v175, v175
    v_mfma_f32_32x32x16_bf16 v[144:159], a[96:99], a[24:27], v[144:159]
    v_cvt_pk_bf16_f32 v187, v166, v167
    v_permlane16_swap_b32 v186, v190
    v_cvt_pk_bf16_f32 v191, v174, v175
    v_mul_f32 v209, v209, v241
    v_mul_f32 v210, v210, v242
    v_mfma_f32_32x32x16_bf16 v[144:159], a[100:103], a[28:31], v[144:159]
    buffer_load_dwordx4 v239, s[8:11], s20 offen offset:2048 sc1 lds
    v_permlane16_swap_b32 v187, v191
    v_mul_f32 v211, v211, v243
    v_mul_f32 v240, v212, v212
    v_mfma_f32_32x32x16_bf16 v[144:159], a[104:107], a[32:35], v[144:159]
    buffer_load_dwordx4 v239, s[8:11], s21 offen offset:3072 sc1 lds
    s_add_u32 m0, s64, 4096
    v_mul_f32 v241, v213, v213
    v_mul_f32 v242, v214, v214
    v_mul_f32 v243, v215, v215
    v_mfma_f32_16x16x32_bf16 v[72:75], a[108:111], v[184:187], v[72:75]
    v_fma_f32 v240, v240, s60, v248
    v_mfma_f32_16x16x32_bf16 v[108:111], a[108:111], v[188:191], v[108:111]
    ds_read_b64_tr_b16 a[108:109], v234 offset:36864
    v_fma_f32 v241, v241, s60, v248
    v_mfma_f32_16x16x32_bf16 v[76:79], a[112:115], v[184:187], v[76:79]
    ds_read_b64_tr_b16 a[110:111], v236 offset:36864
    v_fma_f32 v242, v242, s60, v248
    v_mfma_f32_16x16x32_bf16 v[112:115], a[112:115], v[188:191], v[112:115]
    ds_read_b64_tr_b16 a[112:113], v234 offset:37888
    v_fma_f32 v243, v243, s60, v248
    v_mfma_f32_16x16x32_bf16 v[80:83], a[116:119], v[184:187], v[80:83]
    ds_read_b64_tr_b16 a[114:115], v236 offset:37888
    v_mul_f32 v240, v240, v212
    v_mfma_f32_16x16x32_bf16 v[116:119], a[116:119], v[188:191], v[116:119]
    v_exp_f32 v144, v144
    v_mfma_f32_16x16x32_bf16 v[84:87], a[120:123], v[184:187], v[84:87]
    v_exp_f32 v145, v145
    v_mfma_f32_16x16x32_bf16 v[120:123], a[120:123], v[188:191], v[120:123]
    v_exp_f32 v152, v152
    v_mfma_f32_16x16x32_bf16 v[88:91], a[124:127], v[184:187], v[88:91]
    v_exp_f32 v153, v153
    v_mfma_f32_16x16x32_bf16 v[124:127], a[124:127], v[188:191], v[124:127]
    buffer_load_dwordx4 v239, s[8:11], s22 offen offset:0 sc1 lds
    v_mfma_f32_16x16x32_bf16 v[92:95], a[128:131], v[184:187], v[92:95]
    ds_read_b64_tr_b16 a[116:117], v234 offset:38912
    v_cvt_pk_bf16_f32 v176, v144, v145
    v_mfma_f32_16x16x32_bf16 v[128:131], a[128:131], v[188:191], v[128:131]
    v_exp_f32 v146, v146
    v_mfma_f32_16x16x32_bf16 v[96:99], a[132:135], v[184:187], v[96:99]
    v_exp_f32 v147, v147
    v_mfma_f32_16x16x32_bf16 v[132:135], a[132:135], v[188:191], v[132:135]
    v_cvt_pk_bf16_f32 v180, v152, v153
    v_mul_f32 v241, v241, v213
    v_mfma_f32_16x16x32_bf16 v[100:103], a[136:139], v[184:187], v[100:103]
    v_exp_f32 v154, v154
    v_mfma_f32_16x16x32_bf16 v[136:139], a[136:139], v[188:191], v[136:139]
    buffer_load_dwordx4 v239, s[8:11], s23 offen offset:1024 sc1 lds
    v_mfma_f32_16x16x32_bf16 v[104:107], a[140:143], v[184:187], v[104:107]
    v_exp_f32 v155, v155
    v_mfma_f32_16x16x32_bf16 v[140:143], a[140:143], v[188:191], v[140:143]
    v_cvt_pk_bf16_f32 v177, v146, v147
    v_permlane16_swap_b32 v176, v180
    v_mfma_f32_32x32x16_bf16 v[160:175], a[72:75], a[36:39], 0
    buffer_load_dwordx4 v239, s[8:11], s24 offen offset:2048 sc1 lds
    v_exp_f32 v148, v148
    v_exp_f32 v149, v149
    v_mfma_f32_32x32x16_bf16 v[160:175], a[76:79], a[40:43], v[160:175]
    ds_read_b64_tr_b16 a[118:119], v236 offset:38912
    v_cvt_pk_bf16_f32 v181, v154, v155
    v_exp_f32 v156, v156
    v_exp_f32 v157, v157
    v_mfma_f32_32x32x16_bf16 v[160:175], a[80:83], a[44:47], v[160:175]
    ds_read_b64_tr_b16 a[120:121], v234 offset:39936
    ds_read_b64_tr_b16 a[122:123], v236 offset:39936
    ds_read_b64_tr_b16 a[124:125], v234 offset:40960
    v_cvt_pk_bf16_f32 v178, v148, v149
    v_permlane16_swap_b32 v177, v181
    v_mfma_f32_32x32x16_bf16 v[160:175], a[84:87], a[48:51], v[160:175]
    ds_read_b64_tr_b16 a[126:127], v236 offset:40960
    ds_read_b64_tr_b16 a[128:129], v234 offset:41984
    v_exp_f32 v150, v150
    v_exp_f32 v151, v151
    v_mfma_f32_32x32x16_bf16 v[160:175], a[88:91], a[52:55], v[160:175]
    buffer_load_dwordx4 v239, s[8:11], s25 offen offset:3072 sc1 lds
    ds_read_b64_tr_b16 a[130:131], v236 offset:41984
    v_cvt_pk_bf16_f32 v182, v156, v157
    v_exp_f32 v158, v158
    v_mfma_f32_32x32x16_bf16 v[160:175], a[92:95], a[56:59], v[160:175]
    ds_read_b64_tr_b16 a[132:133], v234 offset:43008
    ds_read_b64_tr_b16 a[134:135], v236 offset:43008
    ds_read_b64_tr_b16 a[136:137], v234 offset:44032
    v_exp_f32 v159, v159
    v_cvt_pk_bf16_f32 v179, v150, v151
    v_mfma_f32_32x32x16_bf16 v[160:175], a[96:99], a[60:63], v[160:175]
    s_add_u32 m0, s64, 8192
    ds_read_b64_tr_b16 a[138:139], v236 offset:44032
    ds_read_b64_tr_b16 a[140:141], v234 offset:45056
    ds_read_b64_tr_b16 a[142:143], v236 offset:45056
    v_permlane16_swap_b32 v178, v182
    v_cvt_pk_bf16_f32 v183, v158, v159
    v_mfma_f32_32x32x16_bf16 v[160:175], a[100:103], a[64:67], v[160:175]
    buffer_load_dwordx4 v239, s[8:11], s26 offen offset:0 sc1 lds
    v_permlane16_swap_b32 v179, v183
    v_mul_f32 v242, v242, v214
    v_mul_f32 v243, v243, v215
    v_mfma_f32_32x32x16_bf16 v[160:175], a[104:107], a[68:71], v[160:175]
    s_waitcnt vmcnt(21) lgkmcnt(0)
    v_exp_f32 v240, v240
    v_exp_f32 v241, v241
    v_exp_f32 v242, v242
    v_mfma_f32_16x16x32_bf16 v[0:3], a[108:111], v[176:179], v[0:3]
    ds_read_b128 a[72:75], v233 offset:0
    v_mfma_f32_16x16x32_bf16 v[36:39], a[108:111], v[180:183], v[36:39]
    ds_read_b128 a[76:79], v233 offset:1024
    v_mfma_f32_16x16x32_bf16 v[4:7], a[112:115], v[176:179], v[4:7]
    ds_read_b128 a[80:83], v233 offset:2048
    v_mfma_f32_16x16x32_bf16 v[40:43], a[112:115], v[180:183], v[40:43]
    ds_read_b128 a[84:87], v233 offset:3072
    v_mfma_f32_16x16x32_bf16 v[8:11], a[116:119], v[176:179], v[8:11]
    ds_read_b128 a[88:91], v233 offset:4096
    v_mfma_f32_16x16x32_bf16 v[44:47], a[116:119], v[180:183], v[44:47]
    ds_read_b128 a[92:95], v233 offset:5120
    v_mfma_f32_16x16x32_bf16 v[12:15], a[120:123], v[176:179], v[12:15]
    ds_read_b128 a[96:99], v233 offset:6144
    v_mfma_f32_16x16x32_bf16 v[48:51], a[120:123], v[180:183], v[48:51]
    ds_read_b128 a[100:103], v233 offset:7168
    v_mfma_f32_16x16x32_bf16 v[16:19], a[124:127], v[176:179], v[16:19]
    v_exp_f32 v243, v243
    v_mfma_f32_16x16x32_bf16 v[52:55], a[124:127], v[180:183], v[52:55]
    v_exp_f32 v160, v160
    v_mfma_f32_16x16x32_bf16 v[20:23], a[128:131], v[176:179], v[20:23]
    s_add_u32 s8, s8, 73728
    s_addc_u32 s9, s9, 0
    v_mfma_f32_16x16x32_bf16 v[56:59], a[128:131], v[180:183], v[56:59]
    s_sub_u32 s10, s10, 73728
    v_exp_f32 v161, v161
    v_mfma_f32_16x16x32_bf16 v[24:27], a[132:135], v[176:179], v[24:27]
    s_max_i32 s10, s10, 0
    ds_read_b128 a[104:107], v233 offset:8192
    v_and_b32 v249, 24, v231
    v_mfma_f32_16x16x32_bf16 v[60:63], a[132:135], v[180:183], v[60:63]
    s_add_u32 m0, s64, 36864
    v_exp_f32 v168, v168
    v_mfma_f32_16x16x32_bf16 v[28:31], a[136:139], v[176:179], v[28:31]
    s_bfe_u32 s69, s2, 0x40003
    v_exp_f32 v169, v169
    v_mfma_f32_16x16x32_bf16 v[64:67], a[136:139], v[180:183], v[64:67]
    s_lshl_b32 s69, s69, 7
    v_cvt_pk_bf16_f32 v184, v160, v161
    v_exp_f32 v162, v162
    v_mfma_f32_16x16x32_bf16 v[32:35], a[140:143], v[176:179], v[32:35]
    s_add_u32 s70, s69, 4804608
    v_exp_f32 v163, v163
    v_mfma_f32_16x16x32_bf16 v[68:71], a[140:143], v[180:183], v[68:71]
    s_waitcnt lgkmcnt(0)
    v_lshlrev_b32 v249, 8, v249
    v_mfma_f32_32x32x16_bf16 v[144:159], a[72:75], a[0:3], 0
    v_cvt_pk_bf16_f32 v188, v168, v169
    v_exp_f32 v170, v170
    v_exp_f32 v171, v171
    v_mfma_f32_32x32x16_bf16 v[144:159], a[76:79], a[4:7], v[144:159]
    v_cvt_pk_bf16_f32 v185, v162, v163
    v_permlane16_swap_b32 v184, v188
    v_exp_f32 v164, v164
    v_add_f32 v240, 1.0, v240
    v_mfma_f32_32x32x16_bf16 v[144:159], a[80:83], a[8:11], v[144:159]
    buffer_load_dwordx4 v239, s[8:11], s18 offen offset:0 sc1 lds
    v_exp_f32 v165, v165
    v_cvt_pk_bf16_f32 v189, v170, v171
    v_add_f32 v241, 1.0, v241
    v_mfma_f32_32x32x16_bf16 v[144:159], a[84:87], a[12:15], v[144:159]
    v_exp_f32 v172, v172
    v_exp_f32 v173, v173
    v_cvt_pk_bf16_f32 v186, v164, v165
    v_add_f32 v242, 1.0, v242
    v_mfma_f32_32x32x16_bf16 v[144:159], a[88:91], a[16:19], v[144:159]
    buffer_load_dwordx4 v239, s[8:11], s19 offen offset:1024 sc1 lds
    v_permlane16_swap_b32 v185, v189
    v_exp_f32 v166, v166
    v_mfma_f32_32x32x16_bf16 v[144:159], a[92:95], a[20:23], v[144:159]
    v_exp_f32 v167, v167
    v_cvt_pk_bf16_f32 v190, v172, v173
    v_exp_f32 v174, v174
    v_add_f32 v243, 1.0, v243
    v_mfma_f32_32x32x16_bf16 v[144:159], a[96:99], a[24:27], v[144:159]
    v_exp_f32 v175, v175
    v_cvt_pk_bf16_f32 v187, v166, v167
    v_permlane16_swap_b32 v186, v190
    v_cvt_pk_bf16_f32 v191, v174, v175
    v_mfma_f32_32x32x16_bf16 v[144:159], a[100:103], a[28:31], v[144:159]
    buffer_load_dwordx4 v239, s[8:11], s20 offen offset:2048 sc1 lds
    v_permlane16_swap_b32 v187, v191
    v_rcp_f32 v240, v240
    v_mfma_f32_32x32x16_bf16 v[144:159], a[104:107], a[32:35], v[144:159]
    buffer_load_dwordx4 v239, s[8:11], s21 offen offset:3072 sc1 lds
    v_rcp_f32 v241, v241
    v_rcp_f32 v242, v242
    v_mfma_f32_16x16x32_bf16 v[72:75], a[108:111], v[184:187], v[72:75]
    v_mfma_f32_16x16x32_bf16 v[108:111], a[108:111], v[188:191], v[108:111]
    ds_read_b64_tr_b16 a[108:109], v235 offset:0
    v_mfma_f32_16x16x32_bf16 v[76:79], a[112:115], v[184:187], v[76:79]
    ds_read_b64_tr_b16 a[110:111], v237 offset:0
    v_mfma_f32_16x16x32_bf16 v[112:115], a[112:115], v[188:191], v[112:115]
    s_add_u32 m0, s64, 40960
    ds_read_b64_tr_b16 a[112:113], v235 offset:1024
    v_mfma_f32_16x16x32_bf16 v[80:83], a[116:119], v[184:187], v[80:83]
    buffer_load_dwordx4 v239, s[8:11], s22 offen offset:0 sc1 lds
    v_mfma_f32_16x16x32_bf16 v[116:119], a[116:119], v[188:191], v[116:119]
    v_exp_f32 v144, v144
    v_mfma_f32_16x16x32_bf16 v[84:87], a[120:123], v[184:187], v[84:87]
    v_exp_f32 v145, v145
    v_mfma_f32_16x16x32_bf16 v[120:123], a[120:123], v[188:191], v[120:123]
    v_exp_f32 v152, v152
    v_mfma_f32_16x16x32_bf16 v[88:91], a[124:127], v[184:187], v[88:91]
    v_exp_f32 v153, v153
    v_mfma_f32_16x16x32_bf16 v[124:127], a[124:127], v[188:191], v[124:127]
    ds_read_b64_tr_b16 a[114:115], v237 offset:1024
    v_cvt_pk_bf16_f32 v176, v144, v145
    v_mfma_f32_16x16x32_bf16 v[92:95], a[128:131], v[184:187], v[92:95]
    v_exp_f32 v146, v146
    v_mfma_f32_16x16x32_bf16 v[128:131], a[128:131], v[188:191], v[128:131]
    v_exp_f32 v147, v147
    v_mfma_f32_16x16x32_bf16 v[96:99], a[132:135], v[184:187], v[96:99]
    buffer_load_dwordx2 v[250:251], v249, s[52:55], s70 offen sc1
    v_mfma_f32_16x16x32_bf16 v[132:135], a[132:135], v[188:191], v[132:135]
    v_cvt_pk_bf16_f32 v180, v152, v153
    v_exp_f32 v154, v154
    v_mfma_f32_16x16x32_bf16 v[100:103], a[136:139], v[184:187], v[100:103]
    v_exp_f32 v155, v155
    v_mfma_f32_16x16x32_bf16 v[136:139], a[136:139], v[188:191], v[136:139]
    ds_read_b64_tr_b16 a[116:117], v235 offset:2048
    v_cvt_pk_bf16_f32 v177, v146, v147
    v_mfma_f32_16x16x32_bf16 v[104:107], a[140:143], v[184:187], v[104:107]
    v_permlane16_swap_b32 v176, v180
    v_mfma_f32_16x16x32_bf16 v[140:143], a[140:143], v[188:191], v[140:143]
    v_exp_f32 v148, v148
    v_mfma_f32_32x32x16_bf16 v[160:175], a[72:75], a[36:39], 0
    buffer_load_dwordx4 v239, s[8:11], s23 offen offset:1024 sc1 lds
    ds_read_b64_tr_b16 a[118:119], v237 offset:2048
    v_exp_f32 v149, v149
    v_cvt_pk_bf16_f32 v181, v154, v155
    v_mfma_f32_32x32x16_bf16 v[160:175], a[76:79], a[40:43], v[160:175]
    ds_read_b64_tr_b16 a[120:121], v235 offset:3072
    ds_read_b64_tr_b16 a[122:123], v237 offset:3072
    v_exp_f32 v156, v156
    v_exp_f32 v157, v157
    v_mfma_f32_32x32x16_bf16 v[160:175], a[80:83], a[44:47], v[160:175]
    buffer_load_dwordx4 v239, s[8:11], s24 offen offset:2048 sc1 lds
    ds_read_b64_tr_b16 a[124:125], v235 offset:4096
    v_cvt_pk_bf16_f32 v178, v148, v149
    v_permlane16_swap_b32 v177, v181
    v_mfma_f32_32x32x16_bf16 v[160:175], a[84:87], a[48:51], v[160:175]
    ds_read_b64_tr_b16 a[126:127], v237 offset:4096
    ds_read_b64_tr_b16 a[128:129], v235 offset:5120
    v_exp_f32 v150, v150
    v_exp_f32 v151, v151
    v_mfma_f32_32x32x16_bf16 v[160:175], a[88:91], a[52:55], v[160:175]
    ds_read_b64_tr_b16 a[130:131], v237 offset:5120
    ds_read_b64_tr_b16 a[132:133], v235 offset:6144
    ds_read_b64_tr_b16 a[134:135], v237 offset:6144
    v_cvt_pk_bf16_f32 v182, v156, v157
    v_exp_f32 v158, v158
    v_mfma_f32_32x32x16_bf16 v[160:175], a[92:95], a[56:59], v[160:175]
    buffer_load_dwordx4 v239, s[8:11], s25 offen offset:3072 sc1 lds
    ds_read_b64_tr_b16 a[136:137], v235 offset:7168
    v_exp_f32 v159, v159
    v_cvt_pk_bf16_f32 v179, v150, v151
    v_mfma_f32_32x32x16_bf16 v[160:175], a[96:99], a[60:63], v[160:175]
    s_add_u32 m0, s64, 45056
    ds_read_b64_tr_b16 a[138:139], v237 offset:7168
    ds_read_b64_tr_b16 a[140:141], v235 offset:8192
    ds_read_b64_tr_b16 a[142:143], v237 offset:8192
    v_permlane16_swap_b32 v178, v182
    v_cvt_pk_bf16_f32 v183, v158, v159
    v_mfma_f32_32x32x16_bf16 v[160:175], a[100:103], a[64:67], v[160:175]
    buffer_load_dwordx4 v239, s[8:11], s26 offen offset:0 sc1 lds
    v_permlane16_swap_b32 v179, v183
    v_rcp_f32 v243, v243
    v_mfma_f32_32x32x16_bf16 v[160:175], a[104:107], a[68:71], v[160:175]
    s_waitcnt vmcnt(19) lgkmcnt(0)
    v_mul_f32 v212, v212, v240
    v_mul_f32 v213, v213, v241
    v_mul_f32 v214, v214, v242
    v_mul_f32 v215, v215, v243
    v_mul_f32 v240, v216, v216
    v_mfma_f32_16x16x32_bf16 v[0:3], a[108:111], v[176:179], v[0:3]
    ds_read_b128 a[72:75], v233 offset:36864
    v_mfma_f32_16x16x32_bf16 v[36:39], a[108:111], v[180:183], v[36:39]
    ds_read_b128 a[76:79], v233 offset:37888
    v_mfma_f32_16x16x32_bf16 v[4:7], a[112:115], v[176:179], v[4:7]
    ds_read_b128 a[80:83], v233 offset:38912
    v_mul_f32 v241, v217, v217
    v_mfma_f32_16x16x32_bf16 v[40:43], a[112:115], v[180:183], v[40:43]
    ds_read_b128 a[84:87], v233 offset:39936
    v_mul_f32 v242, v218, v218
    v_mfma_f32_16x16x32_bf16 v[8:11], a[116:119], v[176:179], v[8:11]
    ds_read_b128 a[88:91], v233 offset:40960
    v_mul_f32 v243, v219, v219
    v_mfma_f32_16x16x32_bf16 v[44:47], a[116:119], v[180:183], v[44:47]
    ds_read_b128 a[92:95], v233 offset:41984
    v_fma_f32 v240, v240, s60, v248
    v_mfma_f32_16x16x32_bf16 v[12:15], a[120:123], v[176:179], v[12:15]
    ds_read_b128 a[96:99], v233 offset:43008
    v_fma_f32 v241, v241, s60, v248
    v_mfma_f32_16x16x32_bf16 v[48:51], a[120:123], v[180:183], v[48:51]
    ds_read_b128 a[100:103], v233 offset:44032
    v_fma_f32 v242, v242, s60, v248
    v_mfma_f32_16x16x32_bf16 v[16:19], a[124:127], v[176:179], v[16:19]
    ds_read_b128 a[104:107], v233 offset:45056
    v_fma_f32 v243, v243, s60, v248
    v_mfma_f32_16x16x32_bf16 v[52:55], a[124:127], v[180:183], v[52:55]
    v_exp_f32 v160, v160
    v_mfma_f32_16x16x32_bf16 v[20:23], a[128:131], v[176:179], v[20:23]
    v_exp_f32 v161, v161
    v_mfma_f32_16x16x32_bf16 v[56:59], a[128:131], v[180:183], v[56:59]
    v_exp_f32 v168, v168
    v_mfma_f32_16x16x32_bf16 v[24:27], a[132:135], v[176:179], v[24:27]
    s_add_u32 s8, s8, 73728
    s_addc_u32 s9, s9, 0
    v_mul_f32 v240, v240, v216
    v_mfma_f32_16x16x32_bf16 v[60:63], a[132:135], v[180:183], v[60:63]
    s_sub_u32 s10, s10, 73728
    v_exp_f32 v169, v169
    v_mfma_f32_16x16x32_bf16 v[28:31], a[136:139], v[176:179], v[28:31]
    s_max_i32 s10, s10, 0
    v_cvt_pk_bf16_f32 v184, v160, v161
    v_mfma_f32_16x16x32_bf16 v[64:67], a[136:139], v[180:183], v[64:67]
    s_add_u32 m0, s64, 73728
    v_exp_f32 v162, v162
    v_mfma_f32_16x16x32_bf16 v[32:35], a[140:143], v[176:179], v[32:35]
    v_exp_f32 v163, v163
    v_mfma_f32_16x16x32_bf16 v[68:71], a[140:143], v[180:183], v[68:71]
    s_waitcnt lgkmcnt(0)
    v_mul_f32 v241, v241, v217
    v_mfma_f32_32x32x16_bf16 v[144:159], a[72:75], a[0:3], 0
    v_cvt_pk_bf16_f32 v188, v168, v169
    v_exp_f32 v170, v170
    v_exp_f32 v171, v171
    v_cvt_pk_bf16_f32 v185, v162, v163
    v_mfma_f32_32x32x16_bf16 v[144:159], a[76:79], a[4:7], v[144:159]
    v_permlane16_swap_b32 v184, v188
    v_exp_f32 v164, v164
    v_exp_f32 v165, v165
    v_mfma_f32_32x32x16_bf16 v[144:159], a[80:83], a[8:11], v[144:159]
    buffer_load_dwordx4 v239, s[8:11], s18 offen offset:0 sc1 lds
    v_cvt_pk_bf16_f32 v189, v170, v171
    v_exp_f32 v172, v172
    v_mul_f32 v242, v242, v218
    v_mfma_f32_32x32x16_bf16 v[144:159], a[84:87], a[12:15], v[144:159]
    v_exp_f32 v173, v173
    v_cvt_pk_bf16_f32 v186, v164, v165
    v_permlane16_swap_b32 v185, v189
    v_exp_f32 v166, v166
    v_mfma_f32_32x32x16_bf16 v[144:159], a[88:91], a[16:19], v[144:159]
    v_exp_f32 v167, v167
    v_cvt_pk_bf16_f32 v190, v172, v173
    v_exp_f32 v174, v174
    v_mul_f32 v243, v243, v219
    v_mfma_f32_32x32x16_bf16 v[144:159], a[92:95], a[20:23], v[144:159]
    buffer_load_dwordx4 v239, s[8:11], s19 offen offset:1024 sc1 lds
    v_exp_f32 v175, v175
    v_exp_f32 v240, v240
    v_mfma_f32_32x32x16_bf16 v[144:159], a[96:99], a[24:27], v[144:159]
    v_cvt_pk_bf16_f32 v187, v166, v167
    v_permlane16_swap_b32 v186, v190
    v_cvt_pk_bf16_f32 v191, v174, v175
    v_exp_f32 v241, v241
    v_mfma_f32_32x32x16_bf16 v[144:159], a[100:103], a[28:31], v[144:159]
    buffer_load_dwordx4 v239, s[8:11], s20 offen offset:2048 sc1 lds
    v_permlane16_swap_b32 v187, v191
    v_exp_f32 v242, v242
    v_mfma_f32_32x32x16_bf16 v[144:159], a[104:107], a[32:35], v[144:159]
    buffer_load_dwordx4 v239, s[8:11], s21 offen offset:3072 sc1 lds
    s_add_u32 m0, s64, 77824
    v_exp_f32 v243, v243
    v_add_f32 v240, 1.0, v240
    v_mfma_f32_16x16x32_bf16 v[72:75], a[108:111], v[184:187], v[72:75]
    v_add_f32 v241, 1.0, v241
    v_mfma_f32_16x16x32_bf16 v[108:111], a[108:111], v[188:191], v[108:111]
    ds_read_b64_tr_b16 a[108:109], v235 offset:36864
    v_mfma_f32_16x16x32_bf16 v[76:79], a[112:115], v[184:187], v[76:79]
    ds_read_b64_tr_b16 a[110:111], v237 offset:36864
    v_mfma_f32_16x16x32_bf16 v[112:115], a[112:115], v[188:191], v[112:115]
    v_add_f32 v242, 1.0, v242
    v_mfma_f32_16x16x32_bf16 v[80:83], a[116:119], v[184:187], v[80:83]
    ds_read_b64_tr_b16 a[112:113], v235 offset:37888
    v_add_f32 v243, 1.0, v243
    v_mfma_f32_16x16x32_bf16 v[116:119], a[116:119], v[188:191], v[116:119]
    v_exp_f32 v144, v144
    v_mfma_f32_16x16x32_bf16 v[84:87], a[120:123], v[184:187], v[84:87]
    v_exp_f32 v145, v145
    v_mfma_f32_16x16x32_bf16 v[120:123], a[120:123], v[188:191], v[120:123]
    v_exp_f32 v152, v152
    v_mfma_f32_16x16x32_bf16 v[88:91], a[124:127], v[184:187], v[88:91]
    v_exp_f32 v153, v153
    v_mfma_f32_16x16x32_bf16 v[124:127], a[124:127], v[188:191], v[124:127]
    buffer_load_dwordx4 v239, s[8:11], s22 offen offset:0 sc1 lds
    v_mfma_f32_16x16x32_bf16 v[92:95], a[128:131], v[184:187], v[92:95]
    ds_read_b64_tr_b16 a[114:115], v237 offset:37888
    v_cvt_pk_bf16_f32 v176, v144, v145
    v_mfma_f32_16x16x32_bf16 v[128:131], a[128:131], v[188:191], v[128:131]
L_padm3:
    s_cbranch_execz L_walked1
    v_exp_f32 v146, v146
    v_mfma_f32_16x16x32_bf16 v[96:99], a[132:135], v[184:187], v[96:99]
    v_exp_f32 v147, v147
    v_mfma_f32_16x16x32_bf16 v[132:135], a[132:135], v[188:191], v[132:135]
    ds_read_b64_tr_b16 a[116:117], v235 offset:38912
    v_cvt_pk_bf16_f32 v180, v152, v153
    v_mfma_f32_16x16x32_bf16 v[100:103], a[136:139], v[184:187], v[100:103]
    v_exp_f32 v154, v154
    v_mfma_f32_16x16x32_bf16 v[136:139], a[136:139], v[188:191], v[136:139]
    buffer_load_dwordx4 v239, s[8:11], s23 offen offset:1024 sc1 lds
    v_mfma_f32_16x16x32_bf16 v[104:107], a[140:143], v[184:187], v[104:107]
    v_exp_f32 v155, v155
    v_mfma_f32_16x16x32_bf16 v[140:143], a[140:143], v[188:191], v[140:143]
    v_cvt_pk_bf16_f32 v177, v146, v147
    v_permlane16_swap_b32 v176, v180
    v_mfma_f32_32x32x16_bf16 v[160:175], a[72:75], a[36:39], 0
    buffer_load_dwordx4 v239, s[8:11], s24 offen offset:2048 sc1 lds
    v_exp_f32 v148, v148
    v_exp_f32 v149, v149
    v_mfma_f32_32x32x16_bf16 v[160:175], a[76:79], a[40:43], v[160:175]
    ds_read_b64_tr_b16 a[118:119], v237 offset:38912
    v_cvt_pk_bf16_f32 v181, v154, v155
    v_exp_f32 v156, v156
    v_exp_f32 v157, v157
    v_mfma_f32_32x32x16_bf16 v[160:175], a[80:83], a[44:47], v[160:175]
    ds_read_b64_tr_b16 a[120:121], v235 offset:39936
    ds_read_b64_tr_b16 a[122:123], v237 offset:39936
    ds_read_b64_tr_b16 a[124:125], v235 offset:40960
    v_cvt_pk_bf16_f32 v178, v148, v149
    v_permlane16_swap_b32 v177, v181
    v_mfma_f32_32x32x16_bf16 v[160:175], a[84:87], a[48:51], v[160:175]
    ds_read_b64_tr_b16 a[126:127], v237 offset:40960
    ds_read_b64_tr_b16 a[128:129], v235 offset:41984
    v_exp_f32 v150, v150
    v_exp_f32 v151, v151
    v_mfma_f32_32x32x16_bf16 v[160:175], a[88:91], a[52:55], v[160:175]
    buffer_load_dwordx4 v239, s[8:11], s25 offen offset:3072 sc1 lds
    ds_read_b64_tr_b16 a[130:131], v237 offset:41984
    v_cvt_pk_bf16_f32 v182, v156, v157
    v_exp_f32 v158, v158
    v_mfma_f32_32x32x16_bf16 v[160:175], a[92:95], a[56:59], v[160:175]
    ds_read_b64_tr_b16 a[132:133], v235 offset:43008
    ds_read_b64_tr_b16 a[134:135], v237 offset:43008
    ds_read_b64_tr_b16 a[136:137], v235 offset:44032
    v_exp_f32 v159, v159
    v_cvt_pk_bf16_f32 v179, v150, v151
    v_mfma_f32_32x32x16_bf16 v[160:175], a[96:99], a[60:63], v[160:175]
    s_add_u32 m0, s64, 81920
    ds_read_b64_tr_b16 a[138:139], v237 offset:44032
    ds_read_b64_tr_b16 a[140:141], v235 offset:45056
    ds_read_b64_tr_b16 a[142:143], v237 offset:45056
    v_permlane16_swap_b32 v178, v182
    v_cvt_pk_bf16_f32 v183, v158, v159
    v_mfma_f32_32x32x16_bf16 v[160:175], a[100:103], a[64:67], v[160:175]
    buffer_load_dwordx4 v239, s[8:11], s26 offen offset:0 sc1 lds
    v_permlane16_swap_b32 v179, v183
    v_rcp_f32 v240, v240
    v_mfma_f32_32x32x16_bf16 v[160:175], a[104:107], a[68:71], v[160:175]
    s_waitcnt vmcnt(13) lgkmcnt(0)
    v_rcp_f32 v241, v241
    v_rcp_f32 v242, v242
    v_rcp_f32 v243, v243
    v_mfma_f32_16x16x32_bf16 v[0:3], a[108:111], v[176:179], v[0:3]
    ds_read_b128 a[72:75], v232 offset:0
    v_mfma_f32_16x16x32_bf16 v[36:39], a[108:111], v[180:183], v[36:39]
    ds_read_b128 a[76:79], v232 offset:1024
    v_mfma_f32_16x16x32_bf16 v[4:7], a[112:115], v[176:179], v[4:7]
    ds_read_b128 a[80:83], v232 offset:2048
    v_mfma_f32_16x16x32_bf16 v[40:43], a[112:115], v[180:183], v[40:43]
    ds_read_b128 a[84:87], v232 offset:3072
    v_mfma_f32_16x16x32_bf16 v[8:11], a[116:119], v[176:179], v[8:11]
    ds_read_b128 a[88:91], v232 offset:4096
    v_mfma_f32_16x16x32_bf16 v[44:47], a[116:119], v[180:183], v[44:47]
    ds_read_b128 a[92:95], v232 offset:5120
    v_mul_f32 v216, v216, v240
    v_mfma_f32_16x16x32_bf16 v[12:15], a[120:123], v[176:179], v[12:15]
    ds_read_b128 a[96:99], v232 offset:6144
    v_mul_f32 v217, v217, v241
    v_mfma_f32_16x16x32_bf16 v[48:51], a[120:123], v[180:183], v[48:51]
    ds_read_b128 a[100:103], v232 offset:7168
    v_mul_f32 v218, v218, v242
    v_mfma_f32_16x16x32_bf16 v[16:19], a[124:127], v[176:179], v[16:19]
    ds_read_b128 a[104:107], v232 offset:8192
    v_mul_f32 v219, v219, v243
    v_mfma_f32_16x16x32_bf16 v[52:55], a[124:127], v[180:183], v[52:55]
    s_add_u32 s8, s8, 73728
    s_addc_u32 s9, s9, 0
    v_mul_f32 v240, v220, v220
    v_mfma_f32_16x16x32_bf16 v[20:23], a[128:131], v[176:179], v[20:23]
    s_sub_u32 s10, s10, 73728
    v_exp_f32 v160, v160
    v_mfma_f32_16x16x32_bf16 v[56:59], a[128:131], v[180:183], v[56:59]
    s_max_i32 s10, s10, 0
    v_exp_f32 v161, v161
    v_mfma_f32_16x16x32_bf16 v[24:27], a[132:135], v[176:179], v[24:27]
    s_add_u32 m0, s64, 110592
    v_exp_f32 v168, v168
    v_mfma_f32_16x16x32_bf16 v[60:63], a[132:135], v[180:183], v[60:63]
    s_sub_u32 s68, 20, s7
    v_exp_f32 v169, v169
    v_mfma_f32_16x16x32_bf16 v[28:31], a[136:139], v[176:179], v[28:31]
    s_mul_i32 s68, s68, 9216
    v_cvt_pk_bf16_f32 v184, v160, v161
    v_mfma_f32_16x16x32_bf16 v[64:67], a[136:139], v[180:183], v[64:67]
    s_add_u32 s90, s68, 73728
    v_exp_f32 v162, v162
    v_mfma_f32_16x16x32_bf16 v[32:35], a[140:143], v[176:179], v[32:35]
    s_sub_u32 s91, 0, s68
    v_exp_f32 v163, v163
    v_mfma_f32_16x16x32_bf16 v[68:71], a[140:143], v[180:183], v[68:71]
    s_waitcnt lgkmcnt(0)
    v_mfma_f32_32x32x16_bf16 v[144:159], a[72:75], a[0:3], 0
    v_cvt_pk_bf16_f32 v188, v168, v169
    v_exp_f32 v170, v170
    v_exp_f32 v171, v171
    v_cvt_pk_bf16_f32 v185, v162, v163
    v_mfma_f32_32x32x16_bf16 v[144:159], a[76:79], a[4:7], v[144:159]
    v_permlane16_swap_b32 v184, v188
    v_exp_f32 v164, v164
    v_exp_f32 v165, v165
    v_mfma_f32_32x32x16_bf16 v[144:159], a[80:83], a[8:11], v[144:159]
    buffer_load_dwordx4 v239, s[8:11], s18 offen offset:0 sc1 lds
    v_cvt_pk_bf16_f32 v189, v170, v171
    v_exp_f32 v172, v172
    v_subrev_co_u32 v252, vcc, s0, v250
    v_mfma_f32_32x32x16_bf16 v[144:159], a[84:87], a[12:15], v[144:159]
    v_exp_f32 v173, v173
    v_cvt_pk_bf16_f32 v186, v164, v165
    v_permlane16_swap_b32 v185, v189
    v_mov_b32 v253, s1
    v_mfma_f32_32x32x16_bf16 v[144:159], a[88:91], a[16:19], v[144:159]
    buffer_load_dwordx4 v239, s[8:11], s19 offen offset:1024 sc1 lds
    v_exp_f32 v166, v166
    v_exp_f32 v167, v167
    v_mfma_f32_32x32x16_bf16 v[144:159], a[92:95], a[20:23], v[144:159]
    v_cvt_pk_bf16_f32 v190, v172, v173
    v_exp_f32 v174, v174
    v_exp_f32 v175, v175
    v_subb_co_u32 v253, vcc, v251, v253, vcc
    v_mfma_f32_32x32x16_bf16 v[144:159], a[96:99], a[24:27], v[144:159]
    v_cvt_pk_bf16_f32 v187, v166, v167
    v_permlane16_swap_b32 v186, v190
    v_cvt_pk_bf16_f32 v191, v174, v175
    v_lshrrev_b32 v252, 28, v252
    v_or_b32 v252, v252, v253
    v_mfma_f32_32x32x16_bf16 v[144:159], a[100:103], a[28:31], v[144:159]
    buffer_load_dwordx4 v239, s[8:11], s20 offen offset:2048 sc1 lds
    v_permlane16_swap_b32 v187, v191
    v_cmp_ne_u32 s[68:69], 0, v252
    v_mul_f32 v241, v221, v221
    v_mfma_f32_32x32x16_bf16 v[144:159], a[104:107], a[32:35], v[144:159]
    buffer_load_dwordx4 v239, s[8:11], s21 offen offset:3072 sc1 lds
    s_add_u32 m0, s64, 114688
    v_mul_f32 v242, v222, v222
    v_mul_f32 v243, v223, v223
    v_fma_f32 v240, v240, s60, v248
    v_mfma_f32_16x16x32_bf16 v[72:75], a[108:111], v[184:187], v[72:75]
    v_fma_f32 v241, v241, s60, v248
    v_mfma_f32_16x16x32_bf16 v[108:111], a[108:111], v[188:191], v[108:111]
    v_fma_f32 v242, v242, s60, v248
    v_mfma_f32_16x16x32_bf16 v[76:79], a[112:115], v[184:187], v[76:79]
    ds_read_b64_tr_b16 a[108:109], v234 offset:0
    v_fma_f32 v243, v243, s60, v248
    v_mfma_f32_16x16x32_bf16 v[112:115], a[112:115], v[188:191], v[112:115]
    ds_read_b64_tr_b16 a[110:111], v236 offset:0
    v_mul_f32 v240, v240, v220
    v_mfma_f32_16x16x32_bf16 v[80:83], a[116:119], v[184:187], v[80:83]
    ds_read_b64_tr_b16 a[112:113], v234 offset:1024
    v_mul_f32 v241, v241, v221
    v_mfma_f32_16x16x32_bf16 v[116:119], a[116:119], v[188:191], v[116:119]
    v_exp_f32 v144, v144
    v_mfma_f32_16x16x32_bf16 v[84:87], a[120:123], v[184:187], v[84:87]
    v_exp_f32 v145, v145
    v_mfma_f32_16x16x32_bf16 v[120:123], a[120:123], v[188:191], v[120:123]
    v_exp_f32 v152, v152
    v_mfma_f32_16x16x32_bf16 v[88:91], a[124:127], v[184:187], v[88:91]
    v_exp_f32 v153, v153
    v_mfma_f32_16x16x32_bf16 v[124:127], a[124:127], v[188:191], v[124:127]
    buffer_load_dwordx4 v239, s[8:11], s22 offen offset:0 sc1 lds
    v_mfma_f32_16x16x32_bf16 v[92:95], a[128:131], v[184:187], v[92:95]
    ds_read_b64_tr_b16 a[114:115], v236 offset:1024
    v_cvt_pk_bf16_f32 v176, v144, v145
    v_mfma_f32_16x16x32_bf16 v[128:131], a[128:131], v[188:191], v[128:131]
    v_exp_f32 v146, v146
    v_mfma_f32_16x16x32_bf16 v[96:99], a[132:135], v[184:187], v[96:99]
    v_exp_f32 v147, v147
    v_mfma_f32_16x16x32_bf16 v[132:135], a[132:135], v[188:191], v[132:135]
    ds_read_b64_tr_b16 a[116:117], v234 offset:2048
    v_cvt_pk_bf16_f32 v180, v152, v153
    v_mfma_f32_16x16x32_bf16 v[100:103], a[136:139], v[184:187], v[100:103]
    v_exp_f32 v154, v154
    v_mfma_f32_16x16x32_bf16 v[136:139], a[136:139], v[188:191], v[136:139]
    buffer_load_dwordx4 v239, s[8:11], s23 offen offset:1024 sc1 lds
    v_mfma_f32_16x16x32_bf16 v[104:107], a[140:143], v[184:187], v[104:107]
    v_exp_f32 v155, v155
    v_mfma_f32_16x16x32_bf16 v[140:143], a[140:143], v[188:191], v[140:143]
    v_cvt_pk_bf16_f32 v177, v146, v147
    v_permlane16_swap_b32 v176, v180
    v_mfma_f32_32x32x16_bf16 v[160:175], a[72:75], a[36:39], 0
    buffer_load_dwordx4 v239, s[8:11], s24 offen offset:2048 sc1 lds
    v_exp_f32 v148, v148
    v_exp_f32 v149, v149
    v_mfma_f32_32x32x16_bf16 v[160:175], a[76:79], a[40:43], v[160:175]
    ds_read_b64_tr_b16 a[118:119], v236 offset:2048
    v_cvt_pk_bf16_f32 v181, v154, v155
    v_exp_f32 v156, v156
    v_exp_f32 v157, v157
    v_mfma_f32_32x32x16_bf16 v[160:175], a[80:83], a[44:47], v[160:175]
    ds_read_b64_tr_b16 a[120:121], v234 offset:3072
    ds_read_b64_tr_b16 a[122:123], v236 offset:3072
    ds_read_b64_tr_b16 a[124:125], v234 offset:4096
    v_cvt_pk_bf16_f32 v178, v148, v149
    v_permlane16_swap_b32 v177, v181
    v_mfma_f32_32x32x16_bf16 v[160:175], a[84:87], a[48:51], v[160:175]
    ds_read_b64_tr_b16 a[126:127], v236 offset:4096
    ds_read_b64_tr_b16 a[128:129], v234 offset:5120
    v_exp_f32 v150, v150
    v_exp_f32 v151, v151
    v_mfma_f32_32x32x16_bf16 v[160:175], a[88:91], a[52:55], v[160:175]
    buffer_load_dwordx4 v239, s[8:11], s25 offen offset:3072 sc1 lds
    ds_read_b64_tr_b16 a[130:131], v236 offset:5120
    v_cvt_pk_bf16_f32 v182, v156, v157
    v_exp_f32 v158, v158
    v_mfma_f32_32x32x16_bf16 v[160:175], a[92:95], a[56:59], v[160:175]
    ds_read_b64_tr_b16 a[132:133], v234 offset:6144
    ds_read_b64_tr_b16 a[134:135], v236 offset:6144
    ds_read_b64_tr_b16 a[136:137], v234 offset:7168
    v_exp_f32 v159, v159
    v_cvt_pk_bf16_f32 v179, v150, v151
    v_mfma_f32_32x32x16_bf16 v[160:175], a[96:99], a[60:63], v[160:175]
    s_add_u32 m0, s64, 118784
    ds_read_b64_tr_b16 a[138:139], v236 offset:7168
    ds_read_b64_tr_b16 a[140:141], v234 offset:8192
    ds_read_b64_tr_b16 a[142:143], v236 offset:8192
    v_permlane16_swap_b32 v178, v182
    v_cvt_pk_bf16_f32 v183, v158, v159
    v_mfma_f32_32x32x16_bf16 v[160:175], a[100:103], a[64:67], v[160:175]
    buffer_load_dwordx4 v239, s[8:11], s26 offen offset:0 sc1 lds
    v_permlane16_swap_b32 v179, v183
    v_mul_f32 v242, v242, v222
    v_mul_f32 v243, v243, v223
    v_mfma_f32_32x32x16_bf16 v[160:175], a[104:107], a[68:71], v[160:175]
    s_waitcnt vmcnt(18) lgkmcnt(0)
    v_exp_f32 v240, v240
    v_exp_f32 v241, v241
    v_exp_f32 v242, v242
    v_mfma_f32_16x16x32_bf16 v[0:3], a[108:111], v[176:179], v[0:3]
    ds_read_b128 a[72:75], v232 offset:36864
    v_mfma_f32_16x16x32_bf16 v[36:39], a[108:111], v[180:183], v[36:39]
    ds_read_b128 a[76:79], v232 offset:37888
    v_mfma_f32_16x16x32_bf16 v[4:7], a[112:115], v[176:179], v[4:7]
    ds_read_b128 a[80:83], v232 offset:38912
    v_mfma_f32_16x16x32_bf16 v[40:43], a[112:115], v[180:183], v[40:43]
    ds_read_b128 a[84:87], v232 offset:39936
    v_mfma_f32_16x16x32_bf16 v[8:11], a[116:119], v[176:179], v[8:11]
    ds_read_b128 a[88:91], v232 offset:40960
    v_mfma_f32_16x16x32_bf16 v[44:47], a[116:119], v[180:183], v[44:47]
    v_exp_f32 v243, v243
    v_mfma_f32_16x16x32_bf16 v[12:15], a[120:123], v[176:179], v[12:15]
    ds_read_b128 a[92:95], v232 offset:41984
    v_add_f32 v240, 1.0, v240
    v_mfma_f32_16x16x32_bf16 v[48:51], a[120:123], v[180:183], v[48:51]
    ds_read_b128 a[96:99], v232 offset:43008
    v_add_f32 v241, 1.0, v241
    v_mfma_f32_16x16x32_bf16 v[16:19], a[124:127], v[176:179], v[16:19]
    ds_read_b128 a[100:103], v232 offset:44032
    v_add_f32 v242, 1.0, v242
    v_mfma_f32_16x16x32_bf16 v[52:55], a[124:127], v[180:183], v[52:55]
    v_exp_f32 v160, v160
    v_mfma_f32_16x16x32_bf16 v[20:23], a[128:131], v[176:179], v[20:23]
    v_exp_f32 v161, v161
    v_mfma_f32_16x16x32_bf16 v[56:59], a[128:131], v[180:183], v[56:59]
    v_exp_f32 v168, v168
    v_mfma_f32_16x16x32_bf16 v[24:27], a[132:135], v[176:179], v[24:27]
    s_add_u32 s8, s8, 73728
    s_addc_u32 s9, s9, 0
    ds_read_b128 a[104:107], v232 offset:45056
    v_mfma_f32_16x16x32_bf16 v[60:63], a[132:135], v[180:183], v[60:63]
    s_sub_u32 s10, s10, 73728
    v_exp_f32 v169, v169
    v_mfma_f32_16x16x32_bf16 v[28:31], a[136:139], v[176:179], v[28:31]
    s_max_i32 s10, s10, 0
    v_add_f32 v243, 1.0, v243
    v_rcp_f32 v240, v240
    v_mfma_f32_16x16x32_bf16 v[64:67], a[136:139], v[180:183], v[64:67]
    s_add_u32 m0, s64, 0
    v_cvt_pk_bf16_f32 v184, v160, v161
    v_exp_f32 v162, v162
    v_mfma_f32_16x16x32_bf16 v[32:35], a[140:143], v[176:179], v[32:35]
    v_exp_f32 v163, v163
    v_mfma_f32_16x16x32_bf16 v[68:71], a[140:143], v[180:183], v[68:71]
    s_waitcnt lgkmcnt(0)
    v_rcp_f32 v241, v241
    s_cmp_lg_u32 s68, 0
    s_cbranch_scc1 L_pollwu
L_woku:
    v_mfma_f32_32x32x16_bf16 v[144:159], a[72:75], a[0:3], 0
    s_add_u32 s12, s64, 4764160
    v_cvt_pk_bf16_f32 v188, v168, v169
    v_exp_f32 v170, v170
    v_exp_f32 v171, v171
    v_cvt_pk_bf16_f32 v185, v162, v163
    v_mfma_f32_32x32x16_bf16 v[144:159], a[76:79], a[4:7], v[144:159]
    buffer_load_dwordx2 a[214:215], v231, s[52:55], s12 offen sc1
    v_permlane16_swap_b32 v184, v188
    v_exp_f32 v164, v164
    v_mfma_f32_32x32x16_bf16 v[144:159], a[80:83], a[8:11], v[144:159]
    v_exp_f32 v165, v165
    v_cvt_pk_bf16_f32 v189, v170, v171
    v_exp_f32 v172, v172
    v_mfma_f32_32x32x16_bf16 v[144:159], a[84:87], a[12:15], v[144:159]
    v_exp_f32 v173, v173
    v_cvt_pk_bf16_f32 v186, v164, v165
    v_permlane16_swap_b32 v185, v189
    v_rcp_f32 v242, v242
    v_mfma_f32_32x32x16_bf16 v[144:159], a[88:91], a[16:19], v[144:159]
    buffer_load_dwordx4 v239, s[8:11], s18 offen offset:0 sc1 lds
    v_exp_f32 v166, v166
    v_rcp_f32 v243, v243
    v_mfma_f32_32x32x16_bf16 v[144:159], a[92:95], a[20:23], v[144:159]
    v_exp_f32 v167, v167
    v_cvt_pk_bf16_f32 v190, v172, v173
    v_exp_f32 v174, v174
    v_mul_f32 v220, v220, v240
    v_mfma_f32_32x32x16_bf16 v[144:159], a[96:99], a[24:27], v[144:159]
    s_add_u32 s12, s64, 4760064
    v_exp_f32 v175, v175
    v_cvt_pk_bf16_f32 v187, v166, v167
    v_permlane16_swap_b32 v186, v190
    v_cvt_pk_bf16_f32 v191, v174, v175
    v_mfma_f32_32x32x16_bf16 v[144:159], a[100:103], a[28:31], v[144:159]
    buffer_load_dwordx4 a[210:213], v239, s[52:55], s12 offen offset:3072 sc1
    v_permlane16_swap_b32 v187, v191
    v_mul_f32 v221, v221, v241
    v_mul_f32 v222, v222, v242
    v_mfma_f32_32x32x16_bf16 v[144:159], a[104:107], a[32:35], v[144:159]
    buffer_load_dwordx4 v239, s[8:11], s19 offen offset:1024 sc1 lds
    v_mul_f32 v223, v223, v243
    v_cvt_pk_bf16_f32 v200, v208, v209
    v_cvt_pk_bf16_f32 v201, v210, v211
    v_cvt_pk_bf16_f32 v204, v212, v213
    v_mfma_f32_16x16x32_bf16 v[72:75], a[108:111], v[184:187], v[72:75]
    v_cvt_pk_bf16_f32 v205, v214, v215
    v_mfma_f32_16x16x32_bf16 v[108:111], a[108:111], v[188:191], v[108:111]
    ds_read_b64_tr_b16 a[108:109], v234 offset:36864
    v_mfma_f32_16x16x32_bf16 v[76:79], a[112:115], v[184:187], v[76:79]
    ds_read_b64_tr_b16 a[110:111], v236 offset:36864
    v_cvt_pk_bf16_f32 v202, v216, v217
    v_mfma_f32_16x16x32_bf16 v[112:115], a[112:115], v[188:191], v[112:115]
    s_nop 0
    ds_read_b64_tr_b16 a[112:113], v234 offset:37888
    ds_read_b64_tr_b16 a[114:115], v236 offset:37888
    v_mfma_f32_16x16x32_bf16 v[80:83], a[116:119], v[184:187], v[80:83]
    buffer_load_dwordx4 v239, s[8:11], s20 offen offset:2048 sc1 lds
    v_mfma_f32_16x16x32_bf16 v[116:119], a[116:119], v[188:191], v[116:119]
    v_exp_f32 v144, v144
    v_mfma_f32_16x16x32_bf16 v[84:87], a[120:123], v[184:187], v[84:87]
    v_exp_f32 v145, v145
    v_mfma_f32_16x16x32_bf16 v[120:123], a[120:123], v[188:191], v[120:123]
    v_exp_f32 v152, v152
    v_mfma_f32_16x16x32_bf16 v[88:91], a[124:127], v[184:187], v[88:91]
    v_exp_f32 v153, v153
    v_mfma_f32_16x16x32_bf16 v[124:127], a[124:127], v[188:191], v[124:127]
    buffer_load_dwordx4 a[206:209], v239, s[52:55], s12 offen offset:2048 sc1
    v_mfma_f32_16x16x32_bf16 v[92:95], a[128:131], v[184:187], v[92:95]
    v_cvt_pk_bf16_f32 v176, v144, v145
    v_exp_f32 v146, v146
    v_mfma_f32_16x16x32_bf16 v[128:131], a[128:131], v[188:191], v[128:131]
    v_exp_f32 v147, v147
    v_mfma_f32_16x16x32_bf16 v[96:99], a[132:135], v[184:187], v[96:99]
    buffer_load_dwordx4 v239, s[8:11], s21 offen offset:3072 sc1 lds
    v_mfma_f32_16x16x32_bf16 v[132:135], a[132:135], v[188:191], v[132:135]
    v_cvt_pk_bf16_f32 v180, v152, v153
    v_exp_f32 v154, v154
    v_mfma_f32_16x16x32_bf16 v[100:103], a[136:139], v[184:187], v[100:103]
    v_exp_f32 v155, v155
    v_mfma_f32_16x16x32_bf16 v[136:139], a[136:139], v[188:191], v[136:139]
    ds_read_b64_tr_b16 a[116:117], v234 offset:38912
    v_cvt_pk_bf16_f32 v177, v146, v147
    v_mfma_f32_16x16x32_bf16 v[104:107], a[140:143], v[184:187], v[104:107]
    v_permlane16_swap_b32 v176, v180
    v_mfma_f32_16x16x32_bf16 v[140:143], a[140:143], v[188:191], v[140:143]
    v_exp_f32 v148, v148
    v_mfma_f32_32x32x16_bf16 v[160:175], a[72:75], a[36:39], 0
    buffer_load_dwordx4 a[202:205], v239, s[52:55], s12 offen offset:1024 sc1
    ds_read_b64_tr_b16 a[118:119], v236 offset:38912
    v_exp_f32 v149, v149
    v_cvt_pk_bf16_f32 v181, v154, v155
    v_mfma_f32_32x32x16_bf16 v[160:175], a[76:79], a[40:43], v[160:175]
    s_add_u32 m0, s64, 4096
    ds_read_b64_tr_b16 a[120:121], v234 offset:39936
    ds_read_b64_tr_b16 a[122:123], v236 offset:39936
    v_exp_f32 v156, v156
    v_exp_f32 v157, v157
    v_mfma_f32_32x32x16_bf16 v[160:175], a[80:83], a[44:47], v[160:175]
    buffer_load_dwordx4 v239, s[8:11], s22 offen offset:0 sc1 lds
    ds_read_b64_tr_b16 a[124:125], v234 offset:40960
    v_cvt_pk_bf16_f32 v178, v148, v149
    v_permlane16_swap_b32 v177, v181
    v_mfma_f32_32x32x16_bf16 v[160:175], a[84:87], a[48:51], v[160:175]
    ds_read_b64_tr_b16 a[126:127], v236 offset:40960
    ds_read_b64_tr_b16 a[128:129], v234 offset:41984
    v_exp_f32 v150, v150
    v_exp_f32 v151, v151
    v_mfma_f32_32x32x16_bf16 v[160:175], a[88:91], a[52:55], v[160:175]
    ds_read_b64_tr_b16 a[130:131], v236 offset:41984
    ds_read_b64_tr_b16 a[132:133], v234 offset:43008
    ds_read_b64_tr_b16 a[134:135], v236 offset:43008
    v_cvt_pk_bf16_f32 v182, v156, v157
    v_exp_f32 v158, v158
    v_mfma_f32_32x32x16_bf16 v[160:175], a[92:95], a[56:59], v[160:175]
    buffer_load_dwordx4 v239, s[8:11], s23 offen offset:1024 sc1 lds
    ds_read_b64_tr_b16 a[136:137], v234 offset:44032
    v_exp_f32 v159, v159
    v_cvt_pk_bf16_f32 v179, v150, v151
    v_mfma_f32_32x32x16_bf16 v[160:175], a[96:99], a[60:63], v[160:175]
    ds_read_b64_tr_b16 a[138:139], v236 offset:44032
    ds_read_b64_tr_b16 a[140:141], v234 offset:45056
    ds_read_b64_tr_b16 a[142:143], v236 offset:45056
    v_permlane16_swap_b32 v178, v182
    v_cvt_pk_bf16_f32 v183, v158, v159
    v_mfma_f32_32x32x16_bf16 v[160:175], a[100:103], a[64:67], v[160:175]
    buffer_load_dwordx4 a[198:201], v239, s[52:55], s12 offen offset:0 sc1
    v_permlane16_swap_b32 v179, v183
    v_cvt_pk_bf16_f32 v203, v218, v219
    v_cvt_pk_bf16_f32 v206, v220, v221
    v_mfma_f32_32x32x16_bf16 v[160:175], a[104:107], a[68:71], v[160:175]
    s_waitcnt vmcnt(20) lgkmcnt(0)
    v_cvt_pk_bf16_f32 v207, v222, v223
    v_mul_f32 v240, v224, v224
    v_mul_f32 v241, v225, v225
    v_mul_f32 v242, v226, v226
    v_mul_f32 v243, v227, v227
    v_mfma_f32_16x16x32_bf16 v[0:3], a[108:111], v[176:179], v[0:3]
    ds_read_b128 a[72:75], v233 offset:0
    v_fma_f32 v240, v240, s60, v248
    v_mfma_f32_16x16x32_bf16 v[36:39], a[108:111], v[180:183], v[36:39]
    ds_read_b128 a[76:79], v233 offset:1024
    v_fma_f32 v241, v241, s60, v248
    v_mfma_f32_16x16x32_bf16 v[4:7], a[112:115], v[176:179], v[4:7]
    buffer_load_dwordx4 v239, s[8:11], s24 offen offset:2048 sc1 lds
    v_mfma_f32_16x16x32_bf16 v[40:43], a[112:115], v[180:183], v[40:43]
    ds_read_b128 a[80:83], v233 offset:2048
    v_fma_f32 v242, v242, s60, v248
    v_mfma_f32_16x16x32_bf16 v[8:11], a[116:119], v[176:179], v[8:11]
    ds_read_b128 a[84:87], v233 offset:3072
    v_fma_f32 v243, v243, s60, v248
    v_mfma_f32_16x16x32_bf16 v[44:47], a[116:119], v[180:183], v[44:47]
    v_exp_f32 v160, v160
    v_mfma_f32_16x16x32_bf16 v[12:15], a[120:123], v[176:179], v[12:15]
    buffer_load_dwordx4 v239, s[8:11], s25 offen offset:3072 sc1 lds
    v_mfma_f32_16x16x32_bf16 v[48:51], a[120:123], v[180:183], v[48:51]
    v_exp_f32 v161, v161
    v_mfma_f32_16x16x32_bf16 v[16:19], a[124:127], v[176:179], v[16:19]
    ds_read_b128 a[88:91], v233 offset:4096
    v_exp_f32 v168, v168
    v_mfma_f32_16x16x32_bf16 v[52:55], a[124:127], v[180:183], v[52:55]
    s_add_u32 s12, s64, 4768768
    ds_read_b128 a[92:95], v233 offset:5120
    v_exp_f32 v169, v169
    v_mfma_f32_16x16x32_bf16 v[20:23], a[128:131], v[176:179], v[20:23]
    buffer_load_dwordx2 a[232:233], v231, s[52:55], s12 offen sc1
    ds_read_b128 a[96:99], v233 offset:6144
    v_mfma_f32_16x16x32_bf16 v[56:59], a[128:131], v[180:183], v[56:59]
    s_add_u32 m0, s64, 8192
    ds_read_b128 a[100:103], v233 offset:7168
    v_cvt_pk_bf16_f32 v184, v160, v161
    v_mfma_f32_16x16x32_bf16 v[24:27], a[132:135], v[176:179], v[24:27]
    buffer_load_dwordx4 v239, s[8:11], s26 offen offset:0 sc1 lds
    ds_read_b128 a[104:107], v233 offset:8192
    v_mfma_f32_16x16x32_bf16 v[60:63], a[132:135], v[180:183], v[60:63]
    s_add_u32 s8, s8, s90
    s_addc_u32 s9, s9, 0
    v_mul_f32 v240, v240, v224
    v_mfma_f32_16x16x32_bf16 v[28:31], a[136:139], v[176:179], v[28:31]
    s_sub_u32 s10, s10, s90
    v_exp_f32 v162, v162
    v_mfma_f32_16x16x32_bf16 v[64:67], a[136:139], v[180:183], v[64:67]
    s_max_i32 s10, s10, 0
    s_add_u32 m0, s64, 36864
    v_mul_f32 v241, v241, v225
    v_mfma_f32_16x16x32_bf16 v[32:35], a[140:143], v[176:179], v[32:35]
    v_exp_f32 v163, v163
    v_mfma_f32_16x16x32_bf16 v[68:71], a[140:143], v[180:183], v[68:71]
    s_waitcnt lgkmcnt(0)
    v_mul_f32 v242, v242, v226
    v_mfma_f32_32x32x16_bf16 v[144:159], a[72:75], a[0:3], 0
    v_cvt_pk_bf16_f32 v188, v168, v169
    v_exp_f32 v170, v170
    v_exp_f32 v171, v171
    v_cvt_pk_bf16_f32 v185, v162, v163
    v_mfma_f32_32x32x16_bf16 v[144:159], a[76:79], a[4:7], v[144:159]
    v_permlane16_swap_b32 v184, v188
    v_exp_f32 v164, v164
    v_exp_f32 v165, v165
    v_mfma_f32_32x32x16_bf16 v[144:159], a[80:83], a[8:11], v[144:159]
    buffer_load_dwordx4 v239, s[8:11], s18 offen offset:0 sc1 lds
    v_cvt_pk_bf16_f32 v189, v170, v171
    v_exp_f32 v172, v172
    v_mfma_f32_32x32x16_bf16 v[144:159], a[84:87], a[12:15], v[144:159]
    buffer_store_dwordx4 v[200:203], v246, s[44:47], s15 offen offset:0 sc1
    v_exp_f32 v173, v173
    v_cvt_pk_bf16_f32 v186, v164, v165
    v_mul_f32 v243, v243, v227
    v_mfma_f32_32x32x16_bf16 v[144:159], a[88:91], a[16:19], v[144:159]
    v_permlane16_swap_b32 v185, v189
    v_exp_f32 v166, v166
    v_exp_f32 v240, v240
    v_mfma_f32_32x32x16_bf16 v[144:159], a[92:95], a[20:23], v[144:159]
    v_exp_f32 v167, v167
    v_cvt_pk_bf16_f32 v190, v172, v173
    v_exp_f32 v174, v174
    v_exp_f32 v175, v175
    v_mfma_f32_32x32x16_bf16 v[144:159], a[96:99], a[24:27], v[144:159]
    v_cvt_pk_bf16_f32 v187, v166, v167
    v_permlane16_swap_b32 v186, v190
    v_cvt_pk_bf16_f32 v191, v174, v175
    v_exp_f32 v241, v241
    v_mfma_f32_32x32x16_bf16 v[144:159], a[100:103], a[28:31], v[144:159]
    buffer_load_dwordx4 v239, s[8:11], s19 offen offset:1024 sc1 lds
    v_permlane16_swap_b32 v187, v191
    v_exp_f32 v242, v242
    v_mfma_f32_32x32x16_bf16 v[144:159], a[104:107], a[32:35], v[144:159]
    buffer_load_dwordx4 v239, s[8:11], s20 offen offset:2048 sc1 lds
    v_exp_f32 v243, v243
    v_add_f32 v240, 1.0, v240
    v_add_f32 v241, 1.0, v241
    v_mfma_f32_16x16x32_bf16 v[72:75], a[108:111], v[184:187], v[72:75]
    v_add_f32 v242, 1.0, v242
    v_mfma_f32_16x16x32_bf16 v[108:111], a[108:111], v[188:191], v[108:111]
    ds_read_b64_tr_b16 a[108:109], v235 offset:0
    v_mfma_f32_16x16x32_bf16 v[76:79], a[112:115], v[184:187], v[76:79]
    ds_read_b64_tr_b16 a[110:111], v237 offset:0
    v_mfma_f32_16x16x32_bf16 v[112:115], a[112:115], v[188:191], v[112:115]
    ds_read_b64_tr_b16 a[112:113], v235 offset:1024
    v_add_f32 v243, 1.0, v243
    v_mfma_f32_16x16x32_bf16 v[80:83], a[116:119], v[184:187], v[80:83]
    buffer_store_dwordx4 v[204:207], v246, s[44:47], s15 offen offset:512 sc1
    v_mfma_f32_16x16x32_bf16 v[116:119], a[116:119], v[188:191], v[116:119]
    v_exp_f32 v144, v144
    v_mfma_f32_16x16x32_bf16 v[84:87], a[120:123], v[184:187], v[84:87]
    v_exp_f32 v145, v145
    v_mfma_f32_16x16x32_bf16 v[120:123], a[120:123], v[188:191], v[120:123]
    v_exp_f32 v152, v152
    v_mfma_f32_16x16x32_bf16 v[88:91], a[124:127], v[184:187], v[88:91]
    v_exp_f32 v153, v153
    v_mfma_f32_16x16x32_bf16 v[124:127], a[124:127], v[188:191], v[124:127]
    ds_read_b64_tr_b16 a[114:115], v237 offset:1024
    v_cvt_pk_bf16_f32 v176, v144, v145
    v_mfma_f32_16x16x32_bf16 v[92:95], a[128:131], v[184:187], v[92:95]
    v_exp_f32 v146, v146
    v_mfma_f32_16x16x32_bf16 v[128:131], a[128:131], v[188:191], v[128:131]
    v_exp_f32 v147, v147
    v_mfma_f32_16x16x32_bf16 v[96:99], a[132:135], v[184:187], v[96:99]
    buffer_load_dwordx4 v239, s[8:11], s21 offen offset:3072 sc1 lds
    v_mfma_f32_16x16x32_bf16 v[132:135], a[132:135], v[188:191], v[132:135]
    v_cvt_pk_bf16_f32 v180, v152, v153
    v_exp_f32 v154, v154
    v_mfma_f32_16x16x32_bf16 v[100:103], a[136:139], v[184:187], v[100:103]
    v_exp_f32 v155, v155
    v_mfma_f32_16x16x32_bf16 v[136:139], a[136:139], v[188:191], v[136:139]
    ds_read_b64_tr_b16 a[116:117], v235 offset:2048
    v_cvt_pk_bf16_f32 v177, v146, v147
    v_mfma_f32_16x16x32_bf16 v[104:107], a[140:143], v[184:187], v[104:107]
    v_permlane16_swap_b32 v176, v180
    v_mfma_f32_16x16x32_bf16 v[140:143], a[140:143], v[188:191], v[140:143]
    s_add_u32 m0, s64, 40960
    v_exp_f32 v148, v148
    v_mfma_f32_32x32x16_bf16 v[160:175], a[72:75], a[36:39], 0
    buffer_load_dwordx4 v239, s[8:11], s22 offen offset:0 sc1 lds
    ds_read_b64_tr_b16 a[118:119], v237 offset:2048
    v_exp_f32 v149, v149
    v_cvt_pk_bf16_f32 v181, v154, v155
    v_mfma_f32_32x32x16_bf16 v[160:175], a[76:79], a[40:43], v[160:175]
    s_add_u32 s12, s64, 4764672
    ds_read_b64_tr_b16 a[120:121], v235 offset:3072
    ds_read_b64_tr_b16 a[122:123], v237 offset:3072
    v_exp_f32 v156, v156
    v_exp_f32 v157, v157
    v_mfma_f32_32x32x16_bf16 v[160:175], a[80:83], a[44:47], v[160:175]
    buffer_load_dwordx4 a[228:231], v239, s[52:55], s12 offen offset:3072 sc1
    ds_read_b64_tr_b16 a[124:125], v235 offset:4096
    v_cvt_pk_bf16_f32 v178, v148, v149
    v_permlane16_swap_b32 v177, v181
    v_mfma_f32_32x32x16_bf16 v[160:175], a[84:87], a[48:51], v[160:175]
    ds_read_b64_tr_b16 a[126:127], v237 offset:4096
    ds_read_b64_tr_b16 a[128:129], v235 offset:5120
    v_exp_f32 v150, v150
    v_exp_f32 v151, v151
    v_mfma_f32_32x32x16_bf16 v[160:175], a[88:91], a[52:55], v[160:175]
    ds_read_b64_tr_b16 a[130:131], v237 offset:5120
    ds_read_b64_tr_b16 a[132:133], v235 offset:6144
    ds_read_b64_tr_b16 a[134:135], v237 offset:6144
    v_cvt_pk_bf16_f32 v182, v156, v157
    v_exp_f32 v158, v158
    v_mfma_f32_32x32x16_bf16 v[160:175], a[92:95], a[56:59], v[160:175]
    buffer_load_dwordx4 v239, s[8:11], s23 offen offset:1024 sc1 lds
    ds_read_b64_tr_b16 a[136:137], v235 offset:7168
    v_exp_f32 v159, v159
    v_cvt_pk_bf16_f32 v179, v150, v151
    v_mfma_f32_32x32x16_bf16 v[160:175], a[96:99], a[60:63], v[160:175]
    ds_read_b64_tr_b16 a[138:139], v237 offset:7168
    ds_read_b64_tr_b16 a[140:141], v235 offset:8192
    ds_read_b64_tr_b16 a[142:143], v237 offset:8192
    v_permlane16_swap_b32 v178, v182
    v_cvt_pk_bf16_f32 v183, v158, v159
    v_mfma_f32_32x32x16_bf16 v[160:175], a[100:103], a[64:67], v[160:175]
    buffer_load_dwordx4 v239, s[8:11], s24 offen offset:2048 sc1 lds
    v_permlane16_swap_b32 v179, v183
    v_rcp_f32 v240, v240
    v_mfma_f32_32x32x16_bf16 v[160:175], a[104:107], a[68:71], v[160:175]
    s_waitcnt vmcnt(25) lgkmcnt(0)
    v_rcp_f32 v241, v241
    v_rcp_f32 v242, v242
    v_rcp_f32 v243, v243
    v_mfma_f32_16x16x32_bf16 v[0:3], a[108:111], v[176:179], v[0:3]
    ds_read_b128 a[72:75], v233 offset:36864
    v_mfma_f32_16x16x32_bf16 v[36:39], a[108:111], v[180:183], v[36:39]
    ds_read_b128 a[76:79], v233 offset:37888
    v_mfma_f32_16x16x32_bf16 v[4:7], a[112:115], v[176:179], v[4:7]
L_padm4:
    s_cbranch_execz L_walked1
    ds_read_b128 a[80:83], v233 offset:38912
    v_mul_f32 v224, v224, v240
    v_mfma_f32_16x16x32_bf16 v[40:43], a[112:115], v[180:183], v[40:43]
    buffer_load_dwordx4 v239, s[8:11], s25 offen offset:3072 sc1 lds
    v_mfma_f32_16x16x32_bf16 v[8:11], a[116:119], v[176:179], v[8:11]
    ds_read_b128 a[84:87], v233 offset:39936
    v_mul_f32 v225, v225, v241
    v_mfma_f32_16x16x32_bf16 v[44:47], a[116:119], v[180:183], v[44:47]
    ds_read_b128 a[88:91], v233 offset:40960
    v_mul_f32 v226, v226, v242
    v_mfma_f32_16x16x32_bf16 v[12:15], a[120:123], v[176:179], v[12:15]
    ds_read_b128 a[92:95], v233 offset:41984
    v_mul_f32 v227, v227, v243
    v_mfma_f32_16x16x32_bf16 v[48:51], a[120:123], v[180:183], v[48:51]
    v_exp_f32 v160, v160
    v_mfma_f32_16x16x32_bf16 v[16:19], a[124:127], v[176:179], v[16:19]
    buffer_load_dwordx4 a[224:227], v239, s[52:55], s12 offen offset:2048 sc1
    v_mfma_f32_16x16x32_bf16 v[52:55], a[124:127], v[180:183], v[52:55]
    v_exp_f32 v161, v161
    v_mfma_f32_16x16x32_bf16 v[20:23], a[128:131], v[176:179], v[20:23]
    s_add_u32 m0, s64, 45056
    ds_read_b128 a[96:99], v233 offset:43008
    v_cvt_pk_bf16_f32 v208, v224, v225
    v_mfma_f32_16x16x32_bf16 v[56:59], a[128:131], v[180:183], v[56:59]
    buffer_load_dwordx4 v239, s[8:11], s26 offen offset:0 sc1 lds
    ds_read_b128 a[100:103], v233 offset:44032
    v_mfma_f32_16x16x32_bf16 v[24:27], a[132:135], v[176:179], v[24:27]
    s_add_u32 s8, s8, s91
    s_addc_u32 s9, s9, -1
    ds_read_b128 a[104:107], v233 offset:45056
    v_mfma_f32_16x16x32_bf16 v[60:63], a[132:135], v[180:183], v[60:63]
    s_sub_u32 s10, s10, s91
    v_exp_f32 v168, v168
    v_mfma_f32_16x16x32_bf16 v[28:31], a[136:139], v[176:179], v[28:31]
    s_max_i32 s10, s10, 0
    v_exp_f32 v169, v169
    v_mfma_f32_16x16x32_bf16 v[64:67], a[136:139], v[180:183], v[64:67]
    s_add_u32 m0, s64, 73728
    v_cvt_pk_bf16_f32 v184, v160, v161
    v_exp_f32 v162, v162
    v_mfma_f32_16x16x32_bf16 v[32:35], a[140:143], v[176:179], v[32:35]
    v_exp_f32 v163, v163
    v_mfma_f32_16x16x32_bf16 v[68:71], a[140:143], v[180:183], v[68:71]
    s_waitcnt lgkmcnt(0)
    v_cvt_pk_bf16_f32 v209, v226, v227
    v_mfma_f32_32x32x16_bf16 v[144:159], a[72:75], a[0:3], 0
    v_cvt_pk_bf16_f32 v188, v168, v169
    v_exp_f32 v170, v170
    v_exp_f32 v171, v171
    v_mfma_f32_32x32x16_bf16 v[144:159], a[76:79], a[4:7], v[144:159]
    v_cvt_pk_bf16_f32 v185, v162, v163
    v_permlane16_swap_b32 v184, v188
    v_exp_f32 v164, v164
    v_mfma_f32_32x32x16_bf16 v[144:159], a[80:83], a[8:11], v[144:159]
    buffer_load_dwordx4 v239, s[8:11], s18 offen offset:0 sc1 lds
    v_exp_f32 v165, v165
    v_bfe_u32 v247, v231, 3, 4
    v_lshrrev_b32 v249, 7, v231
    v_mfma_f32_32x32x16_bf16 v[144:159], a[84:87], a[12:15], v[144:159]
    s_lshr_b32 s68, s3, 1
    v_cvt_pk_bf16_f32 v189, v170, v171
    v_exp_f32 v172, v172
    v_exp_f32 v173, v173
    v_cvt_pk_bf16_f32 v186, v164, v165
    v_mfma_f32_32x32x16_bf16 v[144:159], a[88:91], a[16:19], v[144:159]
    buffer_store_dwordx2 v[208:209], v231, s[44:47], s72 offen sc1
    v_permlane16_swap_b32 v185, v189
    v_exp_f32 v166, v166
    v_mfma_f32_32x32x16_bf16 v[144:159], a[92:95], a[20:23], v[144:159]
    s_mul_i32 s69, s73, 4608
    v_exp_f32 v167, v167
    v_cvt_pk_bf16_f32 v190, v172, v173
    v_exp_f32 v174, v174
    v_add_u32 v217, s64, v239
    v_mfma_f32_32x32x16_bf16 v[144:159], a[96:99], a[24:27], v[144:159]
    s_add_u32 s70, s64, 40960
    v_exp_f32 v175, v175
    v_cvt_pk_bf16_f32 v187, v166, v167
    v_permlane16_swap_b32 v186, v190
    v_cvt_pk_bf16_f32 v191, v174, v175
    v_mfma_f32_32x32x16_bf16 v[144:159], a[100:103], a[28:31], v[144:159]
    buffer_load_dwordx4 v239, s[8:11], s19 offen offset:1024 sc1 lds
    v_permlane16_swap_b32 v187, v191
    v_add_u32 v218, s70, v231
    v_mfma_f32_32x32x16_bf16 v[144:159], a[104:107], a[32:35], v[144:159]
    buffer_load_dwordx4 v239, s[8:11], s20 offen offset:2048 sc1 lds
    s_xor_b32 s70, s3, 1
    s_mul_i32 s70, s70, 9216
    v_add_u32 v219, s70, v239
    v_mfma_f32_16x16x32_bf16 v[72:75], a[108:111], v[184:187], v[72:75]
    s_xor_b32 s70, s3, 2
    v_mfma_f32_16x16x32_bf16 v[108:111], a[108:111], v[188:191], v[108:111]
    s_mul_i32 s70, s70, 9216
    v_add_u32 v212, s70, v239
    v_mfma_f32_16x16x32_bf16 v[76:79], a[112:115], v[184:187], v[76:79]
    s_xor_b32 s70, s3, 3
    ds_read_b64_tr_b16 a[108:109], v235 offset:36864
    ds_read_b64_tr_b16 a[110:111], v237 offset:36864
    v_mfma_f32_16x16x32_bf16 v[112:115], a[112:115], v[188:191], v[112:115]
    s_mul_i32 s70, s70, 9216
    ds_read_b64_tr_b16 a[112:113], v235 offset:37888
    v_add_u32 v213, s70, v239
    v_mfma_f32_16x16x32_bf16 v[80:83], a[116:119], v[184:187], v[80:83]
    buffer_load_dwordx4 a[220:223], v239, s[52:55], s12 offen offset:1024 sc1
    v_mfma_f32_16x16x32_bf16 v[116:119], a[116:119], v[188:191], v[116:119]
    v_exp_f32 v144, v144
    v_mfma_f32_16x16x32_bf16 v[84:87], a[120:123], v[184:187], v[84:87]
    v_exp_f32 v145, v145
    v_mfma_f32_16x16x32_bf16 v[120:123], a[120:123], v[188:191], v[120:123]
    v_exp_f32 v152, v152
    v_mfma_f32_16x16x32_bf16 v[88:91], a[124:127], v[184:187], v[88:91]
    v_exp_f32 v153, v153
    v_mfma_f32_16x16x32_bf16 v[124:127], a[124:127], v[188:191], v[124:127]
    ds_read_b64_tr_b16 a[114:115], v237 offset:37888
    v_cvt_pk_bf16_f32 v176, v144, v145
    v_mfma_f32_16x16x32_bf16 v[92:95], a[128:131], v[184:187], v[92:95]
    v_exp_f32 v146, v146
    v_mfma_f32_16x16x32_bf16 v[128:131], a[128:131], v[188:191], v[128:131]
    v_exp_f32 v147, v147
    v_mfma_f32_16x16x32_bf16 v[96:99], a[132:135], v[184:187], v[96:99]
    buffer_load_dwordx4 v239, s[8:11], s21 offen offset:3072 sc1 lds
    v_mfma_f32_16x16x32_bf16 v[132:135], a[132:135], v[188:191], v[132:135]
    v_cvt_pk_bf16_f32 v180, v152, v153
    v_exp_f32 v154, v154
    v_mfma_f32_16x16x32_bf16 v[100:103], a[136:139], v[184:187], v[100:103]
    v_exp_f32 v155, v155
    v_mfma_f32_16x16x32_bf16 v[136:139], a[136:139], v[188:191], v[136:139]
    ds_read_b64_tr_b16 a[116:117], v235 offset:38912
    v_cvt_pk_bf16_f32 v177, v146, v147
    v_mfma_f32_16x16x32_bf16 v[104:107], a[140:143], v[184:187], v[104:107]
    v_permlane16_swap_b32 v176, v180
    v_mfma_f32_16x16x32_bf16 v[140:143], a[140:143], v[188:191], v[140:143]
    s_add_u32 m0, s64, 77824
    v_exp_f32 v148, v148
    v_mfma_f32_32x32x16_bf16 v[160:175], a[72:75], a[36:39], 0
    buffer_load_dwordx4 v239, s[8:11], s22 offen offset:0 sc1 lds
    ds_read_b64_tr_b16 a[118:119], v237 offset:38912
    v_exp_f32 v149, v149
    v_cvt_pk_bf16_f32 v181, v154, v155
    v_mfma_f32_32x32x16_bf16 v[160:175], a[76:79], a[40:43], v[160:175]
    ds_read_b64_tr_b16 a[120:121], v235 offset:39936
    ds_read_b64_tr_b16 a[122:123], v237 offset:39936
    v_exp_f32 v156, v156
    v_exp_f32 v157, v157
    v_mfma_f32_32x32x16_bf16 v[160:175], a[80:83], a[44:47], v[160:175]
    buffer_load_dwordx4 a[216:219], v239, s[52:55], s12 offen offset:0 sc1
    ds_read_b64_tr_b16 a[124:125], v235 offset:40960
    v_cvt_pk_bf16_f32 v178, v148, v149
    v_permlane16_swap_b32 v177, v181
    v_mfma_f32_32x32x16_bf16 v[160:175], a[84:87], a[48:51], v[160:175]
    ds_read_b64_tr_b16 a[126:127], v237 offset:40960
    ds_read_b64_tr_b16 a[128:129], v235 offset:41984
    v_exp_f32 v150, v150
    v_exp_f32 v151, v151
    v_mfma_f32_32x32x16_bf16 v[160:175], a[88:91], a[52:55], v[160:175]
    s_lshl_b32 s70, s73, 9
    ds_read_b64_tr_b16 a[130:131], v237 offset:41984
    ds_read_b64_tr_b16 a[132:133], v235 offset:43008
    ds_read_b64_tr_b16 a[134:135], v237 offset:43008
    v_cvt_pk_bf16_f32 v182, v156, v157
    v_exp_f32 v158, v158
    v_mfma_f32_32x32x16_bf16 v[160:175], a[92:95], a[56:59], v[160:175]
    buffer_load_dwordx4 v239, s[8:11], s23 offen offset:1024 sc1 lds
    ds_read_b64_tr_b16 a[136:137], v235 offset:44032
    v_exp_f32 v159, v159
    v_cvt_pk_bf16_f32 v179, v150, v151
    v_mfma_f32_32x32x16_bf16 v[160:175], a[96:99], a[60:63], v[160:175]
    s_add_u32 s70, s70, 40960
    ds_read_b64_tr_b16 a[138:139], v237 offset:44032
    ds_read_b64_tr_b16 a[140:141], v235 offset:45056
    ds_read_b64_tr_b16 a[142:143], v237 offset:45056
    v_permlane16_swap_b32 v178, v182
    v_cvt_pk_bf16_f32 v183, v158, v159
    v_mfma_f32_32x32x16_bf16 v[160:175], a[100:103], a[64:67], v[160:175]
    buffer_load_dwordx4 v239, s[8:11], s24 offen offset:2048 sc1 lds
    v_permlane16_swap_b32 v179, v183
    v_add_u32 v220, s70, v231
    v_mfma_f32_32x32x16_bf16 v[160:175], a[104:107], a[68:71], v[160:175]
    s_waitcnt vmcnt(23) lgkmcnt(0)
    s_mul_i32 s70, s68, 6144
    s_add_u32 s70, s70, 147456
    v_add_u32 v221, s70, v239
    v_add_u32 v223, 160776, v239
    s_lshl_b32 s71, s68, 11
    v_mfma_f32_16x16x32_bf16 v[0:3], a[108:111], v[176:179], v[0:3]
    s_add_u32 s71, s71, s69
    ds_read_b128 a[72:75], v232 offset:0
    v_mfma_f32_16x16x32_bf16 v[36:39], a[108:111], v[180:183], v[36:39]
    s_add_u32 s70, s71, 82944
    ds_read_b128 a[76:79], v232 offset:1024
    v_add_u32 v222, s70, v239
    v_mfma_f32_16x16x32_bf16 v[4:7], a[112:115], v[176:179], v[4:7]
    s_add_u32 s70, s69, 77824
    ds_read_b128 a[80:83], v232 offset:2048
    v_add_u32 v251, s70, v231
    v_mfma_f32_16x16x32_bf16 v[40:43], a[112:115], v[180:183], v[40:43]
    buffer_load_dwordx4 v239, s[8:11], s25 offen offset:3072 sc1 lds
    v_mfma_f32_16x16x32_bf16 v[8:11], a[116:119], v[176:179], v[8:11]
    s_cmp_eq_u32 s68, 0
    s_cselect_b32 s70, 152576, s70
    ds_read_b128 a[84:87], v232 offset:3072
    v_mfma_f32_16x16x32_bf16 v[44:47], a[116:119], v[180:183], v[44:47]
    ds_read_b128 a[88:91], v232 offset:4096
    v_add_u32 v227, s70, v231
    v_mfma_f32_16x16x32_bf16 v[12:15], a[120:123], v[176:179], v[12:15]
    s_add_u32 s70, s69, 73728
    ds_read_b128 a[92:95], v232 offset:5120
    v_add_u32 v250, s70, v239
    v_mfma_f32_16x16x32_bf16 v[48:51], a[120:123], v[180:183], v[48:51]
    s_mov_b32 s12, 4801024
    v_exp_f32 v160, v160
    v_mfma_f32_16x16x32_bf16 v[16:19], a[124:127], v[176:179], v[16:19]
    buffer_load_dwordx2 a[250:251], v231, s[52:55], s12 offen sc1
    v_mfma_f32_16x16x32_bf16 v[52:55], a[124:127], v[180:183], v[52:55]
    v_exp_f32 v161, v161
    v_mfma_f32_16x16x32_bf16 v[20:23], a[128:131], v[176:179], v[20:23]
    ds_read_b128 a[96:99], v232 offset:6144
    v_exp_f32 v168, v168
    v_mfma_f32_16x16x32_bf16 v[56:59], a[128:131], v[180:183], v[56:59]
    ds_read_b128 a[100:103], v232 offset:7168
    v_exp_f32 v169, v169
    v_mfma_f32_16x16x32_bf16 v[24:27], a[132:135], v[176:179], v[24:27]
    s_add_u32 m0, s64, 81920
    ds_read_b128 a[104:107], v232 offset:8192
    v_cvt_pk_bf16_f32 v184, v160, v161
    v_mfma_f32_16x16x32_bf16 v[60:63], a[132:135], v[180:183], v[60:63]
    buffer_load_dwordx4 v239, s[8:11], s26 offen offset:0 sc1 lds
    v_mfma_f32_16x16x32_bf16 v[28:31], a[136:139], v[176:179], v[28:31]
    s_add_u32 s8, s8, 73728
    s_addc_u32 s9, s9, 0
    v_exp_f32 v162, v162
    v_mfma_f32_16x16x32_bf16 v[64:67], a[136:139], v[180:183], v[64:67]
    s_sub_u32 s10, s10, 73728
    s_max_i32 s10, s10, 0
    s_add_u32 m0, s64, 110592
    v_mfma_f32_16x16x32_bf16 v[32:35], a[140:143], v[176:179], v[32:35]
    s_sub_u32 s70, 78336, s69
    v_exp_f32 v163, v163
    v_mfma_f32_16x16x32_bf16 v[68:71], a[140:143], v[180:183], v[68:71]
    s_waitcnt lgkmcnt(0)
    v_add_u32 v252, s70, v239
    v_mfma_f32_32x32x16_bf16 v[144:159], a[72:75], a[0:3], 0
    v_cvt_pk_bf16_f32 v188, v168, v169
    v_exp_f32 v170, v170
    v_exp_f32 v171, v171
    v_cvt_pk_bf16_f32 v185, v162, v163
    v_mfma_f32_32x32x16_bf16 v[144:159], a[76:79], a[4:7], v[144:159]
    s_mov_b32 s12, 4796928
    v_permlane16_swap_b32 v184, v188
    v_exp_f32 v164, v164
    v_exp_f32 v165, v165
    v_mfma_f32_32x32x16_bf16 v[144:159], a[80:83], a[8:11], v[144:159]
    buffer_load_dwordx4 a[246:249], v239, s[52:55], s12 offen offset:3072 sc1
    v_cvt_pk_bf16_f32 v189, v170, v171
    v_exp_f32 v172, v172
    v_mfma_f32_32x32x16_bf16 v[144:159], a[84:87], a[12:15], v[144:159]
    buffer_load_dwordx4 v239, s[8:11], s18 offen offset:0 sc1 lds
    v_exp_f32 v173, v173
    v_mov_b32 v228, s100
    v_mov_b32 v229, s101
    v_mfma_f32_32x32x16_bf16 v[144:159], a[88:91], a[16:19], v[144:159]
    s_add_u32 s70, s70, 4096
    v_cvt_pk_bf16_f32 v186, v164, v165
    v_permlane16_swap_b32 v185, v189
    v_exp_f32 v166, v166
    v_add_u32 v253, s70, v231
    v_mfma_f32_32x32x16_bf16 v[144:159], a[92:95], a[20:23], v[144:159]
    s_lshl_b32 s70, s3, 10
    v_exp_f32 v167, v167
    v_cvt_pk_bf16_f32 v190, v172, v173
    v_exp_f32 v174, v174
    v_mfma_f32_32x32x16_bf16 v[144:159], a[96:99], a[24:27], v[144:159]
    s_add_u32 s70, s70, 73728
    v_exp_f32 v175, v175
    v_cvt_pk_bf16_f32 v187, v166, v167
    v_permlane16_swap_b32 v186, v190
    v_cvt_pk_bf16_f32 v191, v174, v175
    v_mfma_f32_32x32x16_bf16 v[144:159], a[100:103], a[28:31], v[144:159]
    buffer_load_dwordx4 a[242:245], v239, s[52:55], s12 offen offset:2048 sc1
    v_permlane16_swap_b32 v187, v191
    v_add_u32 v226, s70, v239
    v_mul_u32_u24 v240, 288, v247
    v_mfma_f32_32x32x16_bf16 v[144:159], a[104:107], a[32:35], v[144:159]
    s_lshl_b32 s70, s3, 6
    buffer_load_dwordx4 v239, s[8:11], s19 offen offset:1024 sc1 lds
    v_lshl_add_u32 v224, v249, 4, v240
    v_lshl_add_u32 v225, v249, 3, v240
    v_add_u32 v224, s70, v224
    v_mfma_f32_16x16x32_bf16 v[72:75], a[108:111], v[184:187], v[72:75]
    s_add_u32 s70, s69, 256
    v_add_u32 v225, s70, v225
    v_mfma_f32_16x16x32_bf16 v[108:111], a[108:111], v[188:191], v[108:111]
    ds_read_b64_tr_b16 a[108:109], v234 offset:0
    v_mfma_f32_16x16x32_bf16 v[76:79], a[112:115], v[184:187], v[76:79]
    ds_read_b64_tr_b16 a[110:111], v236 offset:0
    v_mfma_f32_16x16x32_bf16 v[112:115], a[112:115], v[188:191], v[112:115]
    s_nop 0
    ds_read_b64_tr_b16 a[112:113], v234 offset:1024
    ds_read_b64_tr_b16 a[114:115], v236 offset:1024
    v_mfma_f32_16x16x32_bf16 v[80:83], a[116:119], v[184:187], v[80:83]
    buffer_load_dwordx4 v239, s[8:11], s20 offen offset:2048 sc1 lds
    v_mfma_f32_16x16x32_bf16 v[116:119], a[116:119], v[188:191], v[116:119]
    v_exp_f32 v144, v144
    v_mfma_f32_16x16x32_bf16 v[84:87], a[120:123], v[184:187], v[84:87]
    v_exp_f32 v145, v145
    v_mfma_f32_16x16x32_bf16 v[120:123], a[120:123], v[188:191], v[120:123]
    v_exp_f32 v152, v152
    v_mfma_f32_16x16x32_bf16 v[88:91], a[124:127], v[184:187], v[88:91]
    v_exp_f32 v153, v153
    v_mfma_f32_16x16x32_bf16 v[124:127], a[124:127], v[188:191], v[124:127]
    s_nop 0
    ds_read_b64_tr_b16 a[116:117], v234 offset:2048
    ds_read_b64_tr_b16 a[118:119], v236 offset:2048
    v_mfma_f32_16x16x32_bf16 v[92:95], a[128:131], v[184:187], v[92:95]
    buffer_load_dwordx4 a[238:241], v239, s[52:55], s12 offen offset:1024 sc1
    v_mfma_f32_16x16x32_bf16 v[128:131], a[128:131], v[188:191], v[128:131]
    buffer_load_dwordx4 v239, s[8:11], s21 offen offset:3072 sc1 lds
    v_mfma_f32_16x16x32_bf16 v[96:99], a[132:135], v[184:187], v[96:99]
    buffer_load_dwordx4 a[234:237], v239, s[52:55], s12 offen offset:0 sc1
    s_add_u32 m0, s64, 114688
    v_mfma_f32_16x16x32_bf16 v[132:135], a[132:135], v[188:191], v[132:135]
    ds_read_b64_tr_b16 a[120:121], v234 offset:3072
    v_cvt_pk_bf16_f32 v176, v144, v145
    v_mfma_f32_16x16x32_bf16 v[100:103], a[136:139], v[184:187], v[100:103]
    s_mul_i32 s70, s67, 9216
    v_exp_f32 v146, v146
    v_mfma_f32_16x16x32_bf16 v[136:139], a[136:139], v[188:191], v[136:139]
    s_add_u32 s56, s71, s70
    v_exp_f32 v147, v147
    v_mfma_f32_16x16x32_bf16 v[104:107], a[140:143], v[184:187], v[104:107]
    s_add_u32 s70, s70, s69
    ds_read_b64_tr_b16 a[122:123], v236 offset:3072
    v_cvt_pk_bf16_f32 v180, v152, v153
    v_mfma_f32_16x16x32_bf16 v[140:143], a[140:143], v[188:191], v[140:143]
    s_add_u32 s70, s70, 4096
    v_exp_f32 v154, v154
    v_mfma_f32_32x32x16_bf16 v[160:175], a[72:75], a[36:39], 0
    s_cmp_eq_u32 s68, 0
    s_cselect_b32 s57, 0x7fff0000, s70
    ds_read_b64_tr_b16 a[124:125], v234 offset:4096
    ds_read_b64_tr_b16 a[126:127], v236 offset:4096
    v_exp_f32 v155, v155
    v_cvt_pk_bf16_f32 v177, v146, v147
    v_mfma_f32_32x32x16_bf16 v[160:175], a[76:79], a[40:43], v[160:175]
    ds_read_b64_tr_b16 a[128:129], v234 offset:5120
    ds_read_b64_tr_b16 a[130:131], v236 offset:5120
    v_permlane16_swap_b32 v176, v180
    v_exp_f32 v148, v148
    v_mfma_f32_32x32x16_bf16 v[160:175], a[80:83], a[44:47], v[160:175]
    ds_read_b64_tr_b16 a[132:133], v234 offset:6144
    v_exp_f32 v149, v149
    v_cvt_pk_bf16_f32 v181, v154, v155
    v_exp_f32 v156, v156
    v_mfma_f32_32x32x16_bf16 v[160:175], a[84:87], a[48:51], v[160:175]
    buffer_load_dwordx4 v239, s[8:11], s22 offen offset:0 sc1 lds
    v_exp_f32 v157, v157
    v_cvt_pk_bf16_f32 v178, v148, v149
    v_permlane16_swap_b32 v177, v181
    v_mfma_f32_32x32x16_bf16 v[160:175], a[88:91], a[52:55], v[160:175]
    ds_read_b64_tr_b16 a[134:135], v236 offset:6144
    ds_read_b64_tr_b16 a[136:137], v234 offset:7168
    v_exp_f32 v150, v150
    v_exp_f32 v151, v151
    v_mfma_f32_32x32x16_bf16 v[160:175], a[92:95], a[56:59], v[160:175]
    buffer_load_dwordx4 v239, s[8:11], s23 offen offset:1024 sc1 lds
    v_cvt_pk_bf16_f32 v182, v156, v157
    v_exp_f32 v158, v158
    v_exp_f32 v159, v159
    v_mfma_f32_32x32x16_bf16 v[160:175], a[96:99], a[60:63], v[160:175]
    s_mov_b32 s12, 4759552
    ds_read_b64_tr_b16 a[138:139], v236 offset:7168
    ds_read_b64_tr_b16 a[140:141], v234 offset:8192
    ds_read_b64_tr_b16 a[142:143], v236 offset:8192
    v_cvt_pk_bf16_f32 v179, v150, v151
    v_permlane16_swap_b32 v178, v182
    v_cvt_pk_bf16_f32 v183, v158, v159
    v_mfma_f32_32x32x16_bf16 v[160:175], a[100:103], a[64:67], v[160:175]
    buffer_load_dwordx2 a[196:197], v231, s[52:55], s12 offen sc1
    v_permlane16_swap_b32 v179, v183
    v_add_u32 v240, -1, v247
    v_add_u32 v241, 1, v247
    v_mfma_f32_32x32x16_bf16 v[160:175], a[104:107], a[68:71], v[160:175]
    s_waitcnt vmcnt(24) lgkmcnt(0)
    s_movk_i32 s68, 4352
    v_ashrrev_i32 v240, 4, v240
    v_lshrrev_b32 v241, 4, v241
    s_movk_i32 s69, 4480
    v_mad_i32_i24 v214, v240, s68, v239
    v_mad_i32_i24 v215, v241, s68, v239
    v_mfma_f32_16x16x32_bf16 v[0:3], a[108:111], v[176:179], v[0:3]
    buffer_load_dwordx4 v239, s[8:11], s24 offen offset:2048 sc1 lds
    v_mfma_f32_16x16x32_bf16 v[36:39], a[108:111], v[180:183], v[36:39]
    s_sub_u32 s70, s56, 16
    ds_read_b128 a[72:75], v232 offset:36864
    v_mad_i32_i24 v210, v240, s69, v231
    v_mfma_f32_16x16x32_bf16 v[4:7], a[112:115], v[176:179], v[4:7]
    ds_read_b128 a[76:79], v232 offset:37888
    v_mad_i32_i24 v211, v241, s69, v231
    v_mfma_f32_16x16x32_bf16 v[40:43], a[112:115], v[180:183], v[40:43]
    s_sub_u32 s71, s57, 8
    ds_read_b128 a[80:83], v232 offset:38912
    v_add_u32 v214, s70, v214
    v_mfma_f32_16x16x32_bf16 v[8:11], a[116:119], v[176:179], v[8:11]
    ds_read_b128 a[84:87], v232 offset:39936
    v_add_u32 v210, s71, v210
    v_mfma_f32_16x16x32_bf16 v[44:47], a[116:119], v[180:183], v[44:47]
    s_lshl_b32 s68, s6, 6
    v_exp_f32 v160, v160
    v_mfma_f32_16x16x32_bf16 v[12:15], a[120:123], v[176:179], v[12:15]
    buffer_load_dwordx4 v239, s[8:11], s25 offen offset:3072 sc1 lds
    v_mfma_f32_16x16x32_bf16 v[48:51], a[120:123], v[180:183], v[48:51]
    s_add_u32 s68, s68, s4
    ds_read_b128 a[88:91], v232 offset:40960
    s_lshl_b32 s68, s68, 10
    v_mfma_f32_16x16x32_bf16 v[16:19], a[124:127], v[176:179], v[16:19]
    s_mov_b32 s12, 4755456
    ds_read_b128 a[92:95], v232 offset:41984
    v_exp_f32 v161, v161
    v_mfma_f32_16x16x32_bf16 v[52:55], a[124:127], v[180:183], v[52:55]
    buffer_load_dwordx4 a[192:195], v239, s[52:55], s12 offen offset:3072 sc1
    ds_read_b128 a[96:99], v232 offset:43008
    v_mfma_f32_16x16x32_bf16 v[20:23], a[128:131], v[176:179], v[20:23]
    s_add_u32 s68, s68, 7536640
    v_exp_f32 v168, v168
    v_exp_f32 v169, v169
    v_mfma_f32_16x16x32_bf16 v[56:59], a[128:131], v[180:183], v[56:59]
    s_add_u32 m0, s64, 118784
    ds_read_b128 a[100:103], v232 offset:44032
    v_cvt_pk_bf16_f32 v184, v160, v161
    v_mfma_f32_16x16x32_bf16 v[24:27], a[132:135], v[176:179], v[24:27]
    buffer_load_dwordx4 v239, s[8:11], s26 offen offset:0 sc1 lds
    ds_read_b128 a[104:107], v232 offset:45056
    v_mfma_f32_16x16x32_bf16 v[60:63], a[132:135], v[180:183], v[60:63]
    s_waitcnt vmcnt(26)
    v_exp_f32 v162, v162
    v_mfma_f32_16x16x32_bf16 v[28:31], a[136:139], v[176:179], v[28:31]
    buffer_store_dwordx2 v[228:229], v238, s[52:55], s78 offen sc1
    v_mfma_f32_16x16x32_bf16 v[64:67], a[136:139], v[180:183], v[64:67]
    s_movk_i32 s70, 1408
    v_exp_f32 v163, v163
    v_mfma_f32_16x16x32_bf16 v[32:35], a[140:143], v[176:179], v[32:35]
    s_cmp_eq_u32 s4, 62
    s_cselect_b32 s69, 896, s70
    v_lshlrev_b32 v255, 3, v239
    v_mfma_f32_16x16x32_bf16 v[68:71], a[140:143], v[180:183], v[68:71]
    s_waitcnt lgkmcnt(0)
    v_min_u32 v255, s69, v255
    v_add_u32 v255, s68, v255
    s_cmp_eq_u32 s73, 1
    s_cbranch_scc1 L_dup0
    v_mfma_f32_32x32x16_bf16 v[192:207], a[72:75], a[0:3], 0
    s_add_u32 s40, s16, s65
    s_addc_u32 s41, s17, 0
    v_cvt_pk_bf16_f32 v188, v168, v169
    v_exp_f32 v170, v170
    v_exp_f32 v171, v171
    v_mfma_f32_32x32x16_bf16 v[192:207], a[76:79], a[4:7], v[192:207]
    buffer_load_dwordx4 a[188:191], v239, s[52:55], s12 offen offset:2048 sc1
    v_cvt_pk_bf16_f32 v185, v162, v163
    v_permlane16_swap_b32 v184, v188
    v_exp_f32 v164, v164
    v_mfma_f32_32x32x16_bf16 v[192:207], a[80:83], a[8:11], v[192:207]
    ds_read_b64_tr_b16 a[144:145], v234 offset:36864
    v_exp_f32 v165, v165
    v_cvt_pk_bf16_f32 v189, v170, v171
    v_exp_f32 v172, v172
    v_mfma_f32_32x32x16_bf16 v[192:207], a[84:87], a[12:15], v[192:207]
    ds_read_b64_tr_b16 a[146:147], v236 offset:36864
    v_exp_f32 v173, v173
    v_cvt_pk_bf16_f32 v186, v164, v165
    v_permlane16_swap_b32 v185, v189
    v_mfma_f32_32x32x16_bf16 v[192:207], a[88:91], a[16:19], v[192:207]
    buffer_load_dwordx4 a[184:187], v239, s[52:55], s12 offen offset:1024 sc1
    v_exp_f32 v166, v166
    v_exp_f32 v167, v167
    v_mfma_f32_32x32x16_bf16 v[192:207], a[92:95], a[20:23], v[192:207]
    ds_read_b64_tr_b16 a[148:149], v234 offset:37888
    v_cvt_pk_bf16_f32 v190, v172, v173
    v_exp_f32 v174, v174
    v_exp_f32 v175, v175
    v_mfma_f32_32x32x16_bf16 v[192:207], a[96:99], a[24:27], v[192:207]
    buffer_load_dwordx4 a[180:183], v239, s[52:55], s12 offen offset:0 sc1
    v_cvt_pk_bf16_f32 v187, v166, v167
    v_permlane16_swap_b32 v186, v190
    v_cvt_pk_bf16_f32 v191, v174, v175
    v_mfma_f32_32x32x16_bf16 v[192:207], a[100:103], a[28:31], v[192:207]
    s_mov_b32 s42, 1152000
    ds_read_b64_tr_b16 a[150:151], v236 offset:37888
    ds_read_b64_tr_b16 a[152:153], v234 offset:38912
    ds_read_b64_tr_b16 a[154:155], v236 offset:38912
    ds_read_b64_tr_b16 a[156:157], v234 offset:39936
    s_add_u32 s12, s64, 4727296
    v_permlane16_swap_b32 v187, v191
    v_mfma_f32_32x32x16_bf16 v[192:207], a[104:107], a[32:35], v[192:207]
    s_waitcnt vmcnt(19)
    ds_read_b64_tr_b16 a[158:159], v236 offset:39936
    ds_read_b64_tr_b16 a[160:161], v234 offset:45056
    ds_read_b64_tr_b16 a[162:163], v236 offset:45056
    buffer_load_dwordx2 a[178:179], v231, s[52:55], s12 offen sc1
    s_add_u32 s12, s64, 4723200
    s_branch L_dup0e
L_dup0:
    v_mfma_f32_32x32x16_bf16 v[192:207], a[72:75], a[36:39], 0
    s_add_u32 s40, s16, s65
    s_addc_u32 s41, s17, 0
    v_cvt_pk_bf16_f32 v188, v168, v169
    v_exp_f32 v170, v170
    v_exp_f32 v171, v171
    v_mfma_f32_32x32x16_bf16 v[192:207], a[76:79], a[40:43], v[192:207]
    buffer_load_dwordx4 a[188:191], v239, s[52:55], s12 offen offset:2048 sc1
    v_cvt_pk_bf16_f32 v185, v162, v163
    v_permlane16_swap_b32 v184, v188
    v_exp_f32 v164, v164
    v_mfma_f32_32x32x16_bf16 v[192:207], a[80:83], a[44:47], v[192:207]
    ds_read_b64_tr_b16 a[144:145], v234 offset:36864
    v_exp_f32 v165, v165
    v_cvt_pk_bf16_f32 v189, v170, v171
    v_exp_f32 v172, v172
    v_mfma_f32_32x32x16_bf16 v[192:207], a[84:87], a[48:51], v[192:207]
    ds_read_b64_tr_b16 a[146:147], v236 offset:36864
    v_exp_f32 v173, v173
    v_cvt_pk_bf16_f32 v186, v164, v165
    v_permlane16_swap_b32 v185, v189
    v_mfma_f32_32x32x16_bf16 v[192:207], a[88:91], a[52:55], v[192:207]
    buffer_load_dwordx4 a[184:187], v239, s[52:55], s12 offen offset:1024 sc1
    v_exp_f32 v166, v166
    v_exp_f32 v167, v167
    v_mfma_f32_32x32x16_bf16 v[192:207], a[92:95], a[56:59], v[192:207]
    ds_read_b64_tr_b16 a[148:149], v234 offset:37888
    v_cvt_pk_bf16_f32 v190, v172, v173
    v_exp_f32 v174, v174
    v_exp_f32 v175, v175
    v_mfma_f32_32x32x16_bf16 v[192:207], a[96:99], a[60:63], v[192:207]
    buffer_load_dwordx4 a[180:183], v239, s[52:55], s12 offen offset:0 sc1
    v_cvt_pk_bf16_f32 v187, v166, v167
    v_permlane16_swap_b32 v186, v190
    v_cvt_pk_bf16_f32 v191, v174, v175
    v_mfma_f32_32x32x16_bf16 v[192:207], a[100:103], a[64:67], v[192:207]
    s_mov_b32 s42, 1152000
    ds_read_b64_tr_b16 a[150:151], v236 offset:37888
    ds_read_b64_tr_b16 a[152:153], v234 offset:38912
    ds_read_b64_tr_b16 a[154:155], v236 offset:38912
    ds_read_b64_tr_b16 a[156:157], v234 offset:39936
    s_add_u32 s12, s64, 4727296
    v_permlane16_swap_b32 v187, v191
    v_mfma_f32_32x32x16_bf16 v[192:207], a[104:107], a[68:71], v[192:207]
    s_waitcnt vmcnt(19)
    ds_read_b64_tr_b16 a[158:159], v236 offset:39936
    ds_read_b64_tr_b16 a[160:161], v234 offset:45056
    ds_read_b64_tr_b16 a[162:163], v236 offset:45056
    buffer_load_dwordx2 a[178:179], v231, s[52:55], s12 offen sc1
    s_add_u32 s12, s64, 4723200
L_dup0e:
    v_mfma_f32_16x16x32_bf16 v[72:75], a[108:111], v[184:187], v[72:75]
    s_mov_b32 s43, 0x20000
    ds_read_b128 a[72:75], v233 offset:0
    v_mfma_f32_16x16x32_bf16 v[108:111], a[108:111], v[188:191], v[108:111]
    s_add_u32 s62, s65, 2359296
    ds_read_b128 a[76:79], v233 offset:1024
    v_mfma_f32_16x16x32_bf16 v[76:79], a[112:115], v[184:187], v[76:79]
    s_add_u32 s44, s38, s62
    s_addc_u32 s45, s39, 0
    ds_read_b128 a[80:83], v233 offset:2048
    v_mfma_f32_16x16x32_bf16 v[112:115], a[112:115], v[188:191], v[112:115]
    s_mov_b32 s46, 1152000
    ds_read_b64_tr_b16 a[108:109], v235 offset:0
    ds_read_b64_tr_b16 a[110:111], v237 offset:0
    v_mfma_f32_16x16x32_bf16 v[80:83], a[116:119], v[184:187], v[80:83]
    s_mov_b32 s47, 0x20000
    ds_read_b64_tr_b16 a[112:113], v235 offset:1024
    ds_read_b64_tr_b16 a[114:115], v237 offset:1024
    v_mfma_f32_16x16x32_bf16 v[116:119], a[116:119], v[188:191], v[116:119]
    s_add_u32 s62, s65, 7667712
    ds_read_b64_tr_b16 a[116:117], v235 offset:2048
    ds_read_b64_tr_b16 a[118:119], v237 offset:2048
    v_mfma_f32_16x16x32_bf16 v[84:87], a[120:123], v[184:187], v[84:87]
    buffer_load_dwordx4 a[174:177], v239, s[52:55], s12 offen offset:3072 sc1
    ds_read_b128 a[84:87], v233 offset:3072
    v_mfma_f32_16x16x32_bf16 v[120:123], a[120:123], v[188:191], v[120:123]
    s_add_u32 s48, s38, s62
    s_addc_u32 s49, s39, 0
    ds_read_b128 a[88:91], v233 offset:4096
    v_mfma_f32_16x16x32_bf16 v[88:91], a[124:127], v[184:187], v[88:91]
    ds_read_b128 a[92:95], v233 offset:5120
    v_exp_f32 v192, v192
    v_mfma_f32_16x16x32_bf16 v[124:127], a[124:127], v[188:191], v[124:127]
    ds_read_b128 a[96:99], v233 offset:6144
    v_exp_f32 v193, v193
    v_mfma_f32_16x16x32_bf16 v[92:95], a[128:131], v[184:187], v[92:95]
    ds_read_b128 a[100:103], v233 offset:7168
    v_exp_f32 v200, v200
    v_mfma_f32_16x16x32_bf16 v[128:131], a[128:131], v[188:191], v[128:131]
    buffer_load_dwordx4 a[170:173], v239, s[52:55], s12 offen offset:2048 sc1
    ds_read_b128 a[104:107], v233 offset:8192
    v_mfma_f32_16x16x32_bf16 v[96:99], a[132:135], v[184:187], v[96:99]
    v_exp_f32 v201, v201
    v_mfma_f32_16x16x32_bf16 v[132:135], a[132:135], v[188:191], v[132:135]
    s_mov_b32 s50, 1152000
    v_exp_f32 v194, v194
    v_mfma_f32_16x16x32_bf16 v[100:103], a[136:139], v[184:187], v[100:103]
    buffer_load_dwordx4 a[166:169], v239, s[52:55], s12 offen offset:1024 sc1
    v_mfma_f32_16x16x32_bf16 v[136:139], a[136:139], v[188:191], v[136:139]
    s_lshl_b32 s60, s3, 12
    ds_read_b64_tr_b16 a[120:121], v235 offset:3072
    ds_read_b64_tr_b16 a[122:123], v237 offset:3072
    v_mfma_f32_16x16x32_bf16 v[104:107], a[140:143], v[184:187], v[104:107]
    s_min_u32 s60, s60, 10240
    ds_read_b64_tr_b16 a[124:125], v235 offset:4096
    ds_read_b64_tr_b16 a[126:127], v237 offset:4096
    v_mfma_f32_16x16x32_bf16 v[140:143], a[140:143], v[188:191], v[140:143]
    s_waitcnt lgkmcnt(4)
    ds_read_b64_tr_b16 a[128:129], v235 offset:5120
    s_add_u32 m0, s60, 147456
L_padm5:
    s_cbranch_execz L_walked1
    v_mfma_f32_32x32x16_bf16 v[144:159], a[72:75], a[0:3], 0
    s_add_u32 s60, s60, 4816896
    v_exp_f32 v195, v195
    v_exp_f32 v202, v202
    v_exp_f32 v203, v203
    v_mfma_f32_32x32x16_bf16 v[144:159], a[76:79], a[4:7], v[144:159]
    s_waitcnt vmcnt(8)
    buffer_load_dwordx4 v239, s[52:55], s60 offen offset:0 sc1 lds
    v_exp_f32 v196, v196
    v_exp_f32 v197, v197
    v_mfma_f32_32x32x16_bf16 v[144:159], a[80:83], a[8:11], v[144:159]
    s_mov_b32 s51, 0x20000
    v_exp_f32 v204, v204
    v_exp_f32 v205, v205
    v_exp_f32 v198, v198
    v_mfma_f32_32x32x16_bf16 v[144:159], a[84:87], a[12:15], v[144:159]
    s_xor_b32 s68, s2, 5
    v_exp_f32 v199, v199
    v_exp_f32 v206, v206
    v_exp_f32 v207, v207
    v_mfma_f32_32x32x16_bf16 v[144:159], a[88:91], a[16:19], v[144:159]
    buffer_load_dwordx4 v239, s[52:55], s60 offen offset:1024 sc1 lds
    ds_read_b128 a[72:75], v233 offset:36864
    v_cvt_pk_bf16_f32 v184, v192, v193
    v_cvt_pk_bf16_f32 v188, v200, v201
    v_cvt_pk_bf16_f32 v185, v194, v195
    v_mfma_f32_32x32x16_bf16 v[144:159], a[92:95], a[20:23], v[144:159]
    s_mul_i32 s68, s68, 10240
    ds_read_b128 a[76:79], v233 offset:37888
    ds_read_b128 a[80:83], v233 offset:38912
    v_cvt_pk_bf16_f32 v189, v202, v203
    v_permlane16_swap_b32 v184, v188
    v_cvt_pk_bf16_f32 v186, v196, v197
    v_mfma_f32_32x32x16_bf16 v[144:159], a[96:99], a[24:27], v[144:159]
    buffer_load_dwordx4 v239, s[52:55], s60 offen offset:2048 sc1 lds
    ds_read_b128 a[84:87], v233 offset:39936
    v_cvt_pk_bf16_f32 v190, v204, v205
    v_permlane16_swap_b32 v185, v189
    v_cvt_pk_bf16_f32 v187, v198, v199
    v_mfma_f32_32x32x16_bf16 v[144:159], a[100:103], a[28:31], v[144:159]
    s_add_u32 s68, s68, 4849664
    ds_read_b128 a[88:91], v233 offset:40960
    ds_read_b128 a[92:95], v233 offset:41984
    v_cvt_pk_bf16_f32 v191, v206, v207
    v_permlane16_swap_b32 v186, v190
    s_nop 0
    v_permlane16_swap_b32 v187, v191
    v_mfma_f32_32x32x16_bf16 v[144:159], a[104:107], a[32:35], v[144:159]
    s_lshl_b32 s69, s73, 9
    ds_read_b64_tr_b16 a[130:131], v237 offset:5120
    ds_read_b64_tr_b16 a[132:133], v235 offset:6144
    ds_read_b64_tr_b16 a[134:135], v237 offset:6144
    ds_read_b64_tr_b16 a[136:137], v235 offset:7168
    s_cmp_eq_u32 s73, 1
    s_cbranch_scc1 L_dup36
    v_mfma_f32_16x16x32_bf16 v[0:3], a[144:147], v[184:187], v[0:3]
    buffer_load_dwordx4 v239, s[52:55], s60 offen offset:3072 sc1 lds
    ds_read_b128 a[96:99], v233 offset:43008
    v_mfma_f32_16x16x32_bf16 v[36:39], a[144:147], v[188:191], v[36:39]
    s_add_u32 s71, s69, s76
    ds_read_b64_tr_b16 a[138:139], v237 offset:7168
    ds_read_b64_tr_b16 a[140:141], v235 offset:8192
    v_mfma_f32_16x16x32_bf16 v[4:7], a[148:151], v[184:187], v[4:7]
    s_add_u32 s69, s69, s68
    ds_read_b128 a[100:103], v233 offset:44032
    v_mfma_f32_16x16x32_bf16 v[40:43], a[148:151], v[188:191], v[40:43]
    s_add_u32 s69, s69, 8192
    ds_read_b128 a[104:107], v233 offset:45056
    v_mfma_f32_16x16x32_bf16 v[8:11], a[152:155], v[184:187], v[8:11]
    buffer_load_dwordx2 v[228:229], v255, s[52:55], 0 offen sc1
    v_mfma_f32_16x16x32_bf16 v[44:47], a[152:155], v[188:191], v[44:47]
    s_add_u32 s71, s71, 8192
    v_exp_f32 v144, v144
    v_mfma_f32_16x16x32_bf16 v[12:15], a[156:159], v[184:187], v[12:15]
    s_lshl_b32 s70, s3, 11
    v_exp_f32 v145, v145
    v_mfma_f32_16x16x32_bf16 v[48:51], a[156:159], v[188:191], v[48:51]
    s_waitcnt lgkmcnt(0)
    v_exp_f32 v152, v152
    s_cmp_ge_u32 s3, 2
    s_cbranch_scc1 L_dup36e
    v_mfma_f32_16x16x32_bf16 v[32:35], a[160:163], v[184:187], v[32:35]
    v_mfma_f32_16x16x32_bf16 v[68:71], a[160:163], v[188:191], v[68:71]
    s_branch L_dup36e
L_dup36:
    v_mfma_f32_16x16x32_bf16 v[72:75], a[144:147], v[184:187], v[72:75]
    buffer_load_dwordx4 v239, s[52:55], s60 offen offset:3072 sc1 lds
    ds_read_b128 a[96:99], v233 offset:43008
    v_mfma_f32_16x16x32_bf16 v[108:111], a[144:147], v[188:191], v[108:111]
    s_add_u32 s71, s69, s76
    ds_read_b64_tr_b16 a[138:139], v237 offset:7168
    ds_read_b64_tr_b16 a[140:141], v235 offset:8192
    v_mfma_f32_16x16x32_bf16 v[76:79], a[148:151], v[184:187], v[76:79]
    s_add_u32 s69, s69, s68
    ds_read_b128 a[100:103], v233 offset:44032
    v_mfma_f32_16x16x32_bf16 v[112:115], a[148:151], v[188:191], v[112:115]
    s_add_u32 s69, s69, 8192
    ds_read_b128 a[104:107], v233 offset:45056
    v_mfma_f32_16x16x32_bf16 v[80:83], a[152:155], v[184:187], v[80:83]
    buffer_load_dwordx2 v[228:229], v255, s[52:55], 0 offen sc1
    v_mfma_f32_16x16x32_bf16 v[116:119], a[152:155], v[188:191], v[116:119]
    s_add_u32 s71, s71, 8192
    v_exp_f32 v144, v144
    v_mfma_f32_16x16x32_bf16 v[84:87], a[156:159], v[184:187], v[84:87]
    s_lshl_b32 s70, s3, 11
    v_exp_f32 v145, v145
    v_mfma_f32_16x16x32_bf16 v[120:123], a[156:159], v[188:191], v[120:123]
    s_waitcnt lgkmcnt(0)
    v_exp_f32 v152, v152
    s_cmp_ge_u32 s3, 2
    s_cbranch_scc1 L_dup36e
    v_mfma_f32_16x16x32_bf16 v[104:107], a[160:163], v[184:187], v[104:107]
    v_mfma_f32_16x16x32_bf16 v[140:143], a[160:163], v[188:191], v[140:143]
L_dup36e:
    v_mfma_f32_32x32x16_bf16 v[160:175], a[72:75], a[0:3], 0
    s_add_u32 s68, s68, s70
    v_exp_f32 v153, v153
    v_cvt_pk_bf16_f32 v176, v144, v145
    v_exp_f32 v146, v146
    v_exp_f32 v147, v147
    v_mfma_f32_32x32x16_bf16 v[160:175], a[76:79], a[4:7], v[160:175]
    buffer_load_dwordx4 a[162:165], v239, s[52:55], s12 offen offset:0 sc1
    v_cvt_pk_bf16_f32 v180, v152, v153
    v_exp_f32 v154, v154
    v_exp_f32 v155, v155
    v_mfma_f32_32x32x16_bf16 v[160:175], a[80:83], a[8:11], v[160:175]
    s_add_u32 s12, s64, 4722688
    v_cvt_pk_bf16_f32 v177, v146, v147
    v_permlane16_swap_b32 v176, v180
    v_exp_f32 v148, v148
    v_exp_f32 v149, v149
    v_mfma_f32_32x32x16_bf16 v[160:175], a[84:87], a[12:15], v[160:175]
    buffer_load_dwordx2 a[160:161], v231, s[52:55], s12 offen sc1
    v_cvt_pk_bf16_f32 v181, v154, v155
    v_exp_f32 v156, v156
    v_exp_f32 v157, v157
    v_mfma_f32_32x32x16_bf16 v[160:175], a[88:91], a[16:19], v[160:175]
    s_add_u32 s70, s70, s76
    v_cvt_pk_bf16_f32 v178, v148, v149
    v_permlane16_swap_b32 v177, v181
    v_exp_f32 v150, v150
    v_exp_f32 v151, v151
    v_mfma_f32_32x32x16_bf16 v[160:175], a[92:95], a[20:23], v[160:175]
    s_add_u32 s12, s64, 4718592
    ds_read_b64_tr_b16 a[142:143], v237 offset:8192
    v_cvt_pk_bf16_f32 v182, v156, v157
    v_exp_f32 v158, v158
    v_exp_f32 v159, v159
    v_mfma_f32_32x32x16_bf16 v[160:175], a[96:99], a[24:27], v[160:175]
    buffer_load_dwordx4 a[156:159], v239, s[52:55], s12 offen offset:3072 sc1
    v_cvt_pk_bf16_f32 v179, v150, v151
    v_permlane16_swap_b32 v178, v182
    v_cvt_pk_bf16_f32 v183, v158, v159
    v_mfma_f32_32x32x16_bf16 v[160:175], a[100:103], a[28:31], v[160:175]
    s_cmp_ge_u32 s3, 2
    s_cselect_b32 s69, 0x7fff0000, s69
    s_cselect_b32 s71, s71, 0x7fff0000
    v_permlane16_swap_b32 v179, v183
    v_mfma_f32_32x32x16_bf16 v[160:175], a[104:107], a[32:35], v[160:175]
    s_waitcnt lgkmcnt(0)
    s_mul_i32 s13, s67, 9216
    s_mul_i32 s15, s73, 4608
    s_add_u32 s14, s13, s15
    s_sub_u32 s15, s13, s15
    s_add_u32 s15, s15, 4608
    v_mfma_f32_16x16x32_bf16 v[0:3], a[108:111], v[176:179], v[0:3]
    s_cmp_ge_u32 s3, 2
    s_cselect_b32 s72, 0x7fff0000, s13
    v_mfma_f32_16x16x32_bf16 v[36:39], a[108:111], v[180:183], v[36:39]
    buffer_load_dwordx4 a[152:155], v239, s[52:55], s12 offen offset:2048 sc1
    v_mfma_f32_16x16x32_bf16 v[4:7], a[112:115], v[176:179], v[4:7]
    s_nop 0
    ds_read_b64_tr_b16 a[0:1], v235 offset:36864
    ds_read_b64_tr_b16 a[2:3], v237 offset:36864
    v_mfma_f32_16x16x32_bf16 v[40:43], a[112:115], v[180:183], v[40:43]
    s_nop 0
    ds_read_b64_tr_b16 a[4:5], v235 offset:37888
    ds_read_b64_tr_b16 a[6:7], v237 offset:37888
    v_mfma_f32_16x16x32_bf16 v[8:11], a[116:119], v[176:179], v[8:11]
    s_nop 0
    ds_read_b64_tr_b16 a[8:9], v235 offset:38912
    ds_read_b64_tr_b16 a[10:11], v237 offset:38912
    v_mfma_f32_16x16x32_bf16 v[44:47], a[116:119], v[180:183], v[44:47]
    s_nop 0
    ds_read_b64_tr_b16 a[12:13], v235 offset:39936
    ds_read_b64_tr_b16 a[14:15], v237 offset:39936
    v_mfma_f32_16x16x32_bf16 v[12:15], a[120:123], v[176:179], v[12:15]
    buffer_load_dwordx4 a[148:151], v239, s[52:55], s12 offen offset:1024 sc1
    v_mfma_f32_16x16x32_bf16 v[48:51], a[120:123], v[180:183], v[48:51]
    s_nop 0
    ds_read_b64_tr_b16 a[16:17], v235 offset:40960
    ds_read_b64_tr_b16 a[18:19], v237 offset:40960
    v_mfma_f32_16x16x32_bf16 v[16:19], a[124:127], v[176:179], v[16:19]
    s_nop 0
    ds_read_b64_tr_b16 a[20:21], v235 offset:41984
    ds_read_b64_tr_b16 a[22:23], v237 offset:41984
    v_mfma_f32_16x16x32_bf16 v[52:55], a[124:127], v[180:183], v[52:55]
    v_exp_f32 v160, v160
    v_mfma_f32_16x16x32_bf16 v[20:23], a[128:131], v[176:179], v[20:23]
    v_exp_f32 v161, v161
    v_mfma_f32_16x16x32_bf16 v[56:59], a[128:131], v[180:183], v[56:59]
    v_exp_f32 v168, v168
    v_mfma_f32_16x16x32_bf16 v[24:27], a[132:135], v[176:179], v[24:27]
    buffer_load_dwordx4 a[144:147], v239, s[52:55], s12 offen offset:0 sc1
    v_mfma_f32_16x16x32_bf16 v[60:63], a[132:135], v[180:183], v[60:63]
    v_exp_f32 v169, v169
    v_mfma_f32_16x16x32_bf16 v[28:31], a[136:139], v[176:179], v[28:31]
    ds_read_b64_tr_b16 a[24:25], v235 offset:43008
    v_cvt_pk_bf16_f32 v184, v160, v161
    v_mfma_f32_16x16x32_bf16 v[64:67], a[136:139], v[180:183], v[64:67]
    v_exp_f32 v162, v162
    v_mfma_f32_16x16x32_bf16 v[32:35], a[140:143], v[176:179], v[32:35]
    ds_read_b64_tr_b16 a[26:27], v237 offset:43008
    v_exp_f32 v163, v163
    v_mfma_f32_16x16x32_bf16 v[68:71], a[140:143], v[180:183], v[68:71]
    s_nop 0
    ds_read_b64_tr_b16 a[28:29], v235 offset:44032
    ds_read_b64_tr_b16 a[30:31], v237 offset:44032
L_b14:
L_pady:
    s_cbranch_execz L_walked2
    v_mfma_f32_32x32x16_bf16 v[144:159], a[72:75], a[36:39], 0
    v_cvt_pk_bf16_f32 v188, v168, v169
    v_exp_f32 v170, v170
    v_exp_f32 v171, v171
    v_cvt_pk_bf16_f32 v185, v162, v163
    v_mfma_f32_32x32x16_bf16 v[144:159], a[76:79], a[40:43], v[144:159]
    buffer_load_dwordx4 v[240:243], v224, s[40:43], s14 offen
    v_permlane16_swap_b32 v184, v188
    v_exp_f32 v164, v164
    v_mfma_f32_32x32x16_bf16 v[144:159], a[80:83], a[44:47], v[144:159]
    v_exp_f32 v165, v165
    v_cvt_pk_bf16_f32 v189, v170, v171
    v_exp_f32 v172, v172
    v_mfma_f32_32x32x16_bf16 v[144:159], a[84:87], a[48:51], v[144:159]
    v_exp_f32 v173, v173
    v_cvt_pk_bf16_f32 v186, v164, v165
    v_permlane16_swap_b32 v185, v189
    v_mfma_f32_32x32x16_bf16 v[144:159], a[88:91], a[52:55], v[144:159]
    buffer_load_dwordx4 v[244:247], v224, s[40:43], s15 offen
    ds_read_b64_tr_b16 a[32:33], v235 offset:45056
    ds_read_b64_tr_b16 a[34:35], v237 offset:45056
    v_exp_f32 v166, v166
    v_mfma_f32_32x32x16_bf16 v[144:159], a[92:95], a[56:59], v[144:159]
    v_exp_f32 v167, v167
    v_cvt_pk_bf16_f32 v190, v172, v173
    v_exp_f32 v174, v174
    v_mfma_f32_32x32x16_bf16 v[144:159], a[96:99], a[60:63], v[144:159]
    v_exp_f32 v175, v175
    v_cvt_pk_bf16_f32 v187, v166, v167
    v_permlane16_swap_b32 v186, v190
    v_cvt_pk_bf16_f32 v191, v174, v175
    v_mfma_f32_32x32x16_bf16 v[144:159], a[100:103], a[64:67], v[144:159]
    buffer_load_dwordx2 v[248:249], v225, s[40:43], s13 offen
    v_permlane16_swap_b32 v187, v191
    v_mfma_f32_32x32x16_bf16 v[144:159], a[104:107], a[68:71], v[144:159]
    s_waitcnt vmcnt(9) lgkmcnt(0)
    v_subrev_co_u32 v230, vcc, s0, v228
    v_mov_b32 v206, s1
    s_nop 0
    v_subb_co_u32 v206, vcc, v229, v206, vcc
    v_lshrrev_b32 v230, 28, v230
    v_or_b32 v230, v230, v206
    v_mfma_f32_16x16x32_bf16 v[8:11], a[8:11], v[184:187], v[8:11]
    ds_read_b128 a[72:75], v233 offset:0
    v_mfma_f32_16x16x32_bf16 v[44:47], a[8:11], v[188:191], v[44:47]
    ds_read_b128 a[76:79], v233 offset:1024
    v_mfma_f32_16x16x32_bf16 v[12:15], a[12:15], v[184:187], v[12:15]
    ds_read_b128 a[80:83], v233 offset:2048
    v_mfma_f32_16x16x32_bf16 v[48:51], a[12:15], v[188:191], v[48:51]
    ds_read_b128 a[84:87], v233 offset:3072
    v_cmp_ne_u32 vcc, 0, v230
    v_mfma_f32_16x16x32_bf16 v[16:19], a[16:19], v[184:187], v[16:19]
    ds_read_b128 a[88:91], v233 offset:4096
    v_cvt_pk_bf16_f32 v8, v8, v9
    v_mfma_f32_16x16x32_bf16 v[52:55], a[16:19], v[188:191], v[52:55]
    v_exp_f32 v144, v144
    v_mfma_f32_16x16x32_bf16 v[20:23], a[20:23], v[184:187], v[20:23]
    s_cbranch_vccnz L_pollg
L_gok:
    v_exp_f32 v145, v145
    v_mfma_f32_16x16x32_bf16 v[56:59], a[20:23], v[188:191], v[56:59]
    ds_read_b128 a[92:95], v233 offset:5120
    v_cvt_pk_bf16_f32 v9, v10, v11
    v_mfma_f32_16x16x32_bf16 v[24:27], a[24:27], v[184:187], v[24:27]
    buffer_load_dwordx4 v[192:195], v239, s[48:51], s56 offen offset:0 sc1
    ds_read_b128 a[96:99], v233 offset:6144
    v_mfma_f32_16x16x32_bf16 v[60:63], a[24:27], v[188:191], v[60:63]
    ds_read_b128 a[100:103], v233 offset:7168
    v_cvt_pk_bf16_f32 v10, v12, v13
    v_mfma_f32_16x16x32_bf16 v[28:31], a[28:31], v[184:187], v[28:31]
    ds_read_b128 a[104:107], v233 offset:8192
    v_cvt_pk_bf16_f32 v11, v14, v15
    v_mfma_f32_16x16x32_bf16 v[64:67], a[28:31], v[188:191], v[64:67]
    ds_write_b128 v217, v[8:11] offset:0
    v_cvt_pk_bf16_f32 v44, v44, v45
    v_cvt_pk_bf16_f32 v45, v46, v47
    v_cvt_pk_bf16_f32 v46, v48, v49
    v_cvt_pk_bf16_f32 v47, v50, v51
    v_mfma_f32_16x16x32_bf16 v[32:35], a[32:35], v[184:187], v[32:35]
    ds_write_b128 v217, v[44:47] offset:1024
    v_mfma_f32_16x16x32_bf16 v[68:71], a[32:35], v[188:191], v[68:71]
    buffer_load_dwordx4 v[8:11], v214, s[44:47], 0 offen offset:0 sc1
    v_cvt_pk_bf16_f32 v16, v16, v17
    v_cvt_pk_bf16_f32 v17, v18, v19
    v_mfma_f32_16x16x32_bf16 v[0:3], a[0:3], v[184:187], v[0:3]
    v_exp_f32 v152, v152
    v_cvt_pk_bf16_f32 v18, v20, v21
    v_mfma_f32_16x16x32_bf16 v[36:39], a[0:3], v[188:191], v[36:39]
    v_exp_f32 v153, v153
    v_cvt_pk_bf16_f32 v19, v22, v23
    v_mfma_f32_16x16x32_bf16 v[4:7], a[4:7], v[184:187], v[4:7]
    ds_write_b128 v217, v[16:19] offset:4096
    v_cvt_pk_bf16_f32 v52, v52, v53
    v_cvt_pk_bf16_f32 v53, v54, v55
    v_cvt_pk_bf16_f32 v54, v56, v57
    v_cvt_pk_bf16_f32 v55, v58, v59
    v_mfma_f32_16x16x32_bf16 v[40:43], a[4:7], v[188:191], v[40:43]
    s_waitcnt lgkmcnt(3)
    ds_write_b128 v217, v[52:55] offset:5120
    v_mfma_f32_32x32x16_bf16 v[160:175], a[72:75], a[36:39], 0
    buffer_load_dwordx4 v[12:15], v214, s[44:47], 0 offen offset:1024 sc1
    v_cvt_pk_bf16_f32 v176, v144, v145
    v_exp_f32 v146, v146
    v_exp_f32 v147, v147
    v_cvt_pk_bf16_f32 v24, v24, v25
    v_mfma_f32_32x32x16_bf16 v[160:175], a[76:79], a[40:43], v[160:175]
    v_cvt_pk_bf16_f32 v180, v152, v153
    v_exp_f32 v154, v154
    v_exp_f32 v155, v155
    v_cvt_pk_bf16_f32 v177, v146, v147
    v_cvt_pk_bf16_f32 v25, v26, v27
    v_cvt_pk_bf16_f32 v26, v28, v29
    v_mfma_f32_32x32x16_bf16 v[160:175], a[80:83], a[44:47], v[160:175]
    buffer_load_dwordx4 v[44:47], v215, s[44:47], s56 offen offset:16 sc1
    v_permlane16_swap_b32 v176, v180
    v_exp_f32 v148, v148
    v_exp_f32 v149, v149
    v_mfma_f32_32x32x16_bf16 v[160:175], a[84:87], a[48:51], v[160:175]
    v_cvt_pk_bf16_f32 v181, v154, v155
    v_exp_f32 v156, v156
    v_exp_f32 v157, v157
    v_cvt_pk_bf16_f32 v178, v148, v149
    v_permlane16_swap_b32 v177, v181
    v_cvt_pk_bf16_f32 v27, v30, v31
    v_mfma_f32_32x32x16_bf16 v[160:175], a[88:91], a[52:55], v[160:175]
    buffer_load_dwordx4 v[18:21], v239, s[44:47], s56 offen offset:0 sc1
    ds_write_b128 v217, v[24:27] offset:36864
    v_exp_f32 v150, v150
    v_mfma_f32_32x32x16_bf16 v[160:175], a[92:95], a[56:59], v[160:175]
    v_exp_f32 v151, v151
    v_cvt_pk_bf16_f32 v182, v156, v157
    v_exp_f32 v158, v158
    v_exp_f32 v159, v159
    v_cvt_pk_bf16_f32 v60, v60, v61
    v_mfma_f32_32x32x16_bf16 v[160:175], a[96:99], a[60:63], v[160:175]
    buffer_load_dwordx4 v[48:51], v215, s[44:47], s56 offen offset:1040 sc1
    v_cvt_pk_bf16_f32 v179, v150, v151
    v_permlane16_swap_b32 v178, v182
    v_cvt_pk_bf16_f32 v183, v158, v159
    v_cvt_pk_bf16_f32 v61, v62, v63
    v_cvt_pk_bf16_f32 v62, v64, v65
    v_cvt_pk_bf16_f32 v63, v66, v67
    v_mfma_f32_32x32x16_bf16 v[160:175], a[100:103], a[64:67], v[160:175]
    ds_write_b128 v217, v[60:63] offset:37888
    v_permlane16_swap_b32 v179, v183
    v_cvt_pk_bf16_f32 v32, v32, v33
    v_cvt_pk_bf16_f32 v33, v34, v35
    v_mfma_f32_32x32x16_bf16 v[160:175], a[104:107], a[68:71], v[160:175]
    buffer_load_dwordx4 v[22:25], v239, s[44:47], s56 offen offset:1024 sc1
    ds_write_b64 v218, v[32:33] offset:0
    v_cvt_pk_bf16_f32 v68, v68, v69
    v_cvt_pk_bf16_f32 v69, v70, v71
    v_mfma_f32_16x16x32_bf16 v[72:75], a[0:3], v[176:179], v[72:75]
    ds_write_b64 v218, v[68:69] offset:512
    v_mfma_f32_16x16x32_bf16 v[108:111], a[0:3], v[180:183], v[108:111]
    s_add_u32 s40, s34, s65
    s_addc_u32 s41, s35, 0
    v_mfma_f32_16x16x32_bf16 v[76:79], a[4:7], v[176:179], v[76:79]
    s_waitcnt lgkmcnt(0)
    s_barrier
    ds_read_b64 a[252:253], v223
    ds_read_b64 a[254:255], v223
    ds_read_b64 v[28:29], v220 offset:0
    ds_read_b64 v[30:31], v220 offset:9216
    v_mfma_f32_16x16x32_bf16 v[112:115], a[4:7], v[180:183], v[112:115]
    buffer_load_dwordx4 v[196:199], v239, s[48:51], s56 offen offset:1024 sc1
    ds_read_b64 v[32:33], v220 offset:18432
    ds_read_b64 v[34:35], v220 offset:27648
    ds_read_b128 v[54:57], v219 offset:0
    v_mfma_f32_16x16x32_bf16 v[80:83], a[8:11], v[176:179], v[80:83]
    ds_read_b128 v[144:147], v219 offset:1024
    v_mfma_f32_16x16x32_bf16 v[116:119], a[8:11], v[180:183], v[116:119]
    v_exp_f32 v160, v160
    v_mfma_f32_16x16x32_bf16 v[84:87], a[12:15], v[176:179], v[84:87]
    v_exp_f32 v161, v161
    v_mfma_f32_16x16x32_bf16 v[120:123], a[12:15], v[180:183], v[120:123]
    buffer_load_dwordx2 v[16:17], v210, s[44:47], 0 offen offset:0 sc1
    v_mfma_f32_16x16x32_bf16 v[88:91], a[16:19], v[176:179], v[88:91]
    s_waitcnt lgkmcnt(1)
    v_exp_f32 v168, v168
    v_exp_f32 v169, v169
    v_mfma_f32_16x16x32_bf16 v[66:69], a[252:255], v[28:31], 0
    ds_read_b128 v[58:61], v212 offset:4096
    v_cvt_pk_bf16_f32 v184, v160, v161
    v_mfma_f32_16x16x32_bf16 v[124:127], a[16:19], v[180:183], v[124:127]
    v_exp_f32 v162, v162
    v_mfma_f32_16x16x16_bf16 v[4:7], a[252:253], v[54:55], v[4:7]
    ds_read_b128 v[148:151], v212 offset:5120
    v_exp_f32 v163, v163
    v_mfma_f32_16x16x32_bf16 v[92:95], a[20:23], v[176:179], v[92:95]
    s_waitcnt lgkmcnt(2)
    ds_read_b128 v[62:65], v213 offset:36864
    v_cvt_pk_bf16_f32 v188, v168, v169
    v_mfma_f32_16x16x16_bf16 v[40:43], a[252:253], v[144:145], v[40:43]
    buffer_load_dwordx2 v[26:27], v231, s[44:47], s57 offen offset:0 sc1
    v_mfma_f32_16x16x32_bf16 v[128:131], a[20:23], v[180:183], v[128:131]
    v_exp_f32 v170, v170
    v_exp_f32 v171, v171
    v_mfma_f32_16x16x32_bf16 v[66:69], a[252:255], v[32:35], v[66:69]
    ds_read_b128 v[152:155], v213 offset:37888
    v_cvt_pk_bf16_f32 v185, v162, v163
    v_mfma_f32_16x16x32_bf16 v[96:99], a[24:27], v[176:179], v[96:99]
    s_waitcnt lgkmcnt(2)
    v_permlane16_swap_b32 v184, v188
    v_mfma_f32_16x16x32_bf16 v[0:3], a[252:255], v[56:59], v[0:3]
    v_exp_f32 v164, v164
    v_mfma_f32_16x16x32_bf16 v[132:135], a[24:27], v[180:183], v[132:135]
    buffer_load_dwordx2 v[52:53], v211, s[44:47], s57 offen offset:8 sc1
    v_mfma_f32_16x16x32_bf16 v[36:39], a[252:255], v[146:149], v[36:39]
    v_exp_f32 v165, v165
    v_cvt_pk_bf16_f32 v189, v170, v171
    v_mfma_f32_16x16x32_bf16 v[100:103], a[28:31], v[176:179], v[100:103]
    s_waitcnt lgkmcnt(0)
    v_exp_f32 v172, v172
    v_exp_f32 v173, v173
    v_mfma_f32_16x16x32_bf16 v[4:7], a[252:255], v[60:63], v[4:7]
    v_cvt_pk_bf16_f32 v186, v164, v165
    v_permlane16_swap_b32 v185, v189
    v_mfma_f32_16x16x32_bf16 v[136:139], a[28:31], v[180:183], v[136:139]
    v_exp_f32 v166, v166
    v_exp_f32 v167, v167
    v_mfma_f32_16x16x32_bf16 v[40:43], a[252:255], v[150:153], v[40:43]
    buffer_load_dwordx2 v[200:201], v231, s[48:51], s57 offen offset:0 sc1
    v_cvt_pk_bf16_f32 v190, v172, v173
    v_mfma_f32_16x16x32_bf16 v[104:107], a[32:35], v[176:179], v[104:107]
    v_exp_f32 v174, v174
    v_exp_f32 v175, v175
    v_mfma_f32_16x16x16_bf16 v[0:3], a[252:253], v[64:65], v[0:3]
    v_cvt_pk_bf16_f32 v187, v166, v167
    v_permlane16_swap_b32 v186, v190
    v_mfma_f32_16x16x32_bf16 v[140:143], a[32:35], v[180:183], v[140:143]
    v_cvt_pk_bf16_f32 v191, v174, v175
    s_nop 1
    v_permlane16_swap_b32 v187, v191
    v_mfma_f32_16x16x16_bf16 v[36:39], a[252:253], v[154:155], v[36:39]
    ds_read_b128 a[72:75], v221 offset:0
    v_cvt_pk_bf16_f32 v66, v66, v67
    v_cvt_pk_bf16_f32 v67, v68, v69
    v_mfma_f32_16x16x32_bf16 v[80:83], a[116:119], v[184:187], v[80:83]
    buffer_store_dwordx2 v[66:67], v231, s[52:55], s69 offen sc1
    ds_read_b128 a[76:79], v221 offset:1024
    v_mfma_f32_16x16x32_bf16 v[116:119], a[116:119], v[188:191], v[116:119]
    ds_read_b128 a[80:83], v221 offset:2048
    v_cvt_pk_bf16_f32 v0, v0, v1
    v_cvt_pk_bf16_f32 v1, v2, v3
    v_cvt_pk_bf16_f32 v2, v4, v5
    v_cvt_pk_bf16_f32 v3, v6, v7
    v_mfma_f32_16x16x32_bf16 v[84:87], a[120:123], v[184:187], v[84:87]
    buffer_store_dwordx4 v[0:3], v239, s[52:55], s68 offen offset:0 sc1
    ds_read_b128 a[84:87], v221 offset:3072
    v_mfma_f32_16x16x32_bf16 v[120:123], a[120:123], v[188:191], v[120:123]
    ds_read_b128 a[88:91], v221 offset:4096
    v_cvt_pk_bf16_f32 v36, v36, v37
    v_cvt_pk_bf16_f32 v37, v38, v39
    v_cvt_pk_bf16_f32 v38, v40, v41
    v_cvt_pk_bf16_f32 v39, v42, v43
    v_mfma_f32_16x16x32_bf16 v[88:91], a[124:127], v[184:187], v[88:91]
    buffer_store_dwordx4 v[36:39], v239, s[52:55], s68 offen offset:1024 sc1
    ds_read_b128 a[92:95], v221 offset:5120
    v_mfma_f32_16x16x32_bf16 v[124:127], a[124:127], v[188:191], v[124:127]
    ds_read_b128 a[96:99], v221 offset:6144
    v_cvt_pk_bf16_f32 v80, v80, v81
    v_cvt_pk_bf16_f32 v81, v82, v83
    v_mfma_f32_16x16x32_bf16 v[92:95], a[128:131], v[184:187], v[92:95]
    ds_read_b128 a[100:103], v221 offset:7168
    v_cvt_pk_bf16_f32 v82, v84, v85
    v_cvt_pk_bf16_f32 v83, v86, v87
    v_mfma_f32_16x16x32_bf16 v[128:131], a[128:131], v[188:191], v[128:131]
    ds_write_b128 v217, v[80:83] offset:2048
    v_mfma_f32_16x16x32_bf16 v[96:99], a[132:135], v[184:187], v[96:99]
    v_cvt_pk_bf16_f32 v116, v116, v117
    v_cvt_pk_bf16_f32 v117, v118, v119
    v_mfma_f32_16x16x32_bf16 v[132:135], a[132:135], v[188:191], v[132:135]
    v_cvt_pk_bf16_f32 v118, v120, v121
    v_cvt_pk_bf16_f32 v119, v122, v123
    v_mfma_f32_16x16x32_bf16 v[100:103], a[136:139], v[184:187], v[100:103]
    ds_write_b128 v217, v[116:119] offset:3072
    v_mfma_f32_16x16x32_bf16 v[136:139], a[136:139], v[188:191], v[136:139]
    v_cvt_pk_bf16_f32 v88, v88, v89
    v_cvt_pk_bf16_f32 v89, v90, v91
    v_cvt_pk_bf16_f32 v90, v92, v93
    v_mfma_f32_16x16x32_bf16 v[104:107], a[140:143], v[184:187], v[104:107]
    s_waitcnt lgkmcnt(2)
    v_cvt_pk_bf16_f32 v91, v94, v95
    v_cvt_pk_bf16_f32 v124, v124, v125
    v_cvt_pk_bf16_f32 v125, v126, v127
    v_mfma_f32_16x16x32_bf16 v[140:143], a[140:143], v[188:191], v[140:143]
    s_waitcnt vmcnt(10)
    ds_write_b128 v217, v[88:91] offset:6144
    v_mfma_f32_16x16x16_bf16 v[28:31], a[72:73], v[8:9], 0
    v_cvt_pk_bf16_f32 v126, v128, v129
    v_cvt_pk_bf16_f32 v127, v130, v131
    v_lshlrev_b32 v68, 16, v192
    v_mfma_f32_16x16x16_bf16 v[32:35], a[78:79], v[10:11], 0
    v_cvt_pk_bf16_f32 v96, v96, v97
    v_cvt_pk_bf16_f32 v97, v98, v99
    v_cvt_pk_bf16_f32 v98, v100, v101
    v_mfma_f32_16x16x16_bf16 v[28:31], a[74:75], v[18:19], v[28:31]
    ds_write_b128 v217, v[124:127] offset:7168
    v_mfma_f32_16x16x16_bf16 v[32:35], a[80:81], v[20:21], v[32:35]
    v_cvt_pk_bf16_f32 v99, v102, v103
    v_cvt_pk_bf16_f32 v132, v132, v133
    v_and_b32 v69, s75, v192
    v_mfma_f32_16x16x16_bf16 v[28:31], a[76:77], v[44:45], v[28:31]
    v_cvt_pk_bf16_f32 v133, v134, v135
    v_cvt_pk_bf16_f32 v134, v136, v137
    v_cvt_pk_bf16_f32 v135, v138, v139
    v_mfma_f32_16x16x16_bf16 v[32:35], a[82:83], v[46:47], v[32:35]
    s_waitcnt vmcnt(7)
    ds_write_b128 v217, v[96:99] offset:38912
    v_mfma_f32_16x16x16_bf16 v[54:57], a[84:85], v[12:13], 0
    v_cvt_pk_bf16_f32 v104, v104, v105
    v_cvt_pk_bf16_f32 v105, v106, v107
    v_lshlrev_b32 v70, 16, v193
    v_mfma_f32_16x16x16_bf16 v[58:61], a[90:91], v[14:15], 0
    v_cvt_pk_bf16_f32 v140, v140, v141
    v_cvt_pk_bf16_f32 v141, v142, v143
    v_and_b32 v71, s75, v193
    v_mfma_f32_16x16x16_bf16 v[54:57], a[86:87], v[22:23], v[54:57]
    ds_write_b128 v217, v[132:135] offset:39936
    v_mfma_f32_16x16x16_bf16 v[58:61], a[92:93], v[24:25], v[58:61]
    s_waitcnt vmcnt(3)
    v_mul_f32 v28, v28, v68
    v_mul_f32 v29, v29, v69
    v_mul_f32 v30, v30, v70
    v_mul_f32 v31, v31, v71
    v_cvt_pk_bf16_f32 v192, v28, v29
    v_mfma_f32_16x16x16_bf16 v[62:65], a[96:97], v[16:17], 0
    ds_write_b64 v218, v[104:105] offset:1024
    v_cvt_pk_bf16_f32 v193, v30, v31
    v_lshlrev_b32 v68, 16, v194
    v_mfma_f32_16x16x16_bf16 v[54:57], a[88:89], v[48:49], v[54:57]
    v_and_b32 v69, s75, v194
    v_lshlrev_b32 v70, 16, v195
    v_and_b32 v71, s75, v195
    v_mul_f32 v32, v32, v68
    v_mul_f32 v33, v33, v69
    v_mul_f32 v34, v34, v70
    v_mfma_f32_16x16x16_bf16 v[62:65], a[98:99], v[26:27], v[62:65]
    ds_write_b64 v218, v[140:141] offset:1536
    v_mul_f32 v35, v35, v71
    v_cvt_pk_bf16_f32 v194, v32, v33
    v_cvt_pk_bf16_f32 v195, v34, v35
    v_mfma_f32_16x16x16_bf16 v[58:61], a[94:95], v[50:51], v[58:61]
    ds_write_b128 v222, v[192:195] offset:0
    v_mfma_f32_16x16x16_bf16 v[62:65], a[100:101], v[52:53], v[62:65]
    v_lshlrev_b32 v68, 16, v196
    v_and_b32 v69, s75, v196
    v_lshlrev_b32 v70, 16, v197
    v_and_b32 v71, s75, v197
    v_mfma_f32_16x16x32_bf16 v[72:75], a[108:111], v[184:187], v[72:75]
    v_mul_f32 v54, v54, v68
    v_mul_f32 v55, v55, v69
    v_mul_f32 v56, v56, v70
    v_mul_f32 v57, v57, v71
    v_cvt_pk_bf16_f32 v196, v54, v55
    v_cvt_pk_bf16_f32 v197, v56, v57
    v_mfma_f32_16x16x32_bf16 v[108:111], a[108:111], v[188:191], v[108:111]
    buffer_load_dwordx4 v[176:179], v239, s[52:55], s70 offen sc1
    v_lshlrev_b32 v68, 16, v198
    v_and_b32 v69, s75, v198
    v_lshlrev_b32 v70, 16, v199
    v_and_b32 v71, s75, v199
    v_mfma_f32_16x16x32_bf16 v[76:79], a[112:115], v[184:187], v[76:79]
    v_mul_f32 v58, v58, v68
    v_mul_f32 v59, v59, v69
    v_mul_f32 v60, v60, v70
    v_mul_f32 v61, v61, v71
    v_cvt_pk_bf16_f32 v198, v58, v59
    v_cvt_pk_bf16_f32 v199, v60, v61
    v_mfma_f32_16x16x32_bf16 v[112:115], a[112:115], v[188:191], v[112:115]
    buffer_load_dwordx4 v[180:183], v239, s[52:55], s70 offen offset:1024 sc1
    ds_write_b128 v222, v[196:199] offset:1024
    v_lshlrev_b32 v68, 16, v200
    v_and_b32 v69, s75, v200
    v_lshlrev_b32 v70, 16, v201
    v_and_b32 v71, s75, v201
    buffer_load_dwordx2 v[174:175], v231, s[52:55], s71 offen sc1
    v_mul_f32 v62, v62, v68
    v_mul_f32 v63, v63, v69
    v_mul_f32 v64, v64, v70
    v_mul_f32 v65, v65, v71
    v_cvt_pk_bf16_f32 v200, v62, v63
    v_cvt_pk_bf16_f32 v201, v64, v65
    ds_write_b64 v227, v[200:201] offset:9216
    s_waitcnt lgkmcnt(0)
    s_barrier
    ds_read_b64 v[116:117], v220 offset:1024
    ds_read_b64 v[118:119], v220 offset:10240
    ds_read_b64 v[120:121], v220 offset:19456
    ds_read_b64 v[122:123], v220 offset:28672
    ds_read_b128 v[80:83], v219 offset:2048
    ds_read_b128 v[92:95], v219 offset:3072
    ds_read_b128 v[84:87], v212 offset:6144
    ds_read_b128 v[96:99], v212 offset:7168
    ds_read_b128 v[88:91], v213 offset:38912
    ds_read_b128 v[100:103], v213 offset:39936
    v_mfma_f32_16x16x16_bf16 v[144:147], a[252:253], v[240:241], 0
L_padm6:
    s_cbranch_execz L_walked0
    v_mfma_f32_16x16x16_bf16 v[148:151], a[252:253], v[242:243], 0
    v_mfma_f32_16x16x16_bf16 v[152:155], a[252:253], v[244:245], 0
    v_mfma_f32_16x16x16_bf16 v[156:159], a[252:253], v[246:247], 0
    v_mfma_f32_16x16x16_bf16 v[160:163], a[252:253], v[248:249], 0
    s_waitcnt lgkmcnt(8)
    v_mfma_f32_16x16x32_bf16 v[124:127], a[252:255], v[116:119], 0
    ds_read_b64 v[16:17], v251 offset:9216
    ds_read_b64 v[36:37], v253 offset:9216
    s_waitcnt lgkmcnt(7)
    v_mfma_f32_16x16x16_bf16 v[76:79], a[252:253], v[80:81], v[76:79]
    ds_read_b128 v[0:3], v250 offset:9216
    ds_read_b128 v[20:23], v252 offset:9216
    s_waitcnt lgkmcnt(8)
    v_mfma_f32_16x16x16_bf16 v[112:115], a[252:253], v[92:93], v[112:115]
    ds_read_b128 v[4:7], v250 offset:10240
    ds_read_b128 v[24:27], v252 offset:10240
    v_mfma_f32_16x16x32_bf16 v[124:127], a[252:255], v[120:123], v[124:127]
    ds_read_b128 v[8:11], v250 offset:11264
    ds_read_b128 v[28:31], v252 offset:11264
    s_waitcnt lgkmcnt(11)
    v_mfma_f32_16x16x32_bf16 v[72:75], a[252:255], v[82:85], v[72:75]
    ds_read_b128 v[12:15], v250 offset:12288
    ds_read_b128 v[32:35], v252 offset:12288
    s_waitcnt lgkmcnt(12)
    v_mfma_f32_16x16x32_bf16 v[108:111], a[252:255], v[94:97], v[108:111]
    s_waitcnt lgkmcnt(11)
    v_mfma_f32_16x16x32_bf16 v[76:79], a[252:255], v[86:89], v[76:79]
    s_waitcnt lgkmcnt(10)
    v_mfma_f32_16x16x32_bf16 v[112:115], a[252:255], v[98:101], v[112:115]
    v_mfma_f32_16x16x16_bf16 v[72:75], a[252:253], v[90:91], v[72:75]
    s_nop 0
    v_mfma_f32_16x16x16_bf16 v[108:111], a[252:253], v[102:103], v[108:111]
    s_waitcnt lgkmcnt(8)
    v_mfma_f32_16x16x16_bf16 v[144:147], a[214:215], v[16:17], v[144:147]
    v_mfma_f32_16x16x16_bf16 v[148:151], a[232:233], v[16:17], v[148:151]
    v_mfma_f32_16x16x16_bf16 v[152:155], a[214:215], v[36:37], v[152:155]
    v_mfma_f32_16x16x16_bf16 v[156:159], a[232:233], v[36:37], v[156:159]
    v_mfma_f32_16x16x16_bf16 v[160:163], a[250:251], v[16:17], v[160:163]
    s_waitcnt lgkmcnt(6)
    s_nop 0
    v_mfma_f32_16x16x32_bf16 v[144:147], a[198:201], v[0:3], v[144:147]
    v_mfma_f32_16x16x32_bf16 v[148:151], a[216:219], v[0:3], v[148:151]
    v_mfma_f32_16x16x32_bf16 v[152:155], a[198:201], v[20:23], v[152:155]
    v_mfma_f32_16x16x32_bf16 v[156:159], a[216:219], v[20:23], v[156:159]
    v_mfma_f32_16x16x32_bf16 v[160:163], a[234:237], v[0:3], v[160:163]
    s_waitcnt lgkmcnt(4)
    v_mfma_f32_16x16x32_bf16 v[144:147], a[202:205], v[4:7], v[144:147]
    v_mfma_f32_16x16x32_bf16 v[148:151], a[220:223], v[4:7], v[148:151]
    s_mov_b32 s62, 0
L_pollxc:
    s_waitcnt vmcnt(0)
    v_max3_u32 v228, v174, v176, v180
    v_cmp_eq_u32 vcc, -1, v228
    s_add_u32 s62, s62, 1
    s_and_b32 s60, s62, 31
    s_nop 2
    s_cbranch_vccz L_gotx
    s_cbranch_scc0 L_pollx
L_pollxr:
    buffer_load_dwordx4 v[176:179], v239, s[52:55], s70 offen sc1
    buffer_load_dwordx4 v[180:183], v239, s[52:55], s70 offen offset:1024 sc1
    buffer_load_dwordx2 v[174:175], v231, s[52:55], s71 offen sc1
    s_branch L_pollxc
L_gotx:
    v_mfma_f32_16x16x16_bf16 v[72:75], a[252:253], v[176:177], v[72:75]
    v_mfma_f32_16x16x16_bf16 v[76:79], a[252:253], v[178:179], v[76:79]
    v_mfma_f32_16x16x16_bf16 v[108:111], a[252:253], v[180:181], v[108:111]
    v_mfma_f32_16x16x16_bf16 v[112:115], a[252:253], v[182:183], v[112:115]
    v_mfma_f32_16x16x16_bf16 v[124:127], a[252:253], v[174:175], v[124:127]
    s_waitcnt lgkmcnt(0)
    v_mfma_f32_16x16x32_bf16 v[152:155], a[202:205], v[24:27], v[152:155]
    v_mfma_f32_16x16x32_bf16 v[156:159], a[220:223], v[24:27], v[156:159]
    s_nop 0
    v_cvt_pk_bf16_f32 v72, v72, v73
    v_cvt_pk_bf16_f32 v73, v74, v75
    v_cvt_pk_bf16_f32 v74, v76, v77
    v_cvt_pk_bf16_f32 v75, v78, v79
    v_mfma_f32_16x16x32_bf16 v[160:163], a[238:241], v[4:7], v[160:163]
    ds_write_b128 v226, v[72:75] offset:0
    v_cvt_pk_bf16_f32 v108, v108, v109
    v_cvt_pk_bf16_f32 v109, v110, v111
    v_cvt_pk_bf16_f32 v110, v112, v113
    v_cvt_pk_bf16_f32 v111, v114, v115
    v_mfma_f32_16x16x32_bf16 v[144:147], a[206:209], v[8:11], v[144:147]
    ds_write_b128 v226, v[108:111] offset:4608
    v_cvt_pk_bf16_f32 v124, v124, v125
    v_cvt_pk_bf16_f32 v125, v126, v127
    ds_write_b64 v227, v[124:125]
    v_mfma_f32_16x16x32_bf16 v[148:151], a[224:227], v[8:11], v[148:151]
    v_mfma_f32_16x16x32_bf16 v[152:155], a[206:209], v[28:31], v[152:155]
    v_mfma_f32_16x16x32_bf16 v[156:159], a[224:227], v[28:31], v[156:159]
    v_mfma_f32_16x16x32_bf16 v[160:163], a[242:245], v[8:11], v[160:163]
    s_waitcnt lgkmcnt(0)
    s_barrier
    ds_read_b64 v[96:97], v251 offset:0
    ds_read_b64 v[116:117], v253 offset:0
    v_mfma_f32_16x16x32_bf16 v[144:147], a[210:213], v[12:15], v[144:147]
    ds_read_b128 v[80:83], v250 offset:0
    ds_read_b128 v[100:103], v252 offset:0
    v_mfma_f32_16x16x32_bf16 v[148:151], a[228:231], v[12:15], v[148:151]
    ds_read_b128 v[84:87], v250 offset:1024
    ds_read_b128 v[104:107], v252 offset:1024
    v_mfma_f32_16x16x32_bf16 v[152:155], a[210:213], v[32:35], v[152:155]
    ds_read_b128 v[88:91], v250 offset:2048
    ds_read_b128 v[108:111], v252 offset:2048
    v_mfma_f32_16x16x32_bf16 v[156:159], a[228:231], v[32:35], v[156:159]
    ds_read_b128 v[92:95], v250 offset:3072
    ds_read_b128 v[112:115], v252 offset:3072
    v_mfma_f32_16x16x32_bf16 v[160:163], a[246:249], v[12:15], v[160:163]
L_fin:
    s_waitcnt lgkmcnt(8)
    v_mfma_f32_16x16x16_bf16 v[60:63], a[160:161], v[96:97], 0
    v_and_b32 v192, s75, v97
    v_mfma_f32_16x16x16_bf16 v[64:67], a[178:179], v[96:97], 0
    v_and_b32 v194, s75, v117
    v_mfma_f32_16x16x16_bf16 v[68:71], a[160:161], v[116:117], 0
    v_mov_b32 v193, v192
    v_mfma_f32_16x16x16_bf16 v[72:75], a[178:179], v[116:117], 0
    v_mov_b32 v195, v194
    v_mfma_f32_16x16x16_bf16 v[76:79], a[196:197], v[96:97], 0
    s_waitcnt lgkmcnt(6)
    v_mov_b32 v197, 0x7f000000
    v_mfma_f32_16x16x32_bf16 v[60:63], a[144:147], v[80:83], v[60:63]
    v_permlane32_swap_b32 v193, v192
    v_mfma_f32_16x16x32_bf16 v[64:67], a[162:165], v[80:83], v[64:67]
    v_permlane32_swap_b32 v195, v194
    v_mfma_f32_16x16x32_bf16 v[68:71], a[144:147], v[100:103], v[68:71]
    v_mov_b32 v193, v192
    v_mfma_f32_16x16x32_bf16 v[72:75], a[162:165], v[100:103], v[72:75]
    v_mov_b32 v195, v194
    v_mfma_f32_16x16x32_bf16 v[76:79], a[180:183], v[80:83], v[76:79]
    s_waitcnt lgkmcnt(4)
    v_permlane16_swap_b32 v193, v192
    v_mfma_f32_16x16x32_bf16 v[60:63], a[148:151], v[84:87], v[60:63]
    v_permlane16_swap_b32 v195, v194
    v_mfma_f32_16x16x32_bf16 v[64:67], a[166:169], v[84:87], v[64:67]
    v_min_f32 v198, v192, v194
    v_mfma_f32_16x16x32_bf16 v[68:71], a[148:151], v[104:107], v[68:71]
    v_add_f32 v199, v192, v194
    v_mfma_f32_16x16x32_bf16 v[72:75], a[166:169], v[104:107], v[72:75]
    v_rcp_f32 v192, v192
    v_mfma_f32_16x16x32_bf16 v[76:79], a[184:187], v[84:87], v[76:79]
    s_waitcnt lgkmcnt(0)
    v_rcp_f32 v194, v194
    v_mfma_f32_16x16x32_bf16 v[60:63], a[152:155], v[88:91], v[60:63]
    v_cmp_nle_f32 vcc, 0x21800000, v198
    v_mfma_f32_16x16x32_bf16 v[64:67], a[170:173], v[88:91], v[64:67]
    s_sub_u32 s62, s14, s13
    v_cmp_nlt_f32 s[60:61], v199, v197
    v_add_u32 v200, s62, v224
    v_mfma_f32_16x16x32_bf16 v[60:63], a[156:159], v[92:95], v[60:63]
    s_sub_u32 s62, s15, s13
    v_add_u32 v201, s62, v224
    v_mfma_f32_16x16x32_bf16 v[64:67], a[174:177], v[92:95], v[64:67]
    s_mul_i32 s62, s3, 2304
    v_add_u32 v202, s62, v239
    v_lshrrev_b32 v203, 2, v239
    v_mfma_f32_16x16x32_bf16 v[68:71], a[152:155], v[108:111], v[68:71]
    s_or_b64 vcc, vcc, s[60:61]
    s_cbranch_scc1 L_slow
L_fast:
    v_add_u32 v203, s62, v203
    v_mfma_f32_16x16x32_bf16 v[72:75], a[170:173], v[108:111], v[72:75]
    v_mfma_f32_16x16x32_bf16 v[68:71], a[156:159], v[112:115], v[68:71]
    v_fma_f32 v144, v60, v192, v144
    v_fma_f32 v145, v61, v192, v145
    v_fma_f32 v146, v62, v192, v146
    v_fma_f32 v147, v63, v192, v147
    v_mfma_f32_16x16x32_bf16 v[72:75], a[174:177], v[112:115], v[72:75]
    v_cvt_pk_bf16_f32 v164, v144, v145
    v_cvt_pk_bf16_f32 v165, v146, v147
    v_fma_f32 v148, v64, v192, v148
    v_fma_f32 v149, v65, v192, v149
    v_mfma_f32_16x16x32_bf16 v[76:79], a[188:191], v[88:91], v[76:79]
    v_fma_f32 v150, v66, v192, v150
    v_fma_f32 v151, v67, v192, v151
    v_cvt_pk_bf16_f32 v166, v148, v149
    v_cvt_pk_bf16_f32 v167, v150, v151
    v_mfma_f32_16x16x32_bf16 v[76:79], a[192:195], v[92:95], v[76:79]
    ds_write_b128 v200, v[164:167]
    v_pk_fma_f32 v[152:153], v[68:69], v[194:195], v[152:153] op_sel_hi:[1,0,1]
    v_pk_fma_f32 v[154:155], v[70:71], v[194:195], v[154:155] op_sel_hi:[1,0,1]
    v_cvt_pk_bf16_f32 v168, v152, v153
    v_cvt_pk_bf16_f32 v169, v154, v155
    v_pk_fma_f32 v[156:157], v[72:73], v[194:195], v[156:157] op_sel_hi:[1,0,1]
    v_pk_fma_f32 v[158:159], v[74:75], v[194:195], v[158:159] op_sel_hi:[1,0,1]
    v_cvt_pk_bf16_f32 v170, v156, v157
    v_cvt_pk_bf16_f32 v171, v158, v159
    ds_write_b128 v201, v[168:171]
    v_pk_fma_f32 v[160:161], v[76:77], v[192:193], v[160:161] op_sel_hi:[1,0,1]
    v_pk_fma_f32 v[162:163], v[78:79], v[192:193], v[162:163] op_sel_hi:[1,0,1]
    v_cvt_pk_bf16_f32 v172, v160, v161
    v_cvt_pk_bf16_f32 v173, v162, v163
    ds_write_b64 v225, v[172:173]
    s_waitcnt lgkmcnt(0)
    s_barrier
    ds_read_b128 v[0:3], v202 offset:0
    ds_read_b128 v[4:7], v202 offset:1024
    ds_read_b32 v8, v203 offset:2048
    s_waitcnt lgkmcnt(2)
    buffer_store_dwordx4 v[0:3], v202, s[40:43], s13 offen offset:0 sc1
    s_waitcnt lgkmcnt(1)
    buffer_store_dwordx4 v[4:7], v202, s[40:43], s13 offen offset:1024 sc1
    s_waitcnt lgkmcnt(0)
    buffer_store_dword v8, v203, s[40:43], s13 offen offset:2048 sc1
    s_endpgm
L_try2:
    s_waitcnt vmcnt(0)
    v_subrev_co_u32 v190, vcc, s0, v188
    v_mov_b32 v191, s1
    s_nop 0
    v_subb_co_u32 v191, vcc, v189, v191, vcc
    v_lshrrev_b32 v190, 28, v190
    v_or_b32 v190, v190, v191
    v_cmp_ne_u32 vcc, 0, v190
    s_nop 0
    s_and_b32 s61, vcc_lo, 0xff
    s_cbranch_scc1 L_try2n
    s_mov_b32 s10, s96
    s_add_u32 m0, s64, 0
    s_nop 0
    buffer_load_dwordx4 v239, s[8:11], s18 offen offset:0 sc1 lds
    buffer_load_dwordx4 v239, s[8:11], s19 offen offset:1024 sc1 lds
    buffer_load_dwordx4 v239, s[8:11], s20 offen offset:2048 sc1 lds
    buffer_load_dwordx4 v239, s[8:11], s21 offen offset:3072 sc1 lds
    s_add_u32 m0, s64, 4096
    s_nop 0
    buffer_load_dwordx4 v239, s[8:11], s22 offen offset:0 sc1 lds
    buffer_load_dwordx4 v239, s[8:11], s23 offen offset:1024 sc1 lds
    buffer_load_dwordx4 v239, s[8:11], s24 offen offset:2048 sc1 lds
    buffer_load_dwordx4 v239, s[8:11], s25 offen offset:3072 sc1 lds
    s_branch L_try2x
L_try2n:
    buffer_load_dwordx2 v[188:189], v255, s[52:55], 0 offen sc1
    s_branch L_try2x
L_poll0:
    s_mov_b32 s68, 0
    s_branch L_poll0c
L_poll0l:
    s_and_b32 s69, s68, 31
    s_cmp_lg_u32 s69, 31
    s_cbranch_scc1 L_ep0
    s_mov_b64 exec, 1
    s_not_b32 s69, s100
    s_not_b32 s70, s101
    v_mov_b32 v188, s69
    v_mov_b32 v189, s70
    v_mov_b32 v190, 128
    global_atomic_umax_x2 v190, v[188:189], s[36:37] sc1
    s_waitcnt vmcnt(0)
    global_load_dwordx2 v[188:189], v190, s[36:37] sc1
    s_waitcnt vmcnt(0)
    v_readfirstlane_b32 s69, v188
    v_readfirstlane_b32 s70, v189
    s_mov_b64 exec, -1
    s_not_b32 s69, s69
    s_not_b32 s70, s70
    s_sub_u32 s0, s69, 1000
    s_subb_u32 s1, s70, 0
L_ep0:
    buffer_load_dwordx2 v[188:189], v255, s[52:55], 0 offen sc1
L_poll0c:
    s_add_u32 s68, s68, 1
    s_waitcnt vmcnt(0)
    v_subrev_co_u32 v190, vcc, s0, v188
    v_mov_b32 v191, s1
    s_nop 0
    v_subb_co_u32 v191, vcc, v189, v191, vcc
    v_lshrrev_b32 v190, 28, v190
    v_or_b32 v190, v190, v191
    v_cmp_ne_u32 vcc, 0, v190
    s_cmp_ge_u32 s68, 0x40000
    s_cbranch_scc1 L_poll0x
    s_and_b32 s69, vcc_lo, 0xff
    s_cbranch_scc1 L_poll0l
L_poll0x:
    s_mov_b32 s10, s96
    s_mov_b32 s8, s90
    s_mov_b32 s9, s91
    s_add_u32 m0, s64, 0
    s_nop 0
    buffer_load_dwordx4 v239, s[8:11], s18 offen offset:0 sc1 lds
    buffer_load_dwordx4 v239, s[8:11], s19 offen offset:1024 sc1 lds
    buffer_load_dwordx4 v239, s[8:11], s20 offen offset:2048 sc1 lds
    buffer_load_dwordx4 v239, s[8:11], s21 offen offset:3072 sc1 lds
    s_add_u32 m0, s64, 4096
    s_nop 0
    buffer_load_dwordx4 v239, s[8:11], s22 offen offset:0 sc1 lds
    buffer_load_dwordx4 v239, s[8:11], s23 offen offset:1024 sc1 lds
    buffer_load_dwordx4 v239, s[8:11], s24 offen offset:2048 sc1 lds
    buffer_load_dwordx4 v239, s[8:11], s25 offen offset:3072 sc1 lds
    s_add_u32 m0, s64, 8192
    s_nop 0
    buffer_load_dwordx4 v239, s[8:11], s26 offen offset:0 sc1 lds
    s_add_u32 s8, s8, 73728
    s_addc_u32 s9, s9, 0
    s_sub_u32 s10, s10, 73728
    s_max_i32 s10, s10, 0
    s_add_u32 m0, s64, 36864
    s_nop 0
    buffer_load_dwordx4 v239, s[8:11], s18 offen offset:0 sc1 lds
    buffer_load_dwordx4 v239, s[8:11], s19 offen offset:1024 sc1 lds
    buffer_load_dwordx4 v239, s[8:11], s20 offen offset:2048 sc1 lds
    buffer_load_dwordx4 v239, s[8:11], s21 offen offset:3072 sc1 lds
    s_add_u32 m0, s64, 40960
    s_nop 0
    buffer_load_dwordx4 v239, s[8:11], s22 offen offset:0 sc1 lds
    buffer_load_dwordx4 v239, s[8:11], s23 offen offset:1024 sc1 lds
    buffer_load_dwordx4 v239, s[8:11], s24 offen offset:2048 sc1 lds
    buffer_load_dwordx4 v239, s[8:11], s25 offen offset:3072 sc1 lds
    s_add_u32 m0, s64, 45056
    s_nop 0
    buffer_load_dwordx4 v239, s[8:11], s26 offen offset:0 sc1 lds
    s_branch L_have
L_poll4g:
    s_mov_b32 s68, 0
L_poll4lg:
    s_and_b32 s69, s68, 31
    s_cmp_lg_u32 s69, 31
    s_cbranch_scc1 L_ep4g
    s_mov_b64 exec, 1
    s_not_b32 s69, s100
    s_not_b32 s70, s101
    v_mov_b32 v246, s69
    v_mov_b32 v247, s70
    v_mov_b32 v230, 128
    global_atomic_umax_x2 v230, v[246:247], s[36:37] sc1
    s_waitcnt vmcnt(0)
    global_load_dwordx2 v[246:247], v230, s[36:37] sc1
    s_waitcnt vmcnt(0)
    v_readfirstlane_b32 s69, v246
    v_readfirstlane_b32 s70, v247
    s_mov_b64 exec, -1
    s_not_b32 s69, s69
    s_not_b32 s70, s70
    s_sub_u32 s0, s69, 1000
    s_subb_u32 s1, s70, 0
L_ep4g:
    buffer_load_dwordx2 v[246:247], v255, s[52:55], 0 offen sc1
    s_add_u32 s68, s68, 1
    s_waitcnt vmcnt(0)
    v_subrev_co_u32 v230, vcc, s0, v246
    v_mov_b32 v249, s1
    s_nop 0
    v_subb_co_u32 v249, vcc, v247, v249, vcc
    v_lshrrev_b32 v230, 28, v230
    v_or_b32 v230, v230, v249
    v_cmp_ne_u32 vcc, 0, v230
    s_cmp_ge_u32 s68, 0x40000
    s_cbranch_scc1 L_have4g
    s_nop 2
    s_cbranch_vccnz L_poll4lg
    s_branch L_have4g
L_pollwg:
    s_mov_b32 s68, 0
L_pollw1g:
    s_and_b32 s69, s68, 31
    s_cmp_lg_u32 s69, 31
    s_cbranch_scc1 L_epwg
    s_mov_b64 exec, 1
    s_not_b32 s69, s100
    s_not_b32 s71, s101
    v_mov_b32 v250, s69
    v_mov_b32 v251, s71
    v_mov_b32 v252, 128
    global_atomic_umax_x2 v252, v[250:251], s[36:37] sc1
    s_waitcnt vmcnt(0)
    global_load_dwordx2 v[250:251], v252, s[36:37] sc1
    s_waitcnt vmcnt(0)
    v_readfirstlane_b32 s69, v250
    v_readfirstlane_b32 s71, v251
    s_mov_b64 exec, -1
    s_not_b32 s69, s69
    s_not_b32 s71, s71
    s_sub_u32 s0, s69, 1000
    s_subb_u32 s1, s71, 0
L_epwg:
    buffer_load_dwordx2 v[250:251], v249, s[52:55], s70 offen sc1
    s_add_u32 s68, s68, 1
    s_waitcnt vmcnt(0)
    v_subrev_co_u32 v252, vcc, s0, v250
    v_mov_b32 v253, s1
    s_nop 0
    v_subb_co_u32 v253, vcc, v251, v253, vcc
    v_lshrrev_b32 v252, 28, v252
    v_or_b32 v252, v252, v253
    v_cmp_ne_u32 vcc, 0, v252
    s_cmp_ge_u32 s68, 0x40000
    s_cbranch_scc1 L_wokg
    s_nop 2
    s_cbranch_vccnz L_pollw1g
    s_branch L_wokg
L_poll4u:
    s_mov_b32 s68, 0
L_poll4lu:
    s_and_b32 s69, s68, 31
    s_cmp_lg_u32 s69, 31
    s_cbranch_scc1 L_ep4u
    s_mov_b64 exec, 1
    s_not_b32 s69, s100
    s_not_b32 s70, s101
    v_mov_b32 v246, s69
    v_mov_b32 v247, s70
    v_mov_b32 v230, 128
    global_atomic_umax_x2 v230, v[246:247], s[36:37] sc1
    s_waitcnt vmcnt(0)
    global_load_dwordx2 v[246:247], v230, s[36:37] sc1
    s_waitcnt vmcnt(0)
    v_readfirstlane_b32 s69, v246
    v_readfirstlane_b32 s70, v247
    s_mov_b64 exec, -1
    s_not_b32 s69, s69
    s_not_b32 s70, s70
    s_sub_u32 s0, s69, 1000
    s_subb_u32 s1, s70, 0
L_ep4u:
    buffer_load_dwordx2 v[246:247], v255, s[52:55], 0 offen sc1
    s_add_u32 s68, s68, 1
    s_waitcnt vmcnt(0)
    v_subrev_co_u32 v230, vcc, s0, v246
    v_mov_b32 v249, s1
    s_nop 0
    v_subb_co_u32 v249, vcc, v247, v249, vcc
    v_lshrrev_b32 v230, 28, v230
    v_or_b32 v230, v230, v249
    v_cmp_ne_u32 vcc, 0, v230
    s_cmp_ge_u32 s68, 0x40000
    s_cbranch_scc1 L_have4u
    s_nop 2
    s_cbranch_vccnz L_poll4lu
    s_branch L_have4u
L_pollwu:
    s_mov_b32 s68, 0
L_pollw1u:
    s_and_b32 s69, s68, 31
    s_cmp_lg_u32 s69, 31
    s_cbranch_scc1 L_epwu
    s_mov_b64 exec, 1
    s_not_b32 s69, s100
    s_not_b32 s71, s101
    v_mov_b32 v250, s69
    v_mov_b32 v251, s71
    v_mov_b32 v252, 128
    global_atomic_umax_x2 v252, v[250:251], s[36:37] sc1
    s_waitcnt vmcnt(0)
    global_load_dwordx2 v[250:251], v252, s[36:37] sc1
    s_waitcnt vmcnt(0)
    v_readfirstlane_b32 s69, v250
    v_readfirstlane_b32 s71, v251
    s_mov_b64 exec, -1
    s_not_b32 s69, s69
    s_not_b32 s71, s71
    s_sub_u32 s0, s69, 1000
    s_subb_u32 s1, s71, 0
L_epwu:
    buffer_load_dwordx2 v[250:251], v249, s[52:55], s70 offen sc1
    s_add_u32 s68, s68, 1
    s_waitcnt vmcnt(0)
    v_subrev_co_u32 v252, vcc, s0, v250
    v_mov_b32 v253, s1
    s_nop 0
    v_subb_co_u32 v253, vcc, v251, v253, vcc
    v_lshrrev_b32 v252, 28, v252
    v_or_b32 v252, v252, v253
    v_cmp_ne_u32 vcc, 0, v252
    s_cmp_ge_u32 s68, 0x40000
    s_cbranch_scc1 L_woku
    s_nop 2
    s_cbranch_vccnz L_pollw1u
    s_branch L_woku
L_pollg:
    s_mov_b32 s62, 0
L_pollg1:
    s_and_b32 s60, s62, 31
    s_cmp_lg_u32 s60, 31
    s_cbranch_scc1 L_epg
    s_mov_b64 exec, 1
    s_not_b32 s60, s100
    s_not_b32 s61, s101
    v_mov_b32 v228, s60
    v_mov_b32 v229, s61
    v_mov_b32 v230, 128
    global_atomic_umax_x2 v230, v[228:229], s[36:37] sc1
    s_waitcnt vmcnt(0)
    global_load_dwordx2 v[228:229], v230, s[36:37] sc1
    s_waitcnt vmcnt(0)
    v_readfirstlane_b32 s60, v228
    v_readfirstlane_b32 s61, v229
    s_mov_b64 exec, -1
    s_not_b32 s60, s60
    s_not_b32 s61, s61
    s_sub_u32 s0, s60, 1000
    s_subb_u32 s1, s61, 0
L_epg:
    buffer_load_dwordx2 v[228:229], v255, s[52:55], 0 offen sc1
    s_add_u32 s62, s62, 1
    s_waitcnt vmcnt(0)
    v_subrev_co_u32 v230, vcc, s0, v228
    v_mov_b32 v206, s1
    s_nop 0
    v_subb_co_u32 v206, vcc, v229, v206, vcc
    v_lshrrev_b32 v230, 28, v230
    v_or_b32 v230, v230, v206
    v_cmp_ne_u32 vcc, 0, v230
    s_cmp_ge_u32 s62, 0x40000
    s_cbranch_scc1 L_gok
    s_nop 2
    s_cbranch_vccnz L_pollg1
    s_branch L_gok
L_pollx:
    s_cmp_ge_u32 s62, 0x40000
    s_cbranch_scc1 L_gotx
    s_mov_b64 exec, 1
    s_not_b32 s60, s100
    s_not_b32 s61, s101
    v_mov_b32 v174, s60
    v_mov_b32 v175, s61
    v_mov_b32 v228, 128
    global_atomic_umax_x2 v228, v[174:175], s[36:37] sc1
    s_waitcnt vmcnt(0)
    global_load_dwordx2 v[174:175], v228, s[36:37] sc1
    s_waitcnt vmcnt(0)
    v_readfirstlane_b32 s60, v174
    v_readfirstlane_b32 s61, v175
    s_mov_b64 exec, -1
    s_not_b32 s60, s60
    s_not_b32 s61, s61
    s_sub_u32 s0, s60, 1000
    s_subb_u32 s1, s61, 0
    s_branch L_pollxr
L_sback:
    s_barrier
    ds_read_b64 v[96:97], v251 offset:0
    ds_read_b64 v[116:117], v253 offset:0
    ds_read_b128 v[80:83], v250 offset:0
    ds_read_b128 v[100:103], v252 offset:0
    ds_read_b128 v[84:87], v250 offset:1024
    ds_read_b128 v[104:107], v252 offset:1024
    ds_read_b128 v[88:91], v250 offset:2048
    ds_read_b128 v[108:111], v252 offset:2048
    ds_read_b128 v[92:95], v250 offset:3072
    ds_read_b128 v[112:115], v252 offset:3072
    s_branch L_fin
    s_nop 0
    s_nop 0
    s_nop 0
    s_nop 0
    s_nop 0
    s_nop 0
    s_nop 0
    s_nop 0
    s_nop 0
    s_nop 0
    s_nop 0
    s_nop 0
    s_nop 0
    s_nop 0
    s_nop 0
    s_nop 0
    s_nop 0
    s_nop 0
    s_nop 0
    s_nop 0
    s_nop 0
    s_nop 0
    s_nop 0
    s_nop 0
    s_nop 0
    s_nop 0
    s_nop 0
    s_nop 0
    s_nop 0
    s_nop 0
    s_nop 0
    s_nop 0
    s_nop 0
    s_nop 0
    s_nop 0
    s_nop 0
    s_nop 0
    s_nop 0
    s_nop 0
    s_nop 0
    s_nop 0
    s_nop 0
    s_nop 0
    s_nop 0
    s_nop 0
    s_nop 0
    s_nop 0
    s_nop 0
    s_nop 0
    s_nop 0
    s_nop 0
    s_nop 0
    s_nop 0
    s_nop 0
    s_nop 0
    s_nop 0
    s_nop 0
    s_nop 0
    s_nop 0
    s_nop 0
    s_nop 0
    s_nop 0
    s_nop 0
    s_nop 0
    s_nop 0
    s_nop 0
    s_nop 0
    s_nop 0
    s_nop 0
    s_nop 0
    s_nop 0
    s_nop 0
    s_nop 0
    s_nop 0
    s_nop 0
    s_nop 0
    s_nop 0
    s_nop 0
    s_nop 0
    s_nop 0
    s_nop 0
    s_nop 0
    s_nop 0
    s_nop 0
    s_nop 0
    s_nop 0
    s_nop 0
    s_nop 0
    s_nop 0
    s_nop 0
    s_nop 0
    s_nop 0
    s_nop 0
    s_nop 0
    s_nop 0
    s_nop 0
    s_nop 0
    s_nop 0
    s_nop 0
    s_nop 0
    s_nop 0
    s_nop 0
    s_nop 0
    s_nop 0
    s_nop 0
    s_nop 0
    s_nop 0
    s_nop 0
    s_nop 0
    s_nop 0
    s_nop 0
    s_nop 0
    s_nop 0
    s_nop 0
    s_nop 0
    s_nop 0
    s_nop 0
    s_nop 0
    s_nop 0
    s_nop 0
    s_nop 0
    s_nop 0
    s_nop 0
    s_nop 0
    s_nop 0
    s_nop 0
    s_nop 0
    s_nop 0
    s_nop 0
    s_nop 0
    s_nop 0
    s_nop 0
    s_nop 0
    s_nop 0
    s_nop 0
    s_nop 0
    s_nop 0
    s_nop 0
    s_nop 0
    s_nop 0
    s_nop 0
    s_nop 0
    s_nop 0
    s_nop 0
    s_nop 0
    s_nop 0
    s_nop 0
    s_nop 0
    s_nop 0
    s_nop 0
    s_nop 0
    s_nop 0
    s_nop 0
    s_nop 0
    s_nop 0
    s_nop 0
    s_nop 0
    s_nop 0
    s_nop 0
    s_nop 0
    s_nop 0
    s_nop 0
    s_nop 0
    s_nop 0
    s_nop 0
    s_nop 0
    s_nop 0
    s_nop 0
    s_nop 0
    s_nop 0
    s_nop 0
    s_nop 0
    s_nop 0
    s_nop 0
    s_nop 0
    s_nop 0
    s_nop 0
    s_nop 0
    s_nop 0
    s_nop 0
    s_nop 0
    s_nop 0
    s_nop 0
    s_nop 0
    s_nop 0
    s_nop 0
    s_nop 0
    s_nop 0
    s_nop 0
    s_nop 0
    s_nop 0
    s_nop 0
    s_nop 0
    s_nop 0
    s_nop 0
    s_nop 0
    s_nop 0
    s_nop 0
    s_nop 0
    s_nop 0
    s_nop 0
    s_nop 0
    s_nop 0
    s_nop 0
    s_nop 0
    s_nop 0
    s_nop 0
    s_nop 0
    s_nop 0
    s_nop 0
    s_nop 0
    s_nop 0
    s_nop 0
    s_nop 0
    s_nop 0
    s_nop 0
    s_nop 0
    s_nop 0
    s_nop 0
    s_nop 0
    s_nop 0
    s_nop 0
    s_nop 0
    s_nop 0
    s_nop 0
    s_nop 0
    s_nop 0
    s_nop 0
    s_nop 0
    s_nop 0
    s_nop 0
    s_nop 0
    s_nop 0
    s_nop 0
    s_nop 0
    s_nop 0
    s_nop 0
    s_nop 0
    s_nop 0
    s_nop 0
    s_nop 0
    s_nop 0
    s_nop 0
    s_nop 0
    s_nop 0
    s_nop 0
    s_nop 0
    s_nop 0
    s_nop 0
    s_nop 0
    s_nop 0
    s_nop 0
    s_nop 0
    s_nop 0
    s_nop 0
    s_nop 0
    s_nop 0
    s_nop 0
    s_nop 0
    s_nop 0
    s_nop 0
    s_nop 0
    s_nop 0
    s_nop 0
    s_nop 0
    s_nop 0
    s_nop 0
    s_nop 0
    s_nop 0
    s_nop 0
L_gate:
L_padx:
    s_cbranch_execz L_walked0
    v_mfma_f32_32x32x16_bf16 v[144:159], a[72:75], a[0:3], 0
    v_cvt_pk_bf16_f32 v188, v168, v169
    v_exp_f32 v170, v170
    v_exp_f32 v171, v171
    v_mul_f32 v240, v200, v200
    v_mfma_f32_32x32x16_bf16 v[144:159], a[76:79], a[4:7], v[144:159]
    v_cvt_pk_bf16_f32 v185, v162, v163
    v_permlane16_swap_b32 v184, v188
    v_exp_f32 v164, v164
    v_mul_f32 v241, v201, v201
    v_mfma_f32_32x32x16_bf16 v[144:159], a[80:83], a[8:11], v[144:159]
    buffer_load_dwordx4 v239, s[8:11], s20 offen offset:2048 sc1 lds
    v_exp_f32 v165, v165
    v_cvt_pk_bf16_f32 v189, v170, v171
    v_mul_f32 v242, v202, v202
    v_mfma_f32_32x32x16_bf16 v[144:159], a[84:87], a[12:15], v[144:159]
    buffer_load_dwordx4 v239, s[8:11], s21 offen offset:3072 sc1 lds
    v_exp_f32 v172, v172
    v_exp_f32 v173, v173
    v_mfma_f32_32x32x16_bf16 v[144:159], a[88:91], a[16:19], v[144:159]
    v_cvt_pk_bf16_f32 v186, v164, v165
    v_permlane16_swap_b32 v185, v189
    v_exp_f32 v166, v166
    v_mul_f32 v243, v203, v203
    v_mfma_f32_32x32x16_bf16 v[144:159], a[92:95], a[20:23], v[144:159]
    v_exp_f32 v167, v167
    v_cvt_pk_bf16_f32 v190, v172, v173
    v_exp_f32 v174, v174
    v_fma_f32 v240, v240, s60, v248
    v_mfma_f32_32x32x16_bf16 v[144:159], a[96:99], a[24:27], v[144:159]
    s_add_u32 m0, s64, 114688
    v_exp_f32 v175, v175
    v_cvt_pk_bf16_f32 v187, v166, v167
    v_permlane16_swap_b32 v186, v190
    v_cvt_pk_bf16_f32 v191, v174, v175
    v_mfma_f32_32x32x16_bf16 v[144:159], a[100:103], a[28:31], v[144:159]
    buffer_load_dwordx4 v239, s[8:11], s22 offen offset:0 sc1 lds
    v_permlane16_swap_b32 v187, v191
    v_fma_f32 v241, v241, s60, v248
    v_fma_f32 v242, v242, s60, v248
    v_mfma_f32_32x32x16_bf16 v[144:159], a[104:107], a[32:35], v[144:159]
    buffer_load_dwordx4 v239, s[8:11], s23 offen offset:1024 sc1 lds
    v_fma_f32 v243, v243, s60, v248
    v_mul_f32 v240, v240, v200
    v_mul_f32 v241, v241, v201
    v_mul_f32 v242, v242, v202
    v_mfma_f32_16x16x32_bf16 v[72:75], a[108:111], v[184:187], 0
    v_mul_f32 v243, v243, v203
    v_mfma_f32_16x16x32_bf16 v[108:111], a[108:111], v[188:191], 0
    ds_read_b64_tr_b16 a[108:109], v234 offset:36864
    v_mfma_f32_16x16x32_bf16 v[76:79], a[112:115], v[184:187], 0
    ds_read_b64_tr_b16 a[110:111], v236 offset:36864
    v_mfma_f32_16x16x32_bf16 v[112:115], a[112:115], v[188:191], 0
    ds_read_b64_tr_b16 a[112:113], v234 offset:37888
    v_mfma_f32_16x16x32_bf16 v[80:83], a[116:119], v[184:187], 0
    ds_read_b64_tr_b16 a[114:115], v236 offset:37888
    v_mfma_f32_16x16x32_bf16 v[116:119], a[116:119], v[188:191], 0
    v_exp_f32 v144, v144
    v_mfma_f32_16x16x32_bf16 v[84:87], a[120:123], v[184:187], 0
    v_exp_f32 v145, v145
    v_mfma_f32_16x16x32_bf16 v[120:123], a[120:123], v[188:191], 0
    buffer_load_dwordx4 v239, s[8:11], s24 offen offset:2048 sc1 lds
    v_mfma_f32_16x16x32_bf16 v[88:91], a[124:127], v[184:187], 0
    buffer_load_dwordx4 v239, s[8:11], s25 offen offset:3072 sc1 lds
    v_mfma_f32_16x16x32_bf16 v[124:127], a[124:127], v[188:191], 0
    v_exp_f32 v152, v152
    v_mfma_f32_16x16x32_bf16 v[92:95], a[128:131], v[184:187], 0
    s_add_u32 m0, s64, 118784
    v_exp_f32 v153, v153
    v_mfma_f32_16x16x32_bf16 v[128:131], a[128:131], v[188:191], 0
    s_waitcnt vmcnt(11)
    ds_read_b64_tr_b16 a[116:117], v234 offset:38912
    v_subrev_co_u32 v230, vcc, s0, v246
    v_mfma_f32_16x16x32_bf16 v[96:99], a[132:135], v[184:187], 0
    buffer_load_dwordx4 v239, s[8:11], s26 offen offset:0 sc1 lds
    v_mov_b32 v249, s1
    v_mfma_f32_16x16x32_bf16 v[132:135], a[132:135], v[188:191], 0
    ds_read_b64_tr_b16 a[118:119], v236 offset:38912
    v_subb_co_u32 v249, vcc, v247, v249, vcc
    v_lshrrev_b32 v230, 28, v230
    v_mfma_f32_16x16x32_bf16 v[100:103], a[136:139], v[184:187], 0
    ds_read_b64_tr_b16 a[120:121], v234 offset:39936
    v_or_b32 v230, v230, v249
    v_cmp_ne_u32 vcc, 0, v230
    v_mfma_f32_16x16x32_bf16 v[136:139], a[136:139], v[188:191], 0
    s_add_u32 s8, s8, 73728
    s_addc_u32 s9, s9, 0
    v_cvt_pk_bf16_f32 v176, v144, v145
    v_mfma_f32_16x16x32_bf16 v[104:107], a[140:143], v[184:187], 0
    s_sub_u32 s10, s10, 73728
    v_exp_f32 v146, v146
    v_mfma_f32_16x16x32_bf16 v[140:143], a[140:143], v[188:191], 0
    s_cbranch_vccnz L_poll4g
L_have4g:
    ds_read_b64_tr_b16 a[122:123], v236 offset:39936
    ds_read_b64_tr_b16 a[124:125], v234 offset:40960
    v_mfma_f32_32x32x16_bf16 v[160:175], a[72:75], a[36:39], 0
    s_max_i32 s10, s10, 0
    ds_read_b64_tr_b16 a[126:127], v236 offset:40960
    v_exp_f32 v147, v147
    v_cvt_pk_bf16_f32 v180, v152, v153
    v_exp_f32 v154, v154
    v_mfma_f32_32x32x16_bf16 v[160:175], a[76:79], a[40:43], v[160:175]
    s_add_u32 m0, s64, 0
    ds_read_b64_tr_b16 a[128:129], v234 offset:41984
    ds_read_b64_tr_b16 a[130:131], v236 offset:41984
    v_exp_f32 v155, v155
    v_cvt_pk_bf16_f32 v177, v146, v147
    v_permlane16_swap_b32 v176, v180
    v_mfma_f32_32x32x16_bf16 v[160:175], a[80:83], a[44:47], v[160:175]
    buffer_load_dwordx4 v239, s[8:11], s18 offen offset:0 sc1 lds
    ds_read_b64_tr_b16 a[132:133], v234 offset:43008
    v_exp_f32 v148, v148
    v_exp_f32 v149, v149
    v_mfma_f32_32x32x16_bf16 v[160:175], a[84:87], a[48:51], v[160:175]
    ds_read_b64_tr_b16 a[134:135], v236 offset:43008
    v_cvt_pk_bf16_f32 v181, v154, v155
    v_exp_f32 v156, v156
    v_exp_f32 v157, v157
    v_cvt_pk_bf16_f32 v178, v148, v149
    v_mfma_f32_32x32x16_bf16 v[160:175], a[88:91], a[52:55], v[160:175]
    buffer_load_dwordx4 v239, s[8:11], s19 offen offset:1024 sc1 lds
    ds_read_b64_tr_b16 a[136:137], v234 offset:44032
    v_permlane16_swap_b32 v177, v181
    v_exp_f32 v150, v150
    v_mfma_f32_32x32x16_bf16 v[160:175], a[92:95], a[56:59], v[160:175]
    ds_read_b64_tr_b16 a[138:139], v236 offset:44032
    ds_read_b64_tr_b16 a[140:141], v234 offset:45056
    v_exp_f32 v151, v151
    v_cvt_pk_bf16_f32 v182, v156, v157
    v_exp_f32 v158, v158
    v_mfma_f32_32x32x16_bf16 v[160:175], a[96:99], a[60:63], v[160:175]
    ds_read_b64_tr_b16 a[142:143], v236 offset:45056
    v_exp_f32 v159, v159
    v_cvt_pk_bf16_f32 v179, v150, v151
    v_permlane16_swap_b32 v178, v182
    v_cvt_pk_bf16_f32 v183, v158, v159
    v_mfma_f32_32x32x16_bf16 v[160:175], a[100:103], a[64:67], v[160:175]
    buffer_load_dwordx4 v239, s[8:11], s20 offen offset:2048 sc1 lds
    v_permlane16_swap_b32 v179, v183
    v_exp_f32 v240, v240
    v_mfma_f32_32x32x16_bf16 v[160:175], a[104:107], a[68:71], v[160:175]
    s_waitcnt vmcnt(12) lgkmcnt(0)
    v_exp_f32 v241, v241
    v_exp_f32 v242, v242
    v_exp_f32 v243, v243
    v_mfma_f32_16x16x32_bf16 v[0:3], a[108:111], v[176:179], v[0:3]
    ds_read_b128 a[72:75], v233 offset:0
    v_add_f32 v240, 1.0, v240
    v_mfma_f32_16x16x32_bf16 v[36:39], a[108:111], v[180:183], v[36:39]
    buffer_load_dwordx4 v239, s[8:11], s21 offen offset:3072 sc1 lds
    v_mfma_f32_16x16x32_bf16 v[4:7], a[112:115], v[176:179], v[4:7]
    ds_read_b128 a[76:79], v233 offset:1024
    v_add_f32 v241, 1.0, v241
    v_mfma_f32_16x16x32_bf16 v[40:43], a[112:115], v[180:183], v[40:43]
    ds_read_b128 a[80:83], v233 offset:2048
    v_add_f32 v242, 1.0, v242
    v_mfma_f32_16x16x32_bf16 v[8:11], a[116:119], v[176:179], v[8:11]
    ds_read_b128 a[84:87], v233 offset:3072
    v_add_f32 v243, 1.0, v243
    v_mfma_f32_16x16x32_bf16 v[44:47], a[116:119], v[180:183], v[44:47]
    s_add_u32 m0, s64, 4096
    v_rcp_f32 v240, v240
    v_mfma_f32_16x16x32_bf16 v[12:15], a[120:123], v[176:179], v[12:15]
    buffer_load_dwordx4 v239, s[8:11], s22 offen offset:0 sc1 lds
    v_mfma_f32_16x16x32_bf16 v[48:51], a[120:123], v[180:183], v[48:51]
    v_rcp_f32 v241, v241
    v_mfma_f32_16x16x32_bf16 v[16:19], a[124:127], v[176:179], v[16:19]
    ds_read_b128 a[88:91], v233 offset:4096
    v_rcp_f32 v242, v242
    v_mfma_f32_16x16x32_bf16 v[52:55], a[124:127], v[180:183], v[52:55]
    ds_read_b128 a[92:95], v233 offset:5120
    v_exp_f32 v160, v160
    v_mfma_f32_16x16x32_bf16 v[20:23], a[128:131], v[176:179], v[20:23]
    ds_read_b128 a[96:99], v233 offset:6144
    v_exp_f32 v161, v161
    v_mfma_f32_16x16x32_bf16 v[56:59], a[128:131], v[180:183], v[56:59]
    buffer_load_dwordx4 v239, s[8:11], s23 offen offset:1024 sc1 lds
    ds_read_b128 a[100:103], v233 offset:7168
    v_mfma_f32_16x16x32_bf16 v[24:27], a[132:135], v[176:179], v[24:27]
    ds_read_b128 a[104:107], v233 offset:8192
    v_exp_f32 v168, v168
    v_mfma_f32_16x16x32_bf16 v[60:63], a[132:135], v[180:183], v[60:63]
    v_exp_f32 v169, v169
    v_mfma_f32_16x16x32_bf16 v[28:31], a[136:139], v[176:179], v[28:31]
    v_cvt_pk_bf16_f32 v184, v160, v161
    v_exp_f32 v162, v162
    v_mfma_f32_16x16x32_bf16 v[64:67], a[136:139], v[180:183], v[64:67]
    buffer_load_dwordx4 v239, s[8:11], s24 offen offset:2048 sc1 lds
    v_mfma_f32_16x16x32_bf16 v[32:35], a[140:143], v[176:179], v[32:35]
    v_exp_f32 v163, v163
    v_mfma_f32_16x16x32_bf16 v[68:71], a[140:143], v[180:183], v[68:71]
    s_waitcnt lgkmcnt(0)
    v_rcp_f32 v243, v243
    v_mul_f32 v200, v200, v240
    v_mfma_f32_32x32x16_bf16 v[144:159], a[72:75], a[0:3], 0
    v_cvt_pk_bf16_f32 v188, v168, v169
    v_exp_f32 v170, v170
    v_exp_f32 v171, v171
    v_cvt_pk_bf16_f32 v185, v162, v163
    v_mfma_f32_32x32x16_bf16 v[144:159], a[76:79], a[4:7], v[144:159]
    buffer_load_dwordx4 v239, s[8:11], s25 offen offset:3072 sc1 lds
    v_permlane16_swap_b32 v184, v188
    v_exp_f32 v164, v164
    v_mfma_f32_32x32x16_bf16 v[144:159], a[80:83], a[8:11], v[144:159]
    s_add_u32 m0, s64, 8192
    v_exp_f32 v165, v165
    v_cvt_pk_bf16_f32 v189, v170, v171
    v_exp_f32 v172, v172
    v_mul_f32 v201, v201, v241
    v_mfma_f32_32x32x16_bf16 v[144:159], a[84:87], a[12:15], v[144:159]
    buffer_load_dwordx4 v239, s[8:11], s26 offen offset:0 sc1 lds
    v_exp_f32 v173, v173
    v_cvt_pk_bf16_f32 v186, v164, v165
    v_permlane16_swap_b32 v185, v189
    v_mfma_f32_32x32x16_bf16 v[144:159], a[88:91], a[16:19], v[144:159]
    s_add_u32 s8, s8, 73728
    s_addc_u32 s9, s9, 0
    v_exp_f32 v166, v166
    v_exp_f32 v167, v167
    v_mul_f32 v202, v202, v242
    v_mfma_f32_32x32x16_bf16 v[144:159], a[92:95], a[20:23], v[144:159]
    s_sub_u32 s10, s10, 73728
    v_cvt_pk_bf16_f32 v190, v172, v173
    v_exp_f32 v174, v174
    v_exp_f32 v175, v175
    v_mul_f32 v203, v203, v243
    v_mfma_f32_32x32x16_bf16 v[144:159], a[96:99], a[24:27], v[144:159]
    s_max_i32 s10, s10, 0
    s_add_u32 m0, s64, 36864
    v_cvt_pk_bf16_f32 v187, v166, v167
    v_permlane16_swap_b32 v186, v190
    v_cvt_pk_bf16_f32 v191, v174, v175
    v_mul_f32 v240, v204, v204
    v_mfma_f32_32x32x16_bf16 v[144:159], a[100:103], a[28:31], v[144:159]
    buffer_load_dwordx4 v239, s[8:11], s18 offen offset:0 sc1 lds
    v_permlane16_swap_b32 v187, v191
    v_mul_f32 v241, v205, v205
    v_mul_f32 v242, v206, v206
    v_mfma_f32_32x32x16_bf16 v[144:159], a[104:107], a[32:35], v[144:159]
    buffer_load_dwordx4 v239, s[8:11], s19 offen offset:1024 sc1 lds
    v_mul_f32 v243, v207, v207
    v_fma_f32 v240, v240, s60, v248
    v_fma_f32 v241, v241, s60, v248
    v_fma_f32 v242, v242, s60, v248
    v_mfma_f32_16x16x32_bf16 v[72:75], a[108:111], v[184:187], v[72:75]
    v_fma_f32 v243, v243, s60, v248
    v_mfma_f32_16x16x32_bf16 v[108:111], a[108:111], v[188:191], v[108:111]
    ds_read_b64_tr_b16 a[108:109], v235 offset:0
    v_mul_f32 v240, v240, v204
    v_mfma_f32_16x16x32_bf16 v[76:79], a[112:115], v[184:187], v[76:79]
    ds_read_b64_tr_b16 a[110:111], v237 offset:0
    v_mul_f32 v241, v241, v205
    v_mfma_f32_16x16x32_bf16 v[112:115], a[112:115], v[188:191], v[112:115]
    ds_read_b64_tr_b16 a[112:113], v235 offset:1024
    v_mul_f32 v242, v242, v206
    v_mfma_f32_16x16x32_bf16 v[80:83], a[116:119], v[184:187], v[80:83]
    ds_read_b64_tr_b16 a[114:115], v237 offset:1024
    v_mul_f32 v243, v243, v207
    v_mfma_f32_16x16x32_bf16 v[116:119], a[116:119], v[188:191], v[116:119]
    v_exp_f32 v144, v144
    v_mfma_f32_16x16x32_bf16 v[84:87], a[120:123], v[184:187], v[84:87]
    v_exp_f32 v145, v145
    v_mfma_f32_16x16x32_bf16 v[120:123], a[120:123], v[188:191], v[120:123]
    v_exp_f32 v152, v152
    v_mfma_f32_16x16x32_bf16 v[88:91], a[124:127], v[184:187], v[88:91]
    buffer_load_dwordx4 v239, s[8:11], s20 offen offset:2048 sc1 lds
    v_mfma_f32_16x16x32_bf16 v[124:127], a[124:127], v[188:191], v[124:127]
    v_exp_f32 v153, v153
    v_mfma_f32_16x16x32_bf16 v[92:95], a[128:131], v[184:187], v[92:95]
    ds_read_b64_tr_b16 a[116:117], v235 offset:2048
    v_cvt_pk_bf16_f32 v176, v144, v145
    v_mfma_f32_16x16x32_bf16 v[128:131], a[128:131], v[188:191], v[128:131]
    v_exp_f32 v146, v146
    v_mfma_f32_16x16x32_bf16 v[96:99], a[132:135], v[184:187], v[96:99]
    v_exp_f32 v147, v147
    v_mfma_f32_16x16x32_bf16 v[132:135], a[132:135], v[188:191], v[132:135]
    buffer_load_dwordx4 v239, s[8:11], s21 offen offset:3072 sc1 lds
    v_mfma_f32_16x16x32_bf16 v[100:103], a[136:139], v[184:187], v[100:103]
    ds_read_b64_tr_b16 a[118:119], v237 offset:2048
    v_cvt_pk_bf16_f32 v180, v152, v153
    v_mfma_f32_16x16x32_bf16 v[136:139], a[136:139], v[188:191], v[136:139]
    v_exp_f32 v154, v154
    v_mfma_f32_16x16x32_bf16 v[104:107], a[140:143], v[184:187], v[104:107]
    v_exp_f32 v155, v155
    v_mfma_f32_16x16x32_bf16 v[140:143], a[140:143], v[188:191], v[140:143]
    ds_read_b64_tr_b16 a[120:121], v235 offset:3072
    v_cvt_pk_bf16_f32 v177, v146, v147
    v_mfma_f32_32x32x16_bf16 v[160:175], a[72:75], a[36:39], 0
    buffer_store_dwordx4 v[250:253], v239, s[52:55], s62 offen offset:0 sc1
    v_permlane16_swap_b32 v176, v180
    v_exp_f32 v148, v148
    v_mfma_f32_32x32x16_bf16 v[160:175], a[76:79], a[40:43], v[160:175]
    s_add_u32 m0, s64, 40960
    ds_read_b64_tr_b16 a[122:123], v237 offset:3072
    ds_read_b64_tr_b16 a[124:125], v235 offset:4096
    ds_read_b64_tr_b16 a[126:127], v237 offset:4096
    v_exp_f32 v149, v149
    v_cvt_pk_bf16_f32 v181, v154, v155
    v_mfma_f32_32x32x16_bf16 v[160:175], a[80:83], a[44:47], v[160:175]
    buffer_load_dwordx4 v239, s[8:11], s22 offen offset:0 sc1 lds
    v_exp_f32 v156, v156
    v_exp_f32 v157, v157
    v_mfma_f32_32x32x16_bf16 v[160:175], a[84:87], a[48:51], v[160:175]
    ds_read_b64_tr_b16 a[128:129], v235 offset:5120
    ds_read_b64_tr_b16 a[130:131], v237 offset:5120
    ds_read_b64_tr_b16 a[132:133], v235 offset:6144
    v_cvt_pk_bf16_f32 v178, v148, v149
    v_permlane16_swap_b32 v177, v181
    v_mfma_f32_32x32x16_bf16 v[160:175], a[88:91], a[52:55], v[160:175]
    ds_read_b64_tr_b16 a[134:135], v237 offset:6144
    ds_read_b64_tr_b16 a[136:137], v235 offset:7168
    v_exp_f32 v150, v150
    v_exp_f32 v151, v151
    v_mfma_f32_32x32x16_bf16 v[160:175], a[92:95], a[56:59], v[160:175]
    buffer_load_dwordx4 v239, s[8:11], s23 offen offset:1024 sc1 lds
    v_cvt_pk_bf16_f32 v182, v156, v157
    v_exp_f32 v158, v158
    v_exp_f32 v159, v159
    v_mfma_f32_32x32x16_bf16 v[160:175], a[96:99], a[60:63], v[160:175]
    ds_read_b64_tr_b16 a[138:139], v237 offset:7168
    ds_read_b64_tr_b16 a[140:141], v235 offset:8192
    ds_read_b64_tr_b16 a[142:143], v237 offset:8192
    v_cvt_pk_bf16_f32 v179, v150, v151
    v_permlane16_swap_b32 v178, v182
    v_cvt_pk_bf16_f32 v183, v158, v159
    v_mfma_f32_32x32x16_bf16 v[160:175], a[100:103], a[64:67], v[160:175]
    buffer_load_dwordx4 v239, s[8:11], s24 offen offset:2048 sc1 lds
    v_permlane16_swap_b32 v179, v183
    v_exp_f32 v240, v240
    v_mfma_f32_32x32x16_bf16 v[160:175], a[104:107], a[68:71], v[160:175]
    s_waitcnt vmcnt(17) lgkmcnt(0)
    v_exp_f32 v241, v241
    v_exp_f32 v242, v242
    v_exp_f32 v243, v243
    v_mfma_f32_16x16x32_bf16 v[0:3], a[108:111], v[176:179], v[0:3]
    ds_read_b128 a[72:75], v233 offset:36864
    v_add_f32 v240, 1.0, v240
    v_mfma_f32_16x16x32_bf16 v[36:39], a[108:111], v[180:183], v[36:39]
    buffer_load_dwordx4 v239, s[8:11], s25 offen offset:3072 sc1 lds
    v_mfma_f32_16x16x32_bf16 v[4:7], a[112:115], v[176:179], v[4:7]
    ds_read_b128 a[76:79], v233 offset:37888
    v_add_f32 v241, 1.0, v241
    v_mfma_f32_16x16x32_bf16 v[40:43], a[112:115], v[180:183], v[40:43]
    ds_read_b128 a[80:83], v233 offset:38912
    v_add_f32 v242, 1.0, v242
    v_mfma_f32_16x16x32_bf16 v[8:11], a[116:119], v[176:179], v[8:11]
    ds_read_b128 a[84:87], v233 offset:39936
    v_add_f32 v243, 1.0, v243
    v_mfma_f32_16x16x32_bf16 v[44:47], a[116:119], v[180:183], v[44:47]
    v_rcp_f32 v240, v240
    v_mfma_f32_16x16x32_bf16 v[12:15], a[120:123], v[176:179], v[12:15]
    v_rcp_f32 v241, v241
    v_mfma_f32_16x16x32_bf16 v[48:51], a[120:123], v[180:183], v[48:51]
    s_add_u32 m0, s64, 45056
    v_rcp_f32 v242, v242
    v_mfma_f32_16x16x32_bf16 v[16:19], a[124:127], v[176:179], v[16:19]
    buffer_load_dwordx4 v239, s[8:11], s26 offen offset:0 sc1 lds
    ds_read_b128 a[88:91], v233 offset:40960
    v_mfma_f32_16x16x32_bf16 v[52:55], a[124:127], v[180:183], v[52:55]
    ds_read_b128 a[92:95], v233 offset:41984
    v_rcp_f32 v243, v243
    v_mfma_f32_16x16x32_bf16 v[20:23], a[128:131], v[176:179], v[20:23]
    s_add_u32 s8, s8, 73728
    s_addc_u32 s9, s9, 0
    ds_read_b128 a[96:99], v233 offset:43008
    v_mfma_f32_16x16x32_bf16 v[56:59], a[128:131], v[180:183], v[56:59]
    ds_read_b128 a[100:103], v233 offset:44032
    v_exp_f32 v160, v160
    v_mfma_f32_16x16x32_bf16 v[24:27], a[132:135], v[176:179], v[24:27]
    ds_read_b128 a[104:107], v233 offset:45056
    v_exp_f32 v161, v161
    v_mfma_f32_16x16x32_bf16 v[60:63], a[132:135], v[180:183], v[60:63]
    s_sub_u32 s10, s10, 73728
    v_exp_f32 v168, v168
    v_mfma_f32_16x16x32_bf16 v[28:31], a[136:139], v[176:179], v[28:31]
    s_max_i32 s10, s10, 0
    v_exp_f32 v169, v169
    v_mfma_f32_16x16x32_bf16 v[64:67], a[136:139], v[180:183], v[64:67]
    s_add_u32 m0, s64, 73728
    v_cvt_pk_bf16_f32 v184, v160, v161
    v_exp_f32 v162, v162
    v_mfma_f32_16x16x32_bf16 v[32:35], a[140:143], v[176:179], v[32:35]
    v_exp_f32 v163, v163
    v_mfma_f32_16x16x32_bf16 v[68:71], a[140:143], v[180:183], v[68:71]
    s_waitcnt lgkmcnt(0)
    v_mul_f32 v204, v204, v240
    v_mul_f32 v205, v205, v241
    v_mfma_f32_32x32x16_bf16 v[144:159], a[72:75], a[0:3], 0
    v_cvt_pk_bf16_f32 v188, v168, v169
    v_exp_f32 v170, v170
    v_exp_f32 v171, v171
    v_mul_f32 v206, v206, v242
    v_mfma_f32_32x32x16_bf16 v[144:159], a[76:79], a[4:7], v[144:159]
    v_cvt_pk_bf16_f32 v185, v162, v163
    v_permlane16_swap_b32 v184, v188
    v_exp_f32 v164, v164
    v_mul_f32 v207, v207, v243
    v_mfma_f32_32x32x16_bf16 v[144:159], a[80:83], a[8:11], v[144:159]
    buffer_load_dwordx4 v239, s[8:11], s18 offen offset:0 sc1 lds
    v_exp_f32 v165, v165
    v_cvt_pk_bf16_f32 v189, v170, v171
    v_mul_f32 v240, v208, v208
    v_mfma_f32_32x32x16_bf16 v[144:159], a[84:87], a[12:15], v[144:159]
    buffer_load_dwordx4 v239, s[8:11], s19 offen offset:1024 sc1 lds
    v_exp_f32 v172, v172
    v_exp_f32 v173, v173
    v_mfma_f32_32x32x16_bf16 v[144:159], a[88:91], a[16:19], v[144:159]
    v_cvt_pk_bf16_f32 v186, v164, v165
    v_permlane16_swap_b32 v185, v189
    v_exp_f32 v166, v166
    v_mul_f32 v241, v209, v209
    v_mfma_f32_32x32x16_bf16 v[144:159], a[92:95], a[20:23], v[144:159]
    v_exp_f32 v167, v167
    v_cvt_pk_bf16_f32 v190, v172, v173
    v_exp_f32 v174, v174
    v_mul_f32 v242, v210, v210
    v_mfma_f32_32x32x16_bf16 v[144:159], a[96:99], a[24:27], v[144:159]
    v_exp_f32 v175, v175
    v_cvt_pk_bf16_f32 v187, v166, v167
    v_permlane16_swap_b32 v186, v190
    v_cvt_pk_bf16_f32 v191, v174, v175
    v_mfma_f32_32x32x16_bf16 v[144:159], a[100:103], a[28:31], v[144:159]
    buffer_load_dwordx4 v239, s[8:11], s20 offen offset:2048 sc1 lds
    v_permlane16_swap_b32 v187, v191
    v_mul_f32 v243, v211, v211
    v_fma_f32 v240, v240, s60, v248
    v_mfma_f32_32x32x16_bf16 v[144:159], a[104:107], a[32:35], v[144:159]
    buffer_load_dwordx4 v239, s[8:11], s21 offen offset:3072 sc1 lds
    v_fma_f32 v241, v241, s60, v248
    v_fma_f32 v242, v242, s60, v248
    v_fma_f32 v243, v243, s60, v248
    v_mul_f32 v240, v240, v208
    v_mfma_f32_16x16x32_bf16 v[72:75], a[108:111], v[184:187], v[72:75]
    v_mul_f32 v241, v241, v209
    v_mfma_f32_16x16x32_bf16 v[108:111], a[108:111], v[188:191], v[108:111]
    ds_read_b64_tr_b16 a[108:109], v235 offset:36864
    v_mfma_f32_16x16x32_bf16 v[76:79], a[112:115], v[184:187], v[76:79]
    ds_read_b64_tr_b16 a[110:111], v237 offset:36864
    v_mul_f32 v242, v242, v210
    v_mfma_f32_16x16x32_bf16 v[112:115], a[112:115], v[188:191], v[112:115]
    s_add_u32 m0, s64, 77824
    ds_read_b64_tr_b16 a[112:113], v235 offset:37888
    v_mul_f32 v243, v243, v211
    v_mfma_f32_16x16x32_bf16 v[80:83], a[116:119], v[184:187], v[80:83]
    buffer_load_dwordx4 v239, s[8:11], s22 offen offset:0 sc1 lds
    v_mfma_f32_16x16x32_bf16 v[116:119], a[116:119], v[188:191], v[116:119]
    v_exp_f32 v144, v144
    v_mfma_f32_16x16x32_bf16 v[84:87], a[120:123], v[184:187], v[84:87]
    v_exp_f32 v145, v145
    v_mfma_f32_16x16x32_bf16 v[120:123], a[120:123], v[188:191], v[120:123]
    v_exp_f32 v152, v152
    v_mfma_f32_16x16x32_bf16 v[88:91], a[124:127], v[184:187], v[88:91]
    v_exp_f32 v153, v153
    v_mfma_f32_16x16x32_bf16 v[124:127], a[124:127], v[188:191], v[124:127]
    ds_read_b64_tr_b16 a[114:115], v237 offset:37888
    v_cvt_pk_bf16_f32 v176, v144, v145
    v_mfma_f32_16x16x32_bf16 v[92:95], a[128:131], v[184:187], v[92:95]
    v_exp_f32 v146, v146
    v_mfma_f32_16x16x32_bf16 v[128:131], a[128:131], v[188:191], v[128:131]
    v_exp_f32 v147, v147
    v_mfma_f32_16x16x32_bf16 v[96:99], a[132:135], v[184:187], v[96:99]
    buffer_store_dwordx4 v[250:253], v239, s[52:55], s62 offen offset:1024 sc1
    v_mfma_f32_16x16x32_bf16 v[132:135], a[132:135], v[188:191], v[132:135]
    v_cvt_pk_bf16_f32 v180, v152, v153
    v_exp_f32 v154, v154
    v_mfma_f32_16x16x32_bf16 v[100:103], a[136:139], v[184:187], v[100:103]
    v_exp_f32 v155, v155
    v_mfma_f32_16x16x32_bf16 v[136:139], a[136:139], v[188:191], v[136:139]
    ds_read_b64_tr_b16 a[116:117], v235 offset:38912
    v_cvt_pk_bf16_f32 v177, v146, v147
    v_mfma_f32_16x16x32_bf16 v[104:107], a[140:143], v[184:187], v[104:107]
    v_permlane16_swap_b32 v176, v180
    v_mfma_f32_16x16x32_bf16 v[140:143], a[140:143], v[188:191], v[140:143]
    v_exp_f32 v148, v148
    v_mfma_f32_32x32x16_bf16 v[160:175], a[72:75], a[36:39], 0
    buffer_load_dwordx4 v239, s[8:11], s23 offen offset:1024 sc1 lds
    ds_read_b64_tr_b16 a[118:119], v237 offset:38912
    v_exp_f32 v149, v149
    v_cvt_pk_bf16_f32 v181, v154, v155
    v_mfma_f32_32x32x16_bf16 v[160:175], a[76:79], a[40:43], v[160:175]
    ds_read_b64_tr_b16 a[120:121], v235 offset:39936
    ds_read_b64_tr_b16 a[122:123], v237 offset:39936
    v_exp_f32 v156, v156
    v_exp_f32 v157, v157
    v_mfma_f32_32x32x16_bf16 v[160:175], a[80:83], a[44:47], v[160:175]
    buffer_load_dwordx4 v239, s[8:11], s24 offen offset:2048 sc1 lds
    ds_read_b64_tr_b16 a[124:125], v235 offset:40960
    v_cvt_pk_bf16_f32 v178, v148, v149
    v_permlane16_swap_b32 v177, v181
    v_mfma_f32_32x32x16_bf16 v[160:175], a[84:87], a[48:51], v[160:175]
    ds_read_b64_tr_b16 a[126:127], v237 offset:40960
    ds_read_b64_tr_b16 a[128:129], v235 offset:41984
    v_exp_f32 v150, v150
    v_exp_f32 v151, v151
    v_mfma_f32_32x32x16_bf16 v[160:175], a[88:91], a[52:55], v[160:175]
    ds_read_b64_tr_b16 a[130:131], v237 offset:41984
    ds_read_b64_tr_b16 a[132:133], v235 offset:43008
    ds_read_b64_tr_b16 a[134:135], v237 offset:43008
    v_cvt_pk_bf16_f32 v182, v156, v157
    v_exp_f32 v158, v158
    v_mfma_f32_32x32x16_bf16 v[160:175], a[92:95], a[56:59], v[160:175]
    buffer_load_dwordx4 v239, s[8:11], s25 offen offset:3072 sc1 lds
    ds_read_b64_tr_b16 a[136:137], v235 offset:44032
    v_exp_f32 v159, v159
    v_cvt_pk_bf16_f32 v179, v150, v151
    v_mfma_f32_32x32x16_bf16 v[160:175], a[96:99], a[60:63], v[160:175]
    s_add_u32 m0, s64, 81920
    ds_read_b64_tr_b16 a[138:139], v237 offset:44032
    ds_read_b64_tr_b16 a[140:141], v235 offset:45056
    ds_read_b64_tr_b16 a[142:143], v237 offset:45056
    v_permlane16_swap_b32 v178, v182
    v_cvt_pk_bf16_f32 v183, v158, v159
    v_mfma_f32_32x32x16_bf16 v[160:175], a[100:103], a[64:67], v[160:175]
    buffer_load_dwordx4 v239, s[8:11], s26 offen offset:0 sc1 lds
    v_permlane16_swap_b32 v179, v183
    v_exp_f32 v240, v240
    v_mfma_f32_32x32x16_bf16 v[160:175], a[104:107], a[68:71], v[160:175]
    s_waitcnt vmcnt(20) lgkmcnt(0)
    v_exp_f32 v241, v241
    v_exp_f32 v242, v242
    v_exp_f32 v243, v243
    v_mfma_f32_16x16x32_bf16 v[0:3], a[108:111], v[176:179], v[0:3]
    ds_read_b128 a[72:75], v232 offset:0
    v_mfma_f32_16x16x32_bf16 v[36:39], a[108:111], v[180:183], v[36:39]
    ds_read_b128 a[76:79], v232 offset:1024
    v_add_f32 v240, 1.0, v240
    v_mfma_f32_16x16x32_bf16 v[4:7], a[112:115], v[176:179], v[4:7]
    ds_read_b128 a[80:83], v232 offset:2048
    v_add_f32 v241, 1.0, v241
    v_mfma_f32_16x16x32_bf16 v[40:43], a[112:115], v[180:183], v[40:43]
    ds_read_b128 a[84:87], v232 offset:3072
    v_add_f32 v242, 1.0, v242
    v_mfma_f32_16x16x32_bf16 v[8:11], a[116:119], v[176:179], v[8:11]
    ds_read_b128 a[88:91], v232 offset:4096
    v_add_f32 v243, 1.0, v243
    v_mfma_f32_16x16x32_bf16 v[44:47], a[116:119], v[180:183], v[44:47]
    v_rcp_f32 v240, v240
    v_mfma_f32_16x16x32_bf16 v[12:15], a[120:123], v[176:179], v[12:15]
    v_rcp_f32 v241, v241
    v_mfma_f32_16x16x32_bf16 v[48:51], a[120:123], v[180:183], v[48:51]
    v_rcp_f32 v242, v242
    v_mfma_f32_16x16x32_bf16 v[16:19], a[124:127], v[176:179], v[16:19]
    v_rcp_f32 v243, v243
    v_mfma_f32_16x16x32_bf16 v[52:55], a[124:127], v[180:183], v[52:55]
    ds_read_b128 a[92:95], v232 offset:5120
    v_mul_f32 v208, v208, v240
    v_mfma_f32_16x16x32_bf16 v[20:23], a[128:131], v[176:179], v[20:23]
    ds_read_b128 a[96:99], v232 offset:6144
    v_exp_f32 v160, v160
    v_mfma_f32_16x16x32_bf16 v[56:59], a[128:131], v[180:183], v[56:59]
    ds_read_b128 a[100:103], v232 offset:7168
    v_exp_f32 v161, v161
    v_mfma_f32_16x16x32_bf16 v[24:27], a[132:135], v[176:179], v[24:27]
    s_add_u32 s8, s8, 73728
    s_addc_u32 s9, s9, 0
    ds_read_b128 a[104:107], v232 offset:8192
    v_mfma_f32_16x16x32_bf16 v[60:63], a[132:135], v[180:183], v[60:63]
    s_sub_u32 s10, s10, 73728
    v_exp_f32 v168, v168
    v_mfma_f32_16x16x32_bf16 v[28:31], a[136:139], v[176:179], v[28:31]
    s_max_i32 s10, s10, 0
    v_exp_f32 v169, v169
    v_mfma_f32_16x16x32_bf16 v[64:67], a[136:139], v[180:183], v[64:67]
    s_add_u32 m0, s64, 110592
    v_cvt_pk_bf16_f32 v184, v160, v161
    v_exp_f32 v162, v162
    v_mfma_f32_16x16x32_bf16 v[32:35], a[140:143], v[176:179], v[32:35]
    v_exp_f32 v163, v163
    v_mfma_f32_16x16x32_bf16 v[68:71], a[140:143], v[180:183], v[68:71]
    s_waitcnt lgkmcnt(0)
    v_mul_f32 v209, v209, v241
    v_mfma_f32_32x32x16_bf16 v[144:159], a[72:75], a[0:3], 0
    v_cvt_pk_bf16_f32 v188, v168, v169
    v_exp_f32 v170, v170
    v_exp_f32 v171, v171
    v_cvt_pk_bf16_f32 v185, v162, v163
    v_mfma_f32_32x32x16_bf16 v[144:159], a[76:79], a[4:7], v[144:159]
    buffer_load_dwordx4 v239, s[8:11], s18 offen offset:0 sc1 lds
    v_permlane16_swap_b32 v184, v188
    v_exp_f32 v164, v164
    v_mfma_f32_32x32x16_bf16 v[144:159], a[80:83], a[8:11], v[144:159]
    v_exp_f32 v165, v165
    v_cvt_pk_bf16_f32 v189, v170, v171
    v_exp_f32 v172, v172
    v_mul_f32 v210, v210, v242
    v_mfma_f32_32x32x16_bf16 v[144:159], a[84:87], a[12:15], v[144:159]
    v_exp_f32 v173, v173
    v_cvt_pk_bf16_f32 v186, v164, v165
    v_permlane16_swap_b32 v185, v189
    v_mul_f32 v211, v211, v243
    v_mfma_f32_32x32x16_bf16 v[144:159], a[88:91], a[16:19], v[144:159]
    v_exp_f32 v166, v166
    v_exp_f32 v167, v167
    v_cvt_pk_bf16_f32 v190, v172, v173
    v_mul_f32 v240, v212, v212
    v_mfma_f32_32x32x16_bf16 v[144:159], a[92:95], a[20:23], v[144:159]
    buffer_load_dwordx4 v239, s[8:11], s19 offen offset:1024 sc1 lds
    v_exp_f32 v174, v174
    v_exp_f32 v175, v175
    v_mfma_f32_32x32x16_bf16 v[144:159], a[96:99], a[24:27], v[144:159]
    v_cvt_pk_bf16_f32 v187, v166, v167
    v_permlane16_swap_b32 v186, v190
    v_cvt_pk_bf16_f32 v191, v174, v175
    v_mul_f32 v241, v213, v213
    v_mul_f32 v242, v214, v214
    v_mfma_f32_32x32x16_bf16 v[144:159], a[100:103], a[28:31], v[144:159]
    buffer_load_dwordx4 v239, s[8:11], s20 offen offset:2048 sc1 lds
    v_permlane16_swap_b32 v187, v191
    v_mul_f32 v243, v215, v215
    v_fma_f32 v240, v240, s60, v248
    v_mfma_f32_32x32x16_bf16 v[144:159], a[104:107], a[32:35], v[144:159]
    buffer_load_dwordx4 v239, s[8:11], s21 offen offset:3072 sc1 lds
    v_fma_f32 v241, v241, s60, v248
    v_fma_f32 v242, v242, s60, v248
    v_fma_f32 v243, v243, s60, v248
    v_mul_f32 v240, v240, v212
    v_pk_add_f32 v[244:245], v[192:193], v[194:195]
    v_pk_mul_f32 v[246:247], v[192:193], v[192:193]
    v_pk_add_f32 v[244:245], v[244:245], v[196:197]
    v_pk_fma_f32 v[246:247], v[194:195], v[194:195], v[246:247]
    v_pk_add_f32 v[244:245], v[244:245], v[198:199]
    v_pk_fma_f32 v[246:247], v[196:197], v[196:197], v[246:247]
    v_pk_add_f32 v[244:245], v[244:245], v[200:201]
    v_pk_fma_f32 v[246:247], v[198:199], v[198:199], v[246:247]
    v_pk_add_f32 v[244:245], v[244:245], v[202:203]
    v_pk_fma_f32 v[246:247], v[200:201], v[200:201], v[246:247]
    v_pk_add_f32 v[244:245], v[244:245], v[204:205]
    v_pk_fma_f32 v[246:247], v[202:203], v[202:203], v[246:247]
    v_pk_add_f32 v[244:245], v[244:245], v[206:207]
    v_pk_fma_f32 v[246:247], v[204:205], v[204:205], v[246:247]
    v_pk_fma_f32 v[246:247], v[206:207], v[206:207], v[246:247]
    v_add_f32 v255, v244, v245
    v_add_f32 v228, v246, v247
    v_mfma_f32_16x16x32_bf16 v[72:75], a[108:111], v[184:187], v[72:75]
L_padg0:
    s_cbranch_execz L_walked1
    v_mul_f32 v241, v241, v213
    v_mfma_f32_16x16x32_bf16 v[108:111], a[108:111], v[188:191], v[108:111]
    ds_read_b64_tr_b16 a[108:109], v234 offset:0
    v_mfma_f32_16x16x32_bf16 v[76:79], a[112:115], v[184:187], v[76:79]
    ds_read_b64_tr_b16 a[110:111], v236 offset:0
    v_mul_f32 v242, v242, v214
    v_mfma_f32_16x16x32_bf16 v[112:115], a[112:115], v[188:191], v[112:115]
    s_add_u32 m0, s64, 114688
    ds_read_b64_tr_b16 a[112:113], v234 offset:1024
    v_mul_f32 v243, v243, v215
    v_mfma_f32_16x16x32_bf16 v[80:83], a[116:119], v[184:187], v[80:83]
    buffer_load_dwordx4 v239, s[8:11], s22 offen offset:0 sc1 lds
    v_mfma_f32_16x16x32_bf16 v[116:119], a[116:119], v[188:191], v[116:119]
    v_exp_f32 v144, v144
    v_mfma_f32_16x16x32_bf16 v[84:87], a[120:123], v[184:187], v[84:87]
    v_exp_f32 v145, v145
    v_mfma_f32_16x16x32_bf16 v[120:123], a[120:123], v[188:191], v[120:123]
    v_exp_f32 v152, v152
    v_mfma_f32_16x16x32_bf16 v[88:91], a[124:127], v[184:187], v[88:91]
    v_exp_f32 v153, v153
    v_mfma_f32_16x16x32_bf16 v[124:127], a[124:127], v[188:191], v[124:127]
    ds_read_b64_tr_b16 a[114:115], v236 offset:1024
    v_cvt_pk_bf16_f32 v176, v144, v145
    v_mfma_f32_16x16x32_bf16 v[92:95], a[128:131], v[184:187], v[92:95]
    v_exp_f32 v146, v146
    v_mfma_f32_16x16x32_bf16 v[128:131], a[128:131], v[188:191], v[128:131]
    v_exp_f32 v147, v147
    v_mfma_f32_16x16x32_bf16 v[96:99], a[132:135], v[184:187], v[96:99]
    buffer_store_dwordx4 v[250:253], v239, s[52:55], s61 offen sc1
    v_mfma_f32_16x16x32_bf16 v[132:135], a[132:135], v[188:191], v[132:135]
    v_cvt_pk_bf16_f32 v180, v152, v153
    v_exp_f32 v154, v154
    v_mfma_f32_16x16x32_bf16 v[100:103], a[136:139], v[184:187], v[100:103]
    v_exp_f32 v155, v155
    v_mfma_f32_16x16x32_bf16 v[136:139], a[136:139], v[188:191], v[136:139]
    ds_read_b64_tr_b16 a[116:117], v234 offset:2048
    v_cvt_pk_bf16_f32 v177, v146, v147
    v_mfma_f32_16x16x32_bf16 v[104:107], a[140:143], v[184:187], v[104:107]
    v_permlane16_swap_b32 v176, v180
    v_mfma_f32_16x16x32_bf16 v[140:143], a[140:143], v[188:191], v[140:143]
    v_exp_f32 v148, v148
    v_mfma_f32_32x32x16_bf16 v[160:175], a[72:75], a[36:39], 0
    buffer_load_dwordx4 v239, s[8:11], s23 offen offset:1024 sc1 lds
    ds_read_b64_tr_b16 a[118:119], v236 offset:2048
    v_exp_f32 v149, v149
    v_cvt_pk_bf16_f32 v181, v154, v155
    v_mfma_f32_32x32x16_bf16 v[160:175], a[76:79], a[40:43], v[160:175]
    ds_read_b64_tr_b16 a[120:121], v234 offset:3072
    ds_read_b64_tr_b16 a[122:123], v236 offset:3072
    v_exp_f32 v156, v156
    v_exp_f32 v157, v157
    v_mfma_f32_32x32x16_bf16 v[160:175], a[80:83], a[44:47], v[160:175]
    buffer_load_dwordx4 v239, s[8:11], s24 offen offset:2048 sc1 lds
    ds_read_b64_tr_b16 a[124:125], v234 offset:4096
    v_cvt_pk_bf16_f32 v178, v148, v149
    v_permlane16_swap_b32 v177, v181
    v_mfma_f32_32x32x16_bf16 v[160:175], a[84:87], a[48:51], v[160:175]
    ds_read_b64_tr_b16 a[126:127], v236 offset:4096
    ds_read_b64_tr_b16 a[128:129], v234 offset:5120
    v_exp_f32 v150, v150
    v_exp_f32 v151, v151
    v_mfma_f32_32x32x16_bf16 v[160:175], a[88:91], a[52:55], v[160:175]
    ds_read_b64_tr_b16 a[130:131], v236 offset:5120
    ds_read_b64_tr_b16 a[132:133], v234 offset:6144
    ds_read_b64_tr_b16 a[134:135], v236 offset:6144
    v_cvt_pk_bf16_f32 v182, v156, v157
    v_exp_f32 v158, v158
    v_mfma_f32_32x32x16_bf16 v[160:175], a[92:95], a[56:59], v[160:175]
    buffer_load_dwordx4 v239, s[8:11], s25 offen offset:3072 sc1 lds
    ds_read_b64_tr_b16 a[136:137], v234 offset:7168
    v_exp_f32 v159, v159
    v_cvt_pk_bf16_f32 v179, v150, v151
    v_mfma_f32_32x32x16_bf16 v[160:175], a[96:99], a[60:63], v[160:175]
    s_add_u32 m0, s64, 118784
    ds_read_b64_tr_b16 a[138:139], v236 offset:7168
    ds_read_b64_tr_b16 a[140:141], v234 offset:8192
    ds_read_b64_tr_b16 a[142:143], v236 offset:8192
    v_permlane16_swap_b32 v178, v182
    v_cvt_pk_bf16_f32 v183, v158, v159
    v_mfma_f32_32x32x16_bf16 v[160:175], a[100:103], a[64:67], v[160:175]
    buffer_load_dwordx4 v239, s[8:11], s26 offen offset:0 sc1 lds
    v_permlane16_swap_b32 v179, v183
    v_exp_f32 v240, v240
    v_mfma_f32_32x32x16_bf16 v[160:175], a[104:107], a[68:71], v[160:175]
    s_waitcnt vmcnt(20) lgkmcnt(0)
    v_exp_f32 v241, v241
    v_exp_f32 v242, v242
    v_exp_f32 v243, v243
    v_mfma_f32_16x16x32_bf16 v[0:3], a[108:111], v[176:179], v[0:3]
    ds_read_b128 a[72:75], v232 offset:36864
    v_add_f32 v240, 1.0, v240
    v_mfma_f32_16x16x32_bf16 v[36:39], a[108:111], v[180:183], v[36:39]
    ds_read_b128 a[76:79], v232 offset:37888
    v_add_f32 v241, 1.0, v241
    v_mfma_f32_16x16x32_bf16 v[4:7], a[112:115], v[176:179], v[4:7]
    ds_read_b128 a[80:83], v232 offset:38912
    v_add_f32 v242, 1.0, v242
    v_mfma_f32_16x16x32_bf16 v[40:43], a[112:115], v[180:183], v[40:43]
    ds_read_b128 a[84:87], v232 offset:39936
    v_add_f32 v243, 1.0, v243
    v_mfma_f32_16x16x32_bf16 v[8:11], a[116:119], v[176:179], v[8:11]
    v_rcp_f32 v240, v240
    v_mfma_f32_16x16x32_bf16 v[44:47], a[116:119], v[180:183], v[44:47]
    v_rcp_f32 v241, v241
    v_mfma_f32_16x16x32_bf16 v[12:15], a[120:123], v[176:179], v[12:15]
    v_rcp_f32 v242, v242
    v_mfma_f32_16x16x32_bf16 v[48:51], a[120:123], v[180:183], v[48:51]
    v_rcp_f32 v243, v243
    v_mfma_f32_16x16x32_bf16 v[16:19], a[124:127], v[176:179], v[16:19]
    ds_read_b128 a[88:91], v232 offset:40960
    v_mul_f32 v212, v212, v240
    v_mfma_f32_16x16x32_bf16 v[52:55], a[124:127], v[180:183], v[52:55]
    ds_read_b128 a[92:95], v232 offset:41984
    v_mul_f32 v213, v213, v241
    v_mfma_f32_16x16x32_bf16 v[20:23], a[128:131], v[176:179], v[20:23]
    ds_read_b128 a[96:99], v232 offset:43008
    v_exp_f32 v160, v160
    v_mfma_f32_16x16x32_bf16 v[56:59], a[128:131], v[180:183], v[56:59]
    ds_read_b128 a[100:103], v232 offset:44032
    v_exp_f32 v161, v161
    v_mfma_f32_16x16x32_bf16 v[24:27], a[132:135], v[176:179], v[24:27]
    s_add_u32 s8, s8, 73728
    s_addc_u32 s9, s9, 0
    ds_read_b128 a[104:107], v232 offset:45056
    v_mfma_f32_16x16x32_bf16 v[60:63], a[132:135], v[180:183], v[60:63]
    s_sub_u32 s10, s10, 73728
    v_exp_f32 v168, v168
    v_mfma_f32_16x16x32_bf16 v[28:31], a[136:139], v[176:179], v[28:31]
    s_max_i32 s10, s10, 0
    v_exp_f32 v169, v169
    v_mfma_f32_16x16x32_bf16 v[64:67], a[136:139], v[180:183], v[64:67]
    s_add_u32 m0, s64, 0
    v_cvt_pk_bf16_f32 v184, v160, v161
    v_exp_f32 v162, v162
    v_mfma_f32_16x16x32_bf16 v[32:35], a[140:143], v[176:179], v[32:35]
    v_exp_f32 v163, v163
    v_mfma_f32_16x16x32_bf16 v[68:71], a[140:143], v[180:183], v[68:71]
    s_waitcnt lgkmcnt(0)
    v_mul_f32 v214, v214, v242
    v_mfma_f32_32x32x16_bf16 v[144:159], a[72:75], a[0:3], 0
    v_cvt_pk_bf16_f32 v188, v168, v169
    v_exp_f32 v170, v170
    v_exp_f32 v171, v171
    v_mul_f32 v215, v215, v243
    v_mfma_f32_32x32x16_bf16 v[144:159], a[76:79], a[4:7], v[144:159]
    v_cvt_pk_bf16_f32 v185, v162, v163
    v_permlane16_swap_b32 v184, v188
    v_exp_f32 v164, v164
    v_mul_f32 v240, v216, v216
    v_mfma_f32_32x32x16_bf16 v[144:159], a[80:83], a[8:11], v[144:159]
    buffer_load_dwordx4 v239, s[8:11], s18 offen offset:0 sc1 lds
    v_exp_f32 v165, v165
    v_cvt_pk_bf16_f32 v189, v170, v171
    v_exp_f32 v172, v172
    v_mfma_f32_32x32x16_bf16 v[144:159], a[84:87], a[12:15], v[144:159]
    v_exp_f32 v173, v173
    v_cvt_pk_bf16_f32 v186, v164, v165
    v_permlane16_swap_b32 v185, v189
    v_mul_f32 v241, v217, v217
    v_mfma_f32_32x32x16_bf16 v[144:159], a[88:91], a[16:19], v[144:159]
    buffer_load_dwordx4 v239, s[8:11], s19 offen offset:1024 sc1 lds
    v_exp_f32 v166, v166
    v_exp_f32 v167, v167
    v_mfma_f32_32x32x16_bf16 v[144:159], a[92:95], a[20:23], v[144:159]
    v_cvt_pk_bf16_f32 v190, v172, v173
    v_exp_f32 v174, v174
    v_exp_f32 v175, v175
    v_mul_f32 v242, v218, v218
    v_mfma_f32_32x32x16_bf16 v[144:159], a[96:99], a[24:27], v[144:159]
    v_cvt_pk_bf16_f32 v187, v166, v167
    v_permlane16_swap_b32 v186, v190
    v_cvt_pk_bf16_f32 v191, v174, v175
    v_mul_f32 v243, v219, v219
    v_fma_f32 v240, v240, s60, v248
    v_mfma_f32_32x32x16_bf16 v[144:159], a[100:103], a[28:31], v[144:159]
    buffer_load_dwordx4 v239, s[8:11], s20 offen offset:2048 sc1 lds
    v_permlane16_swap_b32 v187, v191
    v_fma_f32 v241, v241, s60, v248
    v_fma_f32 v242, v242, s60, v248
    v_mfma_f32_32x32x16_bf16 v[144:159], a[104:107], a[32:35], v[144:159]
    buffer_load_dwordx4 v239, s[8:11], s21 offen offset:3072 sc1 lds
    s_add_u32 m0, s64, 4096
    v_fma_f32 v243, v243, s60, v248
    v_mul_f32 v240, v240, v216
    v_mul_f32 v241, v241, v217
    v_mfma_f32_16x16x32_bf16 v[72:75], a[108:111], v[184:187], v[72:75]
    v_mul_f32 v242, v242, v218
    v_mfma_f32_16x16x32_bf16 v[108:111], a[108:111], v[188:191], v[108:111]
    ds_read_b64_tr_b16 a[108:109], v234 offset:36864
    v_mul_f32 v243, v243, v219
    v_mfma_f32_16x16x32_bf16 v[76:79], a[112:115], v[184:187], v[76:79]
    v_exp_f32 v240, v240
    v_mfma_f32_16x16x32_bf16 v[112:115], a[112:115], v[188:191], v[112:115]
    v_exp_f32 v241, v241
    v_mfma_f32_16x16x32_bf16 v[80:83], a[116:119], v[184:187], v[80:83]
    v_exp_f32 v242, v242
    v_mfma_f32_16x16x32_bf16 v[116:119], a[116:119], v[188:191], v[116:119]
    v_exp_f32 v144, v144
    v_mfma_f32_16x16x32_bf16 v[84:87], a[120:123], v[184:187], v[84:87]
    v_exp_f32 v145, v145
    v_mfma_f32_16x16x32_bf16 v[120:123], a[120:123], v[188:191], v[120:123]
    v_exp_f32 v152, v152
    v_mfma_f32_16x16x32_bf16 v[88:91], a[124:127], v[184:187], v[88:91]
    v_exp_f32 v153, v153
    v_mfma_f32_16x16x32_bf16 v[124:127], a[124:127], v[188:191], v[124:127]
    buffer_load_dwordx4 v239, s[8:11], s22 offen offset:0 sc1 lds
    v_mfma_f32_16x16x32_bf16 v[92:95], a[128:131], v[184:187], v[92:95]
    v_cvt_pk_bf16_f32 v176, v144, v145
    v_exp_f32 v146, v146
    v_mfma_f32_16x16x32_bf16 v[128:131], a[128:131], v[188:191], v[128:131]
    v_exp_f32 v147, v147
    v_mfma_f32_16x16x32_bf16 v[96:99], a[132:135], v[184:187], v[96:99]
    ds_read_b64_tr_b16 a[110:111], v236 offset:36864
    v_cvt_pk_bf16_f32 v180, v152, v153
    v_mfma_f32_16x16x32_bf16 v[132:135], a[132:135], v[188:191], v[132:135]
    v_exp_f32 v154, v154
    v_mfma_f32_16x16x32_bf16 v[100:103], a[136:139], v[184:187], v[100:103]
    v_exp_f32 v155, v155
    v_mfma_f32_16x16x32_bf16 v[136:139], a[136:139], v[188:191], v[136:139]
    buffer_load_dwordx4 v239, s[8:11], s23 offen offset:1024 sc1 lds
    v_mfma_f32_16x16x32_bf16 v[104:107], a[140:143], v[184:187], v[104:107]
    v_cvt_pk_bf16_f32 v177, v146, v147
    v_permlane16_swap_b32 v176, v180
    v_mfma_f32_16x16x32_bf16 v[140:143], a[140:143], v[188:191], v[140:143]
    v_exp_f32 v148, v148
    v_mfma_f32_32x32x16_bf16 v[160:175], a[72:75], a[36:39], 0
    buffer_load_dwordx4 v239, s[8:11], s24 offen offset:2048 sc1 lds
    ds_read_b64_tr_b16 a[112:113], v234 offset:37888
    v_exp_f32 v149, v149
    v_cvt_pk_bf16_f32 v181, v154, v155
    v_mfma_f32_32x32x16_bf16 v[160:175], a[76:79], a[40:43], v[160:175]
    ds_read_b64_tr_b16 a[114:115], v236 offset:37888
    ds_read_b64_tr_b16 a[116:117], v234 offset:38912
    v_exp_f32 v156, v156
    v_exp_f32 v157, v157
    v_mfma_f32_32x32x16_bf16 v[160:175], a[80:83], a[44:47], v[160:175]
    ds_read_b64_tr_b16 a[118:119], v236 offset:38912
    ds_read_b64_tr_b16 a[120:121], v234 offset:39936
    ds_read_b64_tr_b16 a[122:123], v236 offset:39936
    v_cvt_pk_bf16_f32 v178, v148, v149
    v_permlane16_swap_b32 v177, v181
    v_mfma_f32_32x32x16_bf16 v[160:175], a[84:87], a[48:51], v[160:175]
    ds_read_b64_tr_b16 a[124:125], v234 offset:40960
    ds_read_b64_tr_b16 a[126:127], v236 offset:40960
    v_exp_f32 v150, v150
    v_exp_f32 v151, v151
    v_mfma_f32_32x32x16_bf16 v[160:175], a[88:91], a[52:55], v[160:175]
    buffer_load_dwordx4 v239, s[8:11], s25 offen offset:3072 sc1 lds
    ds_read_b64_tr_b16 a[128:129], v234 offset:41984
    v_cvt_pk_bf16_f32 v182, v156, v157
    v_exp_f32 v158, v158
    v_mfma_f32_32x32x16_bf16 v[160:175], a[92:95], a[56:59], v[160:175]
    ds_read_b64_tr_b16 a[130:131], v236 offset:41984
    ds_read_b64_tr_b16 a[132:133], v234 offset:43008
    ds_read_b64_tr_b16 a[134:135], v236 offset:43008
    v_exp_f32 v159, v159
    v_cvt_pk_bf16_f32 v179, v150, v151
    v_mfma_f32_32x32x16_bf16 v[160:175], a[96:99], a[60:63], v[160:175]
    s_add_u32 m0, s64, 8192
    ds_read_b64_tr_b16 a[136:137], v234 offset:44032
    ds_read_b64_tr_b16 a[138:139], v236 offset:44032
    ds_read_b64_tr_b16 a[140:141], v234 offset:45056
    ds_read_b64_tr_b16 a[142:143], v236 offset:45056
    v_permlane16_swap_b32 v178, v182
    v_cvt_pk_bf16_f32 v183, v158, v159
    v_mfma_f32_32x32x16_bf16 v[160:175], a[100:103], a[64:67], v[160:175]
    buffer_load_dwordx4 v239, s[8:11], s26 offen offset:0 sc1 lds
    v_permlane16_swap_b32 v179, v183
    v_exp_f32 v243, v243
    v_mfma_f32_32x32x16_bf16 v[160:175], a[104:107], a[68:71], v[160:175]
    s_waitcnt vmcnt(19) lgkmcnt(0)
    v_add_f32 v240, 1.0, v240
    v_add_f32 v241, 1.0, v241
    v_add_f32 v242, 1.0, v242
    v_add_f32 v243, 1.0, v243
    v_rcp_f32 v240, v240
    v_mfma_f32_16x16x32_bf16 v[0:3], a[108:111], v[176:179], v[0:3]
    v_rcp_f32 v241, v241
    v_mfma_f32_16x16x32_bf16 v[36:39], a[108:111], v[180:183], v[36:39]
    v_rcp_f32 v242, v242
    v_mfma_f32_16x16x32_bf16 v[4:7], a[112:115], v[176:179], v[4:7]
    v_rcp_f32 v243, v243
    v_mfma_f32_16x16x32_bf16 v[40:43], a[112:115], v[180:183], v[40:43]
    ds_read_b128 a[72:75], v233 offset:0
    v_mfma_f32_16x16x32_bf16 v[8:11], a[116:119], v[176:179], v[8:11]
    ds_read_b128 a[76:79], v233 offset:1024
    v_mfma_f32_16x16x32_bf16 v[44:47], a[116:119], v[180:183], v[44:47]
    ds_read_b128 a[80:83], v233 offset:2048
    v_mfma_f32_16x16x32_bf16 v[12:15], a[120:123], v[176:179], v[12:15]
    s_add_u32 s8, s8, 73728
    s_addc_u32 s9, s9, 0
    ds_read_b128 a[84:87], v233 offset:3072
    v_mfma_f32_16x16x32_bf16 v[48:51], a[120:123], v[180:183], v[48:51]
    ds_read_b128 a[88:91], v233 offset:4096
    v_mul_f32 v216, v216, v240
    v_mfma_f32_16x16x32_bf16 v[16:19], a[124:127], v[176:179], v[16:19]
    ds_read_b128 a[92:95], v233 offset:5120
    v_mul_f32 v217, v217, v241
    v_mfma_f32_16x16x32_bf16 v[52:55], a[124:127], v[180:183], v[52:55]
    ds_read_b128 a[96:99], v233 offset:6144
    v_mul_f32 v218, v218, v242
    v_mfma_f32_16x16x32_bf16 v[20:23], a[128:131], v[176:179], v[20:23]
    ds_read_b128 a[100:103], v233 offset:7168
    v_and_b32 v249, 24, v231
    v_mfma_f32_16x16x32_bf16 v[56:59], a[128:131], v[180:183], v[56:59]
    s_bfe_u32 s69, s2, 0x40003
    v_exp_f32 v160, v160
    v_mfma_f32_16x16x32_bf16 v[24:27], a[132:135], v[176:179], v[24:27]
    s_lshl_b32 s69, s69, 7
    ds_read_b128 a[104:107], v233 offset:8192
    v_exp_f32 v161, v161
    v_mfma_f32_16x16x32_bf16 v[60:63], a[132:135], v[180:183], v[60:63]
    s_sub_u32 s10, s10, 73728
    v_exp_f32 v168, v168
    v_mfma_f32_16x16x32_bf16 v[28:31], a[136:139], v[176:179], v[28:31]
    s_max_i32 s10, s10, 0
    v_exp_f32 v169, v169
    v_mfma_f32_16x16x32_bf16 v[64:67], a[136:139], v[180:183], v[64:67]
    s_add_u32 m0, s64, 36864
    v_cvt_pk_bf16_f32 v184, v160, v161
    v_exp_f32 v162, v162
    v_mfma_f32_16x16x32_bf16 v[32:35], a[140:143], v[176:179], v[32:35]
    s_add_u32 s70, s69, 4804608
    v_exp_f32 v163, v163
    v_mfma_f32_16x16x32_bf16 v[68:71], a[140:143], v[180:183], v[68:71]
    s_waitcnt lgkmcnt(0)
    v_lshlrev_b32 v249, 8, v249
    v_mfma_f32_32x32x16_bf16 v[144:159], a[72:75], a[0:3], 0
    v_cvt_pk_bf16_f32 v188, v168, v169
    v_exp_f32 v170, v170
    v_exp_f32 v171, v171
    v_cvt_pk_bf16_f32 v185, v162, v163
    v_mfma_f32_32x32x16_bf16 v[144:159], a[76:79], a[4:7], v[144:159]
    v_permlane16_swap_b32 v184, v188
    v_exp_f32 v164, v164
    v_exp_f32 v165, v165
    v_mfma_f32_32x32x16_bf16 v[144:159], a[80:83], a[8:11], v[144:159]
    buffer_load_dwordx4 v239, s[8:11], s18 offen offset:0 sc1 lds
    v_cvt_pk_bf16_f32 v189, v170, v171
    v_exp_f32 v172, v172
    v_mul_f32 v219, v219, v243
    v_mfma_f32_32x32x16_bf16 v[144:159], a[84:87], a[12:15], v[144:159]
    v_exp_f32 v173, v173
    v_cvt_pk_bf16_f32 v186, v164, v165
    v_permlane16_swap_b32 v185, v189
    v_mul_f32 v240, v220, v220
    v_mfma_f32_32x32x16_bf16 v[144:159], a[88:91], a[16:19], v[144:159]
    v_exp_f32 v166, v166
    v_exp_f32 v167, v167
    v_cvt_pk_bf16_f32 v190, v172, v173
    v_mul_f32 v241, v221, v221
    v_mfma_f32_32x32x16_bf16 v[144:159], a[92:95], a[20:23], v[144:159]
    buffer_load_dwordx4 v239, s[8:11], s19 offen offset:1024 sc1 lds
    v_exp_f32 v174, v174
    v_exp_f32 v175, v175
    v_mfma_f32_32x32x16_bf16 v[144:159], a[96:99], a[24:27], v[144:159]
    v_cvt_pk_bf16_f32 v187, v166, v167
    v_permlane16_swap_b32 v186, v190
    v_cvt_pk_bf16_f32 v191, v174, v175
    v_mul_f32 v242, v222, v222
    v_mul_f32 v243, v223, v223
    v_mfma_f32_32x32x16_bf16 v[144:159], a[100:103], a[28:31], v[144:159]
    buffer_load_dwordx4 v239, s[8:11], s20 offen offset:2048 sc1 lds
    v_permlane16_swap_b32 v187, v191
    v_fma_f32 v240, v240, s60, v248
    v_fma_f32 v241, v241, s60, v248
    v_mfma_f32_32x32x16_bf16 v[144:159], a[104:107], a[32:35], v[144:159]
    buffer_load_dwordx4 v239, s[8:11], s21 offen offset:3072 sc1 lds
    v_fma_f32 v242, v242, s60, v248
    v_fma_f32 v243, v243, s60, v248
    v_mul_f32 v240, v240, v220
    v_mul_f32 v241, v241, v221
    v_mfma_f32_16x16x32_bf16 v[72:75], a[108:111], v[184:187], v[72:75]
    v_mul_f32 v242, v242, v222
    v_mfma_f32_16x16x32_bf16 v[108:111], a[108:111], v[188:191], v[108:111]
    ds_read_b64_tr_b16 a[108:109], v235 offset:0
    v_mfma_f32_16x16x32_bf16 v[76:79], a[112:115], v[184:187], v[76:79]
    ds_read_b64_tr_b16 a[110:111], v237 offset:0
    v_mfma_f32_16x16x32_bf16 v[112:115], a[112:115], v[188:191], v[112:115]
    ds_read_b64_tr_b16 a[112:113], v235 offset:1024
    v_mfma_f32_16x16x32_bf16 v[80:83], a[116:119], v[184:187], v[80:83]
    ds_read_b64_tr_b16 a[114:115], v237 offset:1024
    v_mul_f32 v243, v243, v223
    v_mfma_f32_16x16x32_bf16 v[116:119], a[116:119], v[188:191], v[116:119]
    v_exp_f32 v144, v144
    v_mfma_f32_16x16x32_bf16 v[84:87], a[120:123], v[184:187], v[84:87]
    v_exp_f32 v145, v145
    v_mfma_f32_16x16x32_bf16 v[120:123], a[120:123], v[188:191], v[120:123]
    s_add_u32 m0, s64, 40960
    v_exp_f32 v152, v152
    v_mfma_f32_16x16x32_bf16 v[88:91], a[124:127], v[184:187], v[88:91]
    buffer_load_dwordx4 v239, s[8:11], s22 offen offset:0 sc1 lds
    v_mfma_f32_16x16x32_bf16 v[124:127], a[124:127], v[188:191], v[124:127]
    v_exp_f32 v153, v153
    v_mfma_f32_16x16x32_bf16 v[92:95], a[128:131], v[184:187], v[92:95]
    ds_read_b64_tr_b16 a[116:117], v235 offset:2048
    v_cvt_pk_bf16_f32 v176, v144, v145
    v_mfma_f32_16x16x32_bf16 v[128:131], a[128:131], v[188:191], v[128:131]
    v_exp_f32 v146, v146
    v_mfma_f32_16x16x32_bf16 v[96:99], a[132:135], v[184:187], v[96:99]
    v_exp_f32 v147, v147
    v_mfma_f32_16x16x32_bf16 v[132:135], a[132:135], v[188:191], v[132:135]
    buffer_load_dwordx2 v[250:251], v249, s[52:55], s70 offen sc1
    v_mfma_f32_16x16x32_bf16 v[100:103], a[136:139], v[184:187], v[100:103]
    ds_read_b64_tr_b16 a[118:119], v237 offset:2048
    v_cvt_pk_bf16_f32 v180, v152, v153
    v_mfma_f32_16x16x32_bf16 v[136:139], a[136:139], v[188:191], v[136:139]
    v_exp_f32 v154, v154
    v_mfma_f32_16x16x32_bf16 v[104:107], a[140:143], v[184:187], v[104:107]
    v_exp_f32 v155, v155
    v_mfma_f32_16x16x32_bf16 v[140:143], a[140:143], v[188:191], v[140:143]
    ds_read_b64_tr_b16 a[120:121], v235 offset:3072
    v_cvt_pk_bf16_f32 v177, v146, v147
    v_mfma_f32_32x32x16_bf16 v[160:175], a[72:75], a[36:39], 0
    buffer_load_dwordx4 v239, s[8:11], s23 offen offset:1024 sc1 lds
    v_permlane16_swap_b32 v176, v180
    v_exp_f32 v148, v148
    v_mfma_f32_32x32x16_bf16 v[160:175], a[76:79], a[40:43], v[160:175]
    buffer_load_dwordx4 v239, s[8:11], s24 offen offset:2048 sc1 lds
    ds_read_b64_tr_b16 a[122:123], v237 offset:3072
    ds_read_b64_tr_b16 a[124:125], v235 offset:4096
    v_exp_f32 v149, v149
    v_mfma_f32_32x32x16_bf16 v[160:175], a[80:83], a[44:47], v[160:175]
    ds_read_b64_tr_b16 a[126:127], v237 offset:4096
    v_cvt_pk_bf16_f32 v181, v154, v155
    v_exp_f32 v156, v156
    v_exp_f32 v157, v157
    v_mfma_f32_32x32x16_bf16 v[160:175], a[84:87], a[48:51], v[160:175]
    ds_read_b64_tr_b16 a[128:129], v235 offset:5120
    ds_read_b64_tr_b16 a[130:131], v237 offset:5120
    ds_read_b64_tr_b16 a[132:133], v235 offset:6144
    v_cvt_pk_bf16_f32 v178, v148, v149
    v_permlane16_swap_b32 v177, v181
    v_mfma_f32_32x32x16_bf16 v[160:175], a[88:91], a[52:55], v[160:175]
    buffer_load_dwordx4 v239, s[8:11], s25 offen offset:3072 sc1 lds
    v_exp_f32 v150, v150
    v_exp_f32 v151, v151
    v_mfma_f32_32x32x16_bf16 v[160:175], a[92:95], a[56:59], v[160:175]
    ds_read_b64_tr_b16 a[134:135], v237 offset:6144
    ds_read_b64_tr_b16 a[136:137], v235 offset:7168
    v_cvt_pk_bf16_f32 v182, v156, v157
    v_exp_f32 v158, v158
    v_exp_f32 v159, v159
    v_mfma_f32_32x32x16_bf16 v[160:175], a[96:99], a[60:63], v[160:175]
    s_add_u32 m0, s64, 45056
    ds_read_b64_tr_b16 a[138:139], v237 offset:7168
    ds_read_b64_tr_b16 a[140:141], v235 offset:8192
    ds_read_b64_tr_b16 a[142:143], v237 offset:8192
    v_cvt_pk_bf16_f32 v179, v150, v151
    v_permlane16_swap_b32 v178, v182
    v_cvt_pk_bf16_f32 v183, v158, v159
    v_mfma_f32_32x32x16_bf16 v[160:175], a[100:103], a[64:67], v[160:175]
    buffer_load_dwordx4 v239, s[8:11], s26 offen offset:0 sc1 lds
    v_permlane16_swap_b32 v179, v183
    v_exp_f32 v240, v240
    v_mfma_f32_32x32x16_bf16 v[160:175], a[104:107], a[68:71], v[160:175]
    s_waitcnt vmcnt(19) lgkmcnt(0)
    v_exp_f32 v241, v241
    v_exp_f32 v242, v242
    v_exp_f32 v243, v243
    v_mfma_f32_16x16x32_bf16 v[0:3], a[108:111], v[176:179], v[0:3]
    ds_read_b128 a[72:75], v233 offset:36864
    v_add_f32 v240, 1.0, v240
    v_mfma_f32_16x16x32_bf16 v[36:39], a[108:111], v[180:183], v[36:39]
    ds_read_b128 a[76:79], v233 offset:37888
    v_add_f32 v241, 1.0, v241
    v_mfma_f32_16x16x32_bf16 v[4:7], a[112:115], v[176:179], v[4:7]
    ds_read_b128 a[80:83], v233 offset:38912
    v_add_f32 v242, 1.0, v242
    v_mfma_f32_16x16x32_bf16 v[40:43], a[112:115], v[180:183], v[40:43]
    s_add_u32 s8, s8, 73728
    s_addc_u32 s9, s9, 0
    v_add_f32 v243, 1.0, v243
    v_mfma_f32_16x16x32_bf16 v[8:11], a[116:119], v[176:179], v[8:11]
    v_rcp_f32 v240, v240
    v_mfma_f32_16x16x32_bf16 v[44:47], a[116:119], v[180:183], v[44:47]
    v_rcp_f32 v241, v241
    v_mfma_f32_16x16x32_bf16 v[12:15], a[120:123], v[176:179], v[12:15]
    v_rcp_f32 v242, v242
    v_mfma_f32_16x16x32_bf16 v[48:51], a[120:123], v[180:183], v[48:51]
    ds_read_b128 a[84:87], v233 offset:39936
    v_rcp_f32 v243, v243
    v_mfma_f32_16x16x32_bf16 v[16:19], a[124:127], v[176:179], v[16:19]
    ds_read_b128 a[88:91], v233 offset:40960
    v_mul_f32 v220, v220, v240
    v_mfma_f32_16x16x32_bf16 v[52:55], a[124:127], v[180:183], v[52:55]
    ds_read_b128 a[92:95], v233 offset:41984
    v_mul_f32 v221, v221, v241
    v_mfma_f32_16x16x32_bf16 v[20:23], a[128:131], v[176:179], v[20:23]
    ds_read_b128 a[96:99], v233 offset:43008
    v_mul_f32 v222, v222, v242
    v_mfma_f32_16x16x32_bf16 v[56:59], a[128:131], v[180:183], v[56:59]
    ds_read_b128 a[100:103], v233 offset:44032
    v_exp_f32 v160, v160
    v_mfma_f32_16x16x32_bf16 v[24:27], a[132:135], v[176:179], v[24:27]
    ds_read_b128 a[104:107], v233 offset:45056
    v_exp_f32 v161, v161
    v_mfma_f32_16x16x32_bf16 v[60:63], a[132:135], v[180:183], v[60:63]
    s_sub_u32 s10, s10, 73728
    v_exp_f32 v168, v168
    v_mfma_f32_16x16x32_bf16 v[28:31], a[136:139], v[176:179], v[28:31]
    s_max_i32 s10, s10, 0
    v_exp_f32 v169, v169
    v_mfma_f32_16x16x32_bf16 v[64:67], a[136:139], v[180:183], v[64:67]
    s_add_u32 m0, s64, 73728
    v_cvt_pk_bf16_f32 v184, v160, v161
    v_exp_f32 v162, v162
    v_mfma_f32_16x16x32_bf16 v[32:35], a[140:143], v[176:179], v[32:35]
    v_exp_f32 v163, v163
    v_mfma_f32_16x16x32_bf16 v[68:71], a[140:143], v[180:183], v[68:71]
    s_waitcnt lgkmcnt(0)
    v_mul_f32 v223, v223, v243
    v_mfma_f32_32x32x16_bf16 v[144:159], a[72:75], a[0:3], 0
    v_cvt_pk_bf16_f32 v188, v168, v169
    v_exp_f32 v170, v170
    v_exp_f32 v171, v171
    v_cvt_pk_bf16_f32 v185, v162, v163
    v_mfma_f32_32x32x16_bf16 v[144:159], a[76:79], a[4:7], v[144:159]
    buffer_load_dwordx4 v239, s[8:11], s18 offen offset:0 sc1 lds
    v_permlane16_swap_b32 v184, v188
    v_exp_f32 v164, v164
    v_mfma_f32_32x32x16_bf16 v[144:159], a[80:83], a[8:11], v[144:159]
    v_exp_f32 v165, v165
    v_cvt_pk_bf16_f32 v189, v170, v171
    v_exp_f32 v172, v172
    v_mfma_f32_32x32x16_bf16 v[144:159], a[84:87], a[12:15], v[144:159]
    v_exp_f32 v173, v173
    v_cvt_pk_bf16_f32 v186, v164, v165
    v_permlane16_swap_b32 v185, v189
    v_mul_f32 v240, v224, v224
    v_mfma_f32_32x32x16_bf16 v[144:159], a[88:91], a[16:19], v[144:159]
    v_exp_f32 v166, v166
    v_exp_f32 v167, v167
    v_mul_f32 v241, v225, v225
    v_mul_f32 v242, v226, v226
    v_mfma_f32_32x32x16_bf16 v[144:159], a[92:95], a[20:23], v[144:159]
    buffer_load_dwordx4 v239, s[8:11], s19 offen offset:1024 sc1 lds
    v_cvt_pk_bf16_f32 v190, v172, v173
    v_exp_f32 v174, v174
    v_mul_f32 v243, v227, v227
    v_mfma_f32_32x32x16_bf16 v[144:159], a[96:99], a[24:27], v[144:159]
    v_exp_f32 v175, v175
    v_cvt_pk_bf16_f32 v187, v166, v167
    v_permlane16_swap_b32 v186, v190
    v_cvt_pk_bf16_f32 v191, v174, v175
    v_mfma_f32_32x32x16_bf16 v[144:159], a[100:103], a[28:31], v[144:159]
    s_nop 0
    v_permlane16_swap_b32 v187, v191
    v_fma_f32 v240, v240, s60, v248
    v_fma_f32 v241, v241, s60, v248
    v_fma_f32 v242, v242, s60, v248
    v_fma_f32 v243, v243, s60, v248
    v_mfma_f32_32x32x16_bf16 v[144:159], a[104:107], a[32:35], v[144:159]
    buffer_load_dwordx4 v239, s[8:11], s20 offen offset:2048 sc1 lds
    v_mul_f32 v240, v240, v224
    v_mul_f32 v241, v241, v225
    v_mul_f32 v242, v242, v226
    v_mul_f32 v243, v243, v227
    v_pk_add_f32 v[244:245], v[208:209], v[210:211]
    v_pk_mul_f32 v[246:247], v[208:209], v[208:209]
    v_pk_add_f32 v[244:245], v[244:245], v[212:213]
    v_pk_fma_f32 v[246:247], v[210:211], v[210:211], v[246:247]
    v_pk_add_f32 v[244:245], v[244:245], v[214:215]
    v_pk_fma_f32 v[246:247], v[212:213], v[212:213], v[246:247]
    v_pk_add_f32 v[244:245], v[244:245], v[216:217]
    v_pk_fma_f32 v[246:247], v[214:215], v[214:215], v[246:247]
    v_pk_add_f32 v[244:245], v[244:245], v[218:219]
    v_pk_fma_f32 v[246:247], v[216:217], v[216:217], v[246:247]
    v_pk_add_f32 v[244:245], v[244:245], v[220:221]
    v_pk_fma_f32 v[246:247], v[218:219], v[218:219], v[246:247]
    v_pk_add_f32 v[244:245], v[244:245], v[222:223]
    v_pk_fma_f32 v[246:247], v[220:221], v[220:221], v[246:247]
    v_pk_fma_f32 v[246:247], v[222:223], v[222:223], v[246:247]
    v_add_f32 v245, v244, v245
    v_add_f32 v229, v246, v247
    v_mfma_f32_16x16x32_bf16 v[72:75], a[108:111], v[184:187], v[72:75]
    v_exp_f32 v240, v240
    v_mfma_f32_16x16x32_bf16 v[108:111], a[108:111], v[188:191], v[108:111]
    ds_read_b64_tr_b16 a[108:109], v235 offset:36864
    v_mfma_f32_16x16x32_bf16 v[76:79], a[112:115], v[184:187], v[76:79]
    ds_read_b64_tr_b16 a[110:111], v237 offset:36864
    v_mfma_f32_16x16x32_bf16 v[112:115], a[112:115], v[188:191], v[112:115]
    ds_read_b64_tr_b16 a[112:113], v235 offset:37888
    v_mfma_f32_16x16x32_bf16 v[80:83], a[116:119], v[184:187], v[80:83]
    buffer_load_dwordx4 v239, s[8:11], s21 offen offset:3072 sc1 lds
    v_mfma_f32_16x16x32_bf16 v[116:119], a[116:119], v[188:191], v[116:119]
    v_exp_f32 v144, v144
    v_mfma_f32_16x16x32_bf16 v[84:87], a[120:123], v[184:187], v[84:87]
    v_exp_f32 v145, v145
    v_mfma_f32_16x16x32_bf16 v[120:123], a[120:123], v[188:191], v[120:123]
    v_exp_f32 v152, v152
    v_mfma_f32_16x16x32_bf16 v[88:91], a[124:127], v[184:187], v[88:91]
    s_add_u32 m0, s64, 77824
    v_exp_f32 v153, v153
    v_mfma_f32_16x16x32_bf16 v[124:127], a[124:127], v[188:191], v[124:127]
    buffer_load_dwordx4 v239, s[8:11], s22 offen offset:0 sc1 lds
    v_mfma_f32_16x16x32_bf16 v[92:95], a[128:131], v[184:187], v[92:95]
    v_cvt_pk_bf16_f32 v176, v144, v145
    v_mfma_f32_16x16x32_bf16 v[128:131], a[128:131], v[188:191], v[128:131]
    v_exp_f32 v146, v146
    v_mfma_f32_16x16x32_bf16 v[96:99], a[132:135], v[184:187], v[96:99]
    v_exp_f32 v147, v147
    v_mfma_f32_16x16x32_bf16 v[132:135], a[132:135], v[188:191], v[132:135]
    v_cvt_pk_bf16_f32 v180, v152, v153
    v_exp_f32 v154, v154
    v_mfma_f32_16x16x32_bf16 v[100:103], a[136:139], v[184:187], v[100:103]
    v_exp_f32 v155, v155
    v_mfma_f32_16x16x32_bf16 v[136:139], a[136:139], v[188:191], v[136:139]
    buffer_load_dwordx4 v239, s[8:11], s23 offen offset:1024 sc1 lds
    v_mfma_f32_16x16x32_bf16 v[104:107], a[140:143], v[184:187], v[104:107]
    v_cvt_pk_bf16_f32 v177, v146, v147
    v_permlane16_swap_b32 v176, v180
    v_mfma_f32_16x16x32_bf16 v[140:143], a[140:143], v[188:191], v[140:143]
    v_exp_f32 v148, v148
    v_mfma_f32_32x32x16_bf16 v[160:175], a[72:75], a[36:39], 0
    buffer_load_dwordx4 v239, s[8:11], s24 offen offset:2048 sc1 lds
    ds_read_b64_tr_b16 a[114:115], v237 offset:37888
    v_exp_f32 v149, v149
    v_cvt_pk_bf16_f32 v181, v154, v155
    v_mfma_f32_32x32x16_bf16 v[160:175], a[76:79], a[40:43], v[160:175]
L_padg1:
    s_cbranch_execz L_walked1
    ds_read_b64_tr_b16 a[116:117], v235 offset:38912
    ds_read_b64_tr_b16 a[118:119], v237 offset:38912
    v_exp_f32 v156, v156
    v_exp_f32 v157, v157
    v_mfma_f32_32x32x16_bf16 v[160:175], a[80:83], a[44:47], v[160:175]
    ds_read_b64_tr_b16 a[120:121], v235 offset:39936
    ds_read_b64_tr_b16 a[122:123], v237 offset:39936
    ds_read_b64_tr_b16 a[124:125], v235 offset:40960
    v_cvt_pk_bf16_f32 v178, v148, v149
    v_permlane16_swap_b32 v177, v181
    v_mfma_f32_32x32x16_bf16 v[160:175], a[84:87], a[48:51], v[160:175]
    ds_read_b64_tr_b16 a[126:127], v237 offset:40960
    ds_read_b64_tr_b16 a[128:129], v235 offset:41984
    v_exp_f32 v150, v150
    v_exp_f32 v151, v151
    v_mfma_f32_32x32x16_bf16 v[160:175], a[88:91], a[52:55], v[160:175]
    buffer_load_dwordx4 v239, s[8:11], s25 offen offset:3072 sc1 lds
    ds_read_b64_tr_b16 a[130:131], v237 offset:41984
    v_cvt_pk_bf16_f32 v182, v156, v157
    v_exp_f32 v158, v158
    v_mfma_f32_32x32x16_bf16 v[160:175], a[92:95], a[56:59], v[160:175]
    ds_read_b64_tr_b16 a[132:133], v235 offset:43008
    ds_read_b64_tr_b16 a[134:135], v237 offset:43008
    ds_read_b64_tr_b16 a[136:137], v235 offset:44032
    v_exp_f32 v159, v159
    v_cvt_pk_bf16_f32 v179, v150, v151
    v_mfma_f32_32x32x16_bf16 v[160:175], a[96:99], a[60:63], v[160:175]
    s_add_u32 m0, s64, 81920
    ds_read_b64_tr_b16 a[138:139], v237 offset:44032
    ds_read_b64_tr_b16 a[140:141], v235 offset:45056
    ds_read_b64_tr_b16 a[142:143], v237 offset:45056
    v_permlane16_swap_b32 v178, v182
    v_cvt_pk_bf16_f32 v183, v158, v159
    v_mfma_f32_32x32x16_bf16 v[160:175], a[100:103], a[64:67], v[160:175]
    buffer_load_dwordx4 v239, s[8:11], s26 offen offset:0 sc1 lds
    v_permlane16_swap_b32 v179, v183
    v_exp_f32 v241, v241
    v_mfma_f32_32x32x16_bf16 v[160:175], a[104:107], a[68:71], v[160:175]
    s_waitcnt vmcnt(13) lgkmcnt(0)
    v_exp_f32 v242, v242
    v_exp_f32 v243, v243
    v_add_f32 v240, 1.0, v240
    v_add_f32 v241, 1.0, v241
    v_mfma_f32_16x16x32_bf16 v[0:3], a[108:111], v[176:179], v[0:3]
    ds_read_b128 a[72:75], v232 offset:0
    v_mfma_f32_16x16x32_bf16 v[36:39], a[108:111], v[180:183], v[36:39]
    ds_read_b128 a[76:79], v232 offset:1024
    v_add_f32 v242, 1.0, v242
    v_mfma_f32_16x16x32_bf16 v[4:7], a[112:115], v[176:179], v[4:7]
    ds_read_b128 a[80:83], v232 offset:2048
    v_add_f32 v243, 1.0, v243
    v_mfma_f32_16x16x32_bf16 v[40:43], a[112:115], v[180:183], v[40:43]
    v_rcp_f32 v240, v240
    v_mfma_f32_16x16x32_bf16 v[8:11], a[116:119], v[176:179], v[8:11]
    v_rcp_f32 v241, v241
    v_mfma_f32_16x16x32_bf16 v[44:47], a[116:119], v[180:183], v[44:47]
    v_rcp_f32 v242, v242
    v_mfma_f32_16x16x32_bf16 v[12:15], a[120:123], v[176:179], v[12:15]
    v_rcp_f32 v243, v243
    v_mfma_f32_16x16x32_bf16 v[48:51], a[120:123], v[180:183], v[48:51]
    ds_read_b128 a[84:87], v232 offset:3072
    v_mul_f32 v224, v224, v240
    v_mfma_f32_16x16x32_bf16 v[16:19], a[124:127], v[176:179], v[16:19]
    ds_read_b128 a[88:91], v232 offset:4096
    v_mul_f32 v225, v225, v241
    v_mfma_f32_16x16x32_bf16 v[52:55], a[124:127], v[180:183], v[52:55]
    ds_read_b128 a[92:95], v232 offset:5120
    v_mul_f32 v226, v226, v242
    v_mfma_f32_16x16x32_bf16 v[20:23], a[128:131], v[176:179], v[20:23]
    ds_read_b128 a[96:99], v232 offset:6144
    v_exp_f32 v160, v160
    v_mfma_f32_16x16x32_bf16 v[56:59], a[128:131], v[180:183], v[56:59]
    ds_read_b128 a[100:103], v232 offset:7168
    v_exp_f32 v161, v161
    v_mfma_f32_16x16x32_bf16 v[24:27], a[132:135], v[176:179], v[24:27]
    s_add_u32 s8, s8, 73728
    s_addc_u32 s9, s9, 0
    ds_read_b128 a[104:107], v232 offset:8192
    v_mfma_f32_16x16x32_bf16 v[60:63], a[132:135], v[180:183], v[60:63]
    s_sub_u32 s10, s10, 73728
    v_exp_f32 v168, v168
    v_mfma_f32_16x16x32_bf16 v[28:31], a[136:139], v[176:179], v[28:31]
    s_max_i32 s10, s10, 0
    v_exp_f32 v169, v169
    v_mfma_f32_16x16x32_bf16 v[64:67], a[136:139], v[180:183], v[64:67]
    s_add_u32 m0, s64, 110592
    v_cvt_pk_bf16_f32 v184, v160, v161
    v_exp_f32 v162, v162
    v_mfma_f32_16x16x32_bf16 v[32:35], a[140:143], v[176:179], v[32:35]
    v_exp_f32 v163, v163
    v_mfma_f32_16x16x32_bf16 v[68:71], a[140:143], v[180:183], v[68:71]
    s_waitcnt lgkmcnt(0)
    v_mul_f32 v227, v227, v243
    v_mfma_f32_32x32x16_bf16 v[144:159], a[72:75], a[0:3], 0
    v_cvt_pk_bf16_f32 v188, v168, v169
    v_exp_f32 v170, v170
    v_exp_f32 v171, v171
    v_subrev_co_u32 v252, vcc, s0, v250
    v_mfma_f32_32x32x16_bf16 v[144:159], a[76:79], a[4:7], v[144:159]
    v_cvt_pk_bf16_f32 v185, v162, v163
    v_permlane16_swap_b32 v184, v188
    v_exp_f32 v164, v164
    v_mov_b32 v253, s1
    v_mfma_f32_32x32x16_bf16 v[144:159], a[80:83], a[8:11], v[144:159]
    buffer_load_dwordx4 v239, s[8:11], s18 offen offset:0 sc1 lds
    v_exp_f32 v165, v165
    v_cvt_pk_bf16_f32 v189, v170, v171
    v_exp_f32 v172, v172
    v_mfma_f32_32x32x16_bf16 v[144:159], a[84:87], a[12:15], v[144:159]
    v_exp_f32 v173, v173
    v_cvt_pk_bf16_f32 v186, v164, v165
    v_permlane16_swap_b32 v185, v189
    v_subb_co_u32 v253, vcc, v251, v253, vcc
    v_mfma_f32_32x32x16_bf16 v[144:159], a[88:91], a[16:19], v[144:159]
    buffer_load_dwordx4 v239, s[8:11], s19 offen offset:1024 sc1 lds
    v_exp_f32 v166, v166
    v_exp_f32 v167, v167
    v_mfma_f32_32x32x16_bf16 v[144:159], a[92:95], a[20:23], v[144:159]
    v_cvt_pk_bf16_f32 v190, v172, v173
    v_exp_f32 v174, v174
    v_exp_f32 v175, v175
    v_lshrrev_b32 v252, 28, v252
    v_mfma_f32_32x32x16_bf16 v[144:159], a[96:99], a[24:27], v[144:159]
    v_cvt_pk_bf16_f32 v187, v166, v167
    v_permlane16_swap_b32 v186, v190
    v_cvt_pk_bf16_f32 v191, v174, v175
    v_or_b32 v252, v252, v253
    v_cmp_ne_u32 s[68:69], 0, v252
    v_mfma_f32_32x32x16_bf16 v[144:159], a[100:103], a[28:31], v[144:159]
    buffer_load_dwordx4 v239, s[8:11], s20 offen offset:2048 sc1 lds
    v_permlane16_swap_b32 v187, v191
    v_mov_b32 v246, v224
    v_mul_f32 v254, v224, v224
    v_mfma_f32_32x32x16_bf16 v[144:159], a[104:107], a[32:35], v[144:159]
    buffer_load_dwordx4 v239, s[8:11], s21 offen offset:3072 sc1 lds
    s_add_u32 m0, s64, 114688
    v_add_f32 v246, v246, v225
    v_fmac_f32 v254, v225, v225
    v_add_f32 v246, v246, v226
    v_mfma_f32_16x16x32_bf16 v[72:75], a[108:111], v[184:187], v[72:75]
    v_fmac_f32 v254, v226, v226
    v_mfma_f32_16x16x32_bf16 v[108:111], a[108:111], v[188:191], v[108:111]
    ds_read_b64_tr_b16 a[108:109], v234 offset:0
    v_add_f32 v246, v246, v227
    v_mfma_f32_16x16x32_bf16 v[76:79], a[112:115], v[184:187], v[76:79]
    ds_read_b64_tr_b16 a[110:111], v236 offset:0
    v_fmac_f32 v254, v227, v227
    v_mfma_f32_16x16x32_bf16 v[112:115], a[112:115], v[188:191], v[112:115]
    ds_read_b64_tr_b16 a[112:113], v234 offset:1024
    v_lshrrev_b32 v247, 7, v231
    v_mfma_f32_16x16x32_bf16 v[80:83], a[116:119], v[184:187], v[80:83]
    v_permlane32_swap_b32 v255, v245
    v_mfma_f32_16x16x32_bf16 v[116:119], a[116:119], v[188:191], v[116:119]
    v_permlane32_swap_b32 v228, v229
    v_mfma_f32_16x16x32_bf16 v[84:87], a[120:123], v[184:187], v[84:87]
    ds_read_b64_tr_b16 a[114:115], v236 offset:1024
    v_cmp_eq_u32 s[12:13], s3, v247
    v_mfma_f32_16x16x32_bf16 v[120:123], a[120:123], v[188:191], v[120:123]
    ds_read_b64_tr_b16 a[116:117], v234 offset:2048
    v_add_f32 v255, v255, v245
    v_mfma_f32_16x16x32_bf16 v[88:91], a[124:127], v[184:187], v[88:91]
    ds_read_b64_tr_b16 a[118:119], v236 offset:2048
    v_add_f32 v228, v228, v229
    v_mfma_f32_16x16x32_bf16 v[124:127], a[124:127], v[188:191], v[124:127]
    ds_read_b64_tr_b16 a[120:121], v234 offset:3072
    v_mov_b32 v240, v246
    v_mfma_f32_16x16x32_bf16 v[92:95], a[128:131], v[184:187], v[92:95]
    buffer_load_dwordx4 v239, s[8:11], s22 offen offset:0 sc1 lds
    v_mfma_f32_16x16x32_bf16 v[128:131], a[128:131], v[188:191], v[128:131]
    ds_read_b64_tr_b16 a[122:123], v236 offset:3072
    v_mov_b32 v241, v254
    v_mfma_f32_16x16x32_bf16 v[96:99], a[132:135], v[184:187], v[96:99]
    buffer_load_dwordx4 v239, s[8:11], s23 offen offset:1024 sc1 lds
    v_mfma_f32_16x16x32_bf16 v[132:135], a[132:135], v[188:191], v[132:135]
    v_exp_f32 v144, v144
    v_mfma_f32_16x16x32_bf16 v[100:103], a[136:139], v[184:187], v[100:103]
    v_exp_f32 v145, v145
    v_mfma_f32_16x16x32_bf16 v[136:139], a[136:139], v[188:191], v[136:139]
    v_exp_f32 v152, v152
    v_mfma_f32_16x16x32_bf16 v[104:107], a[140:143], v[184:187], v[104:107]
    v_exp_f32 v153, v153
    v_mfma_f32_16x16x32_bf16 v[140:143], a[140:143], v[188:191], v[140:143]
    ds_read_b64_tr_b16 a[124:125], v234 offset:4096
    v_cvt_pk_bf16_f32 v176, v144, v145
    v_mfma_f32_32x32x16_bf16 v[160:175], a[72:75], a[36:39], 0
    ds_read_b64_tr_b16 a[126:127], v236 offset:4096
    ds_read_b64_tr_b16 a[128:129], v234 offset:5120
    v_exp_f32 v146, v146
    v_exp_f32 v147, v147
    v_cvt_pk_bf16_f32 v180, v152, v153
    v_mfma_f32_32x32x16_bf16 v[160:175], a[76:79], a[40:43], v[160:175]
    buffer_load_dwordx4 v239, s[8:11], s24 offen offset:2048 sc1 lds
    ds_read_b64_tr_b16 a[130:131], v236 offset:5120
    v_exp_f32 v154, v154
    v_exp_f32 v155, v155
    v_mfma_f32_32x32x16_bf16 v[160:175], a[80:83], a[44:47], v[160:175]
    ds_read_b64_tr_b16 a[132:133], v234 offset:6144
    v_cvt_pk_bf16_f32 v177, v146, v147
    v_permlane16_swap_b32 v176, v180
    v_exp_f32 v148, v148
    v_exp_f32 v149, v149
    v_mfma_f32_32x32x16_bf16 v[160:175], a[84:87], a[48:51], v[160:175]
    ds_read_b64_tr_b16 a[134:135], v236 offset:6144
    v_cvt_pk_bf16_f32 v181, v154, v155
    v_exp_f32 v156, v156
    v_exp_f32 v157, v157
    v_cvt_pk_bf16_f32 v178, v148, v149
    v_mfma_f32_32x32x16_bf16 v[160:175], a[88:91], a[52:55], v[160:175]
    buffer_load_dwordx4 v239, s[8:11], s25 offen offset:3072 sc1 lds
    ds_read_b64_tr_b16 a[136:137], v234 offset:7168
    v_permlane16_swap_b32 v177, v181
    v_exp_f32 v150, v150
    v_mfma_f32_32x32x16_bf16 v[160:175], a[92:95], a[56:59], v[160:175]
    ds_read_b64_tr_b16 a[138:139], v236 offset:7168
    ds_read_b64_tr_b16 a[140:141], v234 offset:8192
    v_exp_f32 v151, v151
    v_cvt_pk_bf16_f32 v182, v156, v157
    v_exp_f32 v158, v158
    v_mfma_f32_32x32x16_bf16 v[160:175], a[96:99], a[60:63], v[160:175]
    s_add_u32 m0, s64, 118784
    ds_read_b64_tr_b16 a[142:143], v236 offset:8192
    v_exp_f32 v159, v159
    v_cvt_pk_bf16_f32 v179, v150, v151
    v_permlane16_swap_b32 v178, v182
    v_cvt_pk_bf16_f32 v183, v158, v159
    v_mfma_f32_32x32x16_bf16 v[160:175], a[100:103], a[64:67], v[160:175]
    buffer_load_dwordx4 v239, s[8:11], s26 offen offset:0 sc1 lds
    v_permlane16_swap_b32 v179, v183
    v_permlane16_swap_b32 v240, v246
    v_mfma_f32_32x32x16_bf16 v[160:175], a[104:107], a[68:71], v[160:175]
    s_waitcnt vmcnt(18) lgkmcnt(0)
    v_permlane16_swap_b32 v241, v254
    v_add_f32 v246, v246, v240
    v_add_f32 v254, v254, v241
    v_mov_b32 v240, v246
    v_mov_b32 v241, v254
    s_nop 0
    v_permlane32_swap_b32 v240, v246
    v_mfma_f32_16x16x32_bf16 v[0:3], a[108:111], v[176:179], v[0:3]
    v_permlane32_swap_b32 v241, v254
    v_mfma_f32_16x16x32_bf16 v[36:39], a[108:111], v[180:183], v[36:39]
    ds_read_b128 a[72:75], v232 offset:36864
    v_add_f32 v246, v246, v240
    v_mfma_f32_16x16x32_bf16 v[4:7], a[112:115], v[176:179], v[4:7]
    ds_read_b128 a[76:79], v232 offset:37888
    v_add_f32 v254, v254, v241
    v_mfma_f32_16x16x32_bf16 v[40:43], a[112:115], v[180:183], v[40:43]
    ds_read_b128 a[80:83], v232 offset:38912
    v_lshlrev_b32 v230, 1, v239
    v_mfma_f32_16x16x32_bf16 v[8:11], a[116:119], v[176:179], v[8:11]
    ds_read_b128 a[84:87], v232 offset:39936
    v_cndmask_b32 v242, 0, v246, s[12:13]
    v_mfma_f32_16x16x32_bf16 v[44:47], a[116:119], v[180:183], v[44:47]
    ds_read_b128 a[88:91], v232 offset:40960
    v_cndmask_b32 v243, 0, v254, s[12:13]
    v_mfma_f32_16x16x32_bf16 v[12:15], a[120:123], v[176:179], v[12:15]
    s_lshl_b32 s60, s3, 3
    ds_read_b128 a[92:95], v232 offset:41984
    v_add_u32 v230, 161792, v230
    v_mfma_f32_16x16x32_bf16 v[48:51], a[120:123], v[180:183], v[48:51]
    ds_read_b128 a[96:99], v232 offset:43008
    v_add_f32 v242, v242, v255
    v_mfma_f32_16x16x32_bf16 v[16:19], a[124:127], v[176:179], v[16:19]
    ds_read_b128 a[100:103], v232 offset:44032
    v_add_f32 v243, v243, v228
    v_mfma_f32_16x16x32_bf16 v[52:55], a[124:127], v[180:183], v[52:55]
    ds_read_b128 a[104:107], v232 offset:45056
    v_add_u32 v240, s60, v230
    v_mfma_f32_16x16x32_bf16 v[20:23], a[128:131], v[176:179], v[20:23]
    v_exp_f32 v160, v160
    v_mfma_f32_16x16x32_bf16 v[56:59], a[128:131], v[180:183], v[56:59]
    v_exp_f32 v161, v161
    v_mfma_f32_16x16x32_bf16 v[24:27], a[132:135], v[176:179], v[24:27]
    s_add_u32 s8, s8, 73728
    s_addc_u32 s9, s9, 0
    v_exp_f32 v168, v168
    v_mfma_f32_16x16x32_bf16 v[60:63], a[132:135], v[180:183], v[60:63]
    s_sub_u32 s10, s10, 73728
    v_exp_f32 v169, v169
    v_mfma_f32_16x16x32_bf16 v[28:31], a[136:139], v[176:179], v[28:31]
    s_max_i32 s10, s10, 0
    ds_write_b64 v240, v[242:243]
    v_mfma_f32_16x16x32_bf16 v[64:67], a[136:139], v[180:183], v[64:67]
    s_add_u32 m0, s64, 0
    v_cvt_pk_bf16_f32 v184, v160, v161
    v_exp_f32 v162, v162
    v_mfma_f32_16x16x32_bf16 v[32:35], a[140:143], v[176:179], v[32:35]
    v_exp_f32 v163, v163
    v_mfma_f32_16x16x32_bf16 v[68:71], a[140:143], v[180:183], v[68:71]
    s_waitcnt lgkmcnt(1)
    s_cmp_lg_u32 s68, 0
    s_cbranch_scc1 L_pollwg
L_wokg:
    v_mfma_f32_32x32x16_bf16 v[144:159], a[72:75], a[0:3], 0
    s_add_u32 s12, s64, 4764160
    v_cvt_pk_bf16_f32 v188, v168, v169
    v_exp_f32 v170, v170
    v_exp_f32 v171, v171
    v_cvt_pk_bf16_f32 v185, v162, v163
    v_mfma_f32_32x32x16_bf16 v[144:159], a[76:79], a[4:7], v[144:159]
    buffer_load_dwordx2 a[214:215], v231, s[52:55], s12 offen sc1
    v_permlane16_swap_b32 v184, v188
    v_exp_f32 v164, v164
    v_mfma_f32_32x32x16_bf16 v[144:159], a[80:83], a[8:11], v[144:159]
    s_waitcnt lgkmcnt(0)
    s_barrier
    v_exp_f32 v165, v165
    v_cvt_pk_bf16_f32 v189, v170, v171
    v_exp_f32 v172, v172
    v_mfma_f32_32x32x16_bf16 v[144:159], a[84:87], a[12:15], v[144:159]
    s_mul_i32 s60, s3, 4224
    ds_read_b128 v[240:243], v230
    ds_read_b128 v[244:247], v230 offset:16
    v_exp_f32 v173, v173
    v_cvt_pk_bf16_f32 v186, v164, v165
    v_mfma_f32_32x32x16_bf16 v[144:159], a[88:91], a[16:19], v[144:159]
    buffer_load_dwordx4 v239, s[8:11], s18 offen offset:0 sc1 lds
    v_permlane16_swap_b32 v185, v189
    v_exp_f32 v166, v166
    v_mfma_f32_32x32x16_bf16 v[144:159], a[92:95], a[20:23], v[144:159]
    s_add_u32 s12, s64, 4760064
    v_exp_f32 v167, v167
    v_cvt_pk_bf16_f32 v190, v172, v173
    v_exp_f32 v174, v174
    v_exp_f32 v175, v175
    v_mfma_f32_32x32x16_bf16 v[144:159], a[96:99], a[24:27], v[144:159]
    buffer_load_dwordx4 a[210:213], v239, s[52:55], s12 offen offset:3072 sc1
    v_cvt_pk_bf16_f32 v187, v166, v167
    v_permlane16_swap_b32 v186, v190
    v_cvt_pk_bf16_f32 v191, v174, v175
    v_mfma_f32_32x32x16_bf16 v[144:159], a[100:103], a[28:31], v[144:159]
    s_add_u32 s60, s60, 147456
    v_permlane16_swap_b32 v187, v191
    v_and_b32 v249, 0x78, v231
    v_add_u32 v249, s60, v249
    v_bfe_u32 v252, v231, 7, 1
    v_and_b32 v253, 0x1ff, v239
    v_mfma_f32_32x32x16_bf16 v[144:159], a[104:107], a[32:35], v[144:159]
    s_waitcnt lgkmcnt(0)
    buffer_load_dwordx4 v239, s[8:11], s19 offen offset:1024 sc1 lds
    v_mul_u32_u24 v252, 4352, v252
    v_lshrrev_b32 v248, 9, v239
    v_lshl_add_u32 v252, v248, 8, v252
    v_mfma_f32_16x16x32_bf16 v[72:75], a[108:111], v[184:187], v[72:75]
    v_add_u32 v248, v252, v253
    v_add_f32 v240, v240, v242
    v_add_f32 v241, v241, v243
    v_mfma_f32_16x16x32_bf16 v[108:111], a[108:111], v[188:191], v[108:111]
    ds_read_b64_tr_b16 a[108:109], v234 offset:36864
    v_add_f32 v244, v244, v246
    v_mfma_f32_16x16x32_bf16 v[76:79], a[112:115], v[184:187], v[76:79]
    ds_read_b64_tr_b16 a[110:111], v236 offset:36864
    v_add_f32 v245, v245, v247
    v_mfma_f32_16x16x32_bf16 v[112:115], a[112:115], v[188:191], v[112:115]
    s_lshl_b32 s60, s3, 12
    ds_read_b64_tr_b16 a[112:113], v234 offset:37888
    v_add_f32 v240, v240, v244
    v_mfma_f32_16x16x32_bf16 v[80:83], a[116:119], v[184:187], v[80:83]
    s_add_u32 s60, s60, 147456
    ds_read_b64_tr_b16 a[114:115], v236 offset:37888
    v_add_u32 v254, s60, v231
    v_mfma_f32_16x16x32_bf16 v[116:119], a[116:119], v[188:191], v[116:119]
    buffer_load_dwordx4 v239, s[8:11], s20 offen offset:2048 sc1 lds
    v_mfma_f32_16x16x32_bf16 v[84:87], a[120:123], v[184:187], v[84:87]
    s_nop 0
    ds_read_b64_tr_b16 a[116:117], v234 offset:38912
    ds_read_b64_tr_b16 a[118:119], v236 offset:38912
    v_mfma_f32_16x16x32_bf16 v[120:123], a[120:123], v[188:191], v[120:123]
    v_exp_f32 v144, v144
    v_mfma_f32_16x16x32_bf16 v[88:91], a[124:127], v[184:187], v[88:91]
    v_exp_f32 v145, v145
    v_mfma_f32_16x16x32_bf16 v[124:127], a[124:127], v[188:191], v[124:127]
    v_exp_f32 v152, v152
    v_mfma_f32_16x16x32_bf16 v[92:95], a[128:131], v[184:187], v[92:95]
    buffer_load_dwordx4 a[206:209], v239, s[52:55], s12 offen offset:2048 sc1
    v_mfma_f32_16x16x32_bf16 v[128:131], a[128:131], v[188:191], v[128:131]
    v_exp_f32 v153, v153
    v_mfma_f32_16x16x32_bf16 v[96:99], a[132:135], v[184:187], v[96:99]
    ds_read_b64_tr_b16 a[120:121], v234 offset:39936
    v_cvt_pk_bf16_f32 v176, v144, v145
    v_mfma_f32_16x16x32_bf16 v[132:135], a[132:135], v[188:191], v[132:135]
    s_lshl_b32 s68, s3, 10
    v_exp_f32 v146, v146
    v_mfma_f32_16x16x32_bf16 v[100:103], a[136:139], v[184:187], v[100:103]
    buffer_load_dwordx4 v239, s[8:11], s21 offen offset:3072 sc1 lds
    v_mfma_f32_16x16x32_bf16 v[136:139], a[136:139], v[188:191], v[136:139]
    s_mul_i32 s14, s66, 9216
    v_exp_f32 v147, v147
    v_mfma_f32_16x16x32_bf16 v[104:107], a[140:143], v[184:187], v[104:107]
    s_mul_i32 s15, s67, 9216
    ds_read_b64_tr_b16 a[122:123], v236 offset:39936
    v_cvt_pk_bf16_f32 v180, v152, v153
    v_mfma_f32_16x16x32_bf16 v[140:143], a[140:143], v[188:191], v[140:143]
    s_add_u32 s14, s14, s68
    v_exp_f32 v154, v154
    v_mfma_f32_32x32x16_bf16 v[160:175], a[72:75], a[36:39], 0
    buffer_load_dwordx4 a[202:205], v239, s[52:55], s12 offen offset:1024 sc1
    ds_read_b64_tr_b16 a[124:125], v234 offset:40960
    v_exp_f32 v155, v155
    v_cvt_pk_bf16_f32 v177, v146, v147
    v_mfma_f32_32x32x16_bf16 v[160:175], a[76:79], a[40:43], v[160:175]
    s_add_u32 s15, s15, s68
    ds_read_b64_tr_b16 a[126:127], v236 offset:40960
    v_permlane16_swap_b32 v176, v180
    v_exp_f32 v148, v148
    v_exp_f32 v149, v149
    v_mfma_f32_32x32x16_bf16 v[160:175], a[80:83], a[44:47], v[160:175]
    s_add_u32 m0, s64, 4096
    ds_read_b64_tr_b16 a[128:129], v234 offset:41984
    ds_read_b64_tr_b16 a[130:131], v236 offset:41984
    v_cvt_pk_bf16_f32 v181, v154, v155
    v_exp_f32 v156, v156
    v_exp_f32 v157, v157
    v_mfma_f32_32x32x16_bf16 v[160:175], a[84:87], a[48:51], v[160:175]
    buffer_load_dwordx4 v239, s[8:11], s22 offen offset:0 sc1 lds
    ds_read_b64_tr_b16 a[132:133], v234 offset:43008
    ds_read_b64_tr_b16 a[134:135], v236 offset:43008
    v_cvt_pk_bf16_f32 v178, v148, v149
    v_permlane16_swap_b32 v177, v181
    v_mfma_f32_32x32x16_bf16 v[160:175], a[88:91], a[52:55], v[160:175]
    s_mul_i32 s72, s74, 4608
    ds_read_b64_tr_b16 a[136:137], v234 offset:44032
    ds_read_b64_tr_b16 a[138:139], v236 offset:44032
    v_exp_f32 v150, v150
    v_exp_f32 v151, v151
    v_cvt_pk_bf16_f32 v182, v156, v157
    v_mfma_f32_32x32x16_bf16 v[160:175], a[92:95], a[56:59], v[160:175]
    buffer_load_dwordx4 v239, s[8:11], s23 offen offset:1024 sc1 lds
    ds_read_b64_tr_b16 a[140:141], v234 offset:45056
    v_exp_f32 v158, v158
    v_exp_f32 v159, v159
    v_mfma_f32_32x32x16_bf16 v[160:175], a[96:99], a[60:63], v[160:175]
    buffer_load_dwordx4 a[198:201], v239, s[52:55], s12 offen offset:0 sc1
    ds_read_b64_tr_b16 a[142:143], v236 offset:45056
    v_cvt_pk_bf16_f32 v179, v150, v151
    v_permlane16_swap_b32 v178, v182
    v_cvt_pk_bf16_f32 v183, v158, v159
    v_mfma_f32_32x32x16_bf16 v[160:175], a[100:103], a[64:67], v[160:175]
    s_add_u32 s72, s72, 4096
    v_permlane16_swap_b32 v179, v183
    v_add_f32 v241, v241, v245
    v_mul_f32 v240, 0x3be38e39, v240
    v_mul_f32 v241, 0x3be38e39, v241
    v_fma_f32 v241, -v240, v240, v241
    v_mfma_f32_32x32x16_bf16 v[160:175], a[104:107], a[68:71], v[160:175]
    s_waitcnt vmcnt(20) lgkmcnt(0)
    v_max_f32 v241, 0, v241
    v_add_f32 v241, 0x3727c5ac, v241
    v_rsq_f32 v243, v241
    s_nop 0
    v_mul_f32 v242, -v240, v243
    v_mov_b32 v228, v242
    v_mfma_f32_16x16x32_bf16 v[0:3], a[108:111], v[176:179], v[0:3]
    ds_read_b128 a[72:75], v233 offset:0
    v_mov_b32 v229, v243
    v_mfma_f32_16x16x32_bf16 v[36:39], a[108:111], v[180:183], v[36:39]
    ds_read_b128 a[76:79], v233 offset:1024
    v_mov_b32 v240, v242
    v_mfma_f32_16x16x32_bf16 v[4:7], a[112:115], v[176:179], v[4:7]
    buffer_load_dwordx4 v239, s[8:11], s24 offen offset:2048 sc1 lds
    v_mfma_f32_16x16x32_bf16 v[40:43], a[112:115], v[180:183], v[40:43]
    ds_read_b128 a[80:83], v233 offset:2048
    v_mov_b32 v241, v243
    v_mfma_f32_16x16x32_bf16 v[8:11], a[116:119], v[176:179], v[8:11]
    v_permlane32_swap_b32 v240, v242
    v_mfma_f32_16x16x32_bf16 v[44:47], a[116:119], v[180:183], v[44:47]
    v_exp_f32 v160, v160
    v_mfma_f32_16x16x32_bf16 v[12:15], a[120:123], v[176:179], v[12:15]
    buffer_load_dwordx4 v239, s[8:11], s25 offen offset:3072 sc1 lds
    ds_read_b128 a[84:87], v233 offset:3072
    v_mfma_f32_16x16x32_bf16 v[48:51], a[120:123], v[180:183], v[48:51]
    v_exp_f32 v161, v161
    v_permlane32_swap_b32 v241, v243
    v_mfma_f32_16x16x32_bf16 v[16:19], a[124:127], v[176:179], v[16:19]
    ds_read_b128 a[88:91], v233 offset:4096
    v_exp_f32 v168, v168
    v_mfma_f32_16x16x32_bf16 v[52:55], a[124:127], v[180:183], v[52:55]
    s_add_u32 s12, s64, 4768768
    ds_read_b128 a[92:95], v233 offset:5120
    v_exp_f32 v169, v169
    v_mfma_f32_16x16x32_bf16 v[20:23], a[128:131], v[176:179], v[20:23]
    buffer_load_dwordx2 a[232:233], v231, s[52:55], s12 offen sc1
    ds_read_b128 a[96:99], v233 offset:6144
    v_mfma_f32_16x16x32_bf16 v[56:59], a[128:131], v[180:183], v[56:59]
    s_add_u32 m0, s64, 8192
    ds_read_b128 a[100:103], v233 offset:7168
    v_cvt_pk_bf16_f32 v184, v160, v161
    v_mfma_f32_16x16x32_bf16 v[24:27], a[132:135], v[176:179], v[24:27]
    buffer_load_dwordx4 v239, s[8:11], s26 offen offset:0 sc1 lds
    ds_read_b128 a[104:107], v233 offset:8192
    v_mfma_f32_16x16x32_bf16 v[60:63], a[132:135], v[180:183], v[60:63]
    s_add_u32 s8, s8, 73728
    s_addc_u32 s9, s9, 0
    ds_write_b64 v254, v[228:229]
    v_mfma_f32_16x16x32_bf16 v[28:31], a[136:139], v[176:179], v[28:31]
    s_sub_u32 s10, s10, 73728
    v_exp_f32 v162, v162
    v_mfma_f32_16x16x32_bf16 v[64:67], a[136:139], v[180:183], v[64:67]
    s_max_i32 s10, s10, 0
    s_add_u32 m0, s64, 36864
    ds_read_b64 v[244:245], v249
    v_mfma_f32_16x16x32_bf16 v[32:35], a[140:143], v[176:179], v[32:35]
    v_exp_f32 v163, v163
    v_mfma_f32_16x16x32_bf16 v[68:71], a[140:143], v[180:183], v[68:71]
    s_waitcnt lgkmcnt(2)
    v_mfma_f32_32x32x16_bf16 v[144:159], a[72:75], a[0:3], 0
    v_cvt_pk_bf16_f32 v188, v168, v169
    v_exp_f32 v170, v170
    v_exp_f32 v171, v171
    v_fma_f32 v192, v192, v241, v240
    v_mfma_f32_32x32x16_bf16 v[144:159], a[76:79], a[4:7], v[144:159]
    v_cvt_pk_bf16_f32 v185, v162, v163
    v_permlane16_swap_b32 v184, v188
    v_exp_f32 v164, v164
    v_fma_f32 v193, v193, v241, v240
    v_mfma_f32_32x32x16_bf16 v[144:159], a[80:83], a[8:11], v[144:159]
    buffer_load_dwordx4 v239, s[8:11], s18 offen offset:0 sc1 lds
    v_exp_f32 v165, v165
    v_cvt_pk_bf16_f32 v189, v170, v171
    v_exp_f32 v172, v172
    v_mfma_f32_32x32x16_bf16 v[144:159], a[84:87], a[12:15], v[144:159]
    v_exp_f32 v173, v173
    v_cvt_pk_bf16_f32 v186, v164, v165
    v_permlane16_swap_b32 v185, v189
    v_fma_f32 v194, v194, v241, v240
    v_mfma_f32_32x32x16_bf16 v[144:159], a[88:91], a[16:19], v[144:159]
    buffer_load_dwordx4 v239, s[8:11], s19 offen offset:1024 sc1 lds
    v_exp_f32 v166, v166
    v_exp_f32 v167, v167
    v_mfma_f32_32x32x16_bf16 v[144:159], a[92:95], a[20:23], v[144:159]
    v_cvt_pk_bf16_f32 v190, v172, v173
    v_exp_f32 v174, v174
    v_exp_f32 v175, v175
    v_fma_f32 v195, v195, v241, v240
    v_mfma_f32_32x32x16_bf16 v[144:159], a[96:99], a[24:27], v[144:159]
    s_add_u32 s12, s64, 4764672
    v_cvt_pk_bf16_f32 v187, v166, v167
    v_permlane16_swap_b32 v186, v190
    v_cvt_pk_bf16_f32 v191, v174, v175
    v_fma_f32 v196, v196, v241, v240
    v_fma_f32 v197, v197, v241, v240
    v_mfma_f32_32x32x16_bf16 v[144:159], a[100:103], a[28:31], v[144:159]
    buffer_load_dwordx4 a[228:231], v239, s[52:55], s12 offen offset:3072 sc1
    v_permlane16_swap_b32 v187, v191
    v_fma_f32 v198, v198, v241, v240
    v_fma_f32 v199, v199, v241, v240
    v_mfma_f32_32x32x16_bf16 v[144:159], a[104:107], a[32:35], v[144:159]
    buffer_load_dwordx4 v239, s[8:11], s20 offen offset:2048 sc1 lds
    v_fma_f32 v200, v200, v241, v240
    v_fma_f32 v201, v201, v241, v240
    v_fma_f32 v202, v202, v241, v240
    v_fma_f32 v203, v203, v241, v240
    v_mfma_f32_16x16x32_bf16 v[72:75], a[108:111], v[184:187], v[72:75]
    v_fma_f32 v204, v204, v241, v240
    v_fma_f32 v205, v205, v241, v240
    v_mfma_f32_16x16x32_bf16 v[108:111], a[108:111], v[188:191], v[108:111]
    ds_read_b64_tr_b16 a[108:109], v235 offset:0
    v_fma_f32 v206, v206, v241, v240
    v_mfma_f32_16x16x32_bf16 v[76:79], a[112:115], v[184:187], v[76:79]
    ds_read_b64_tr_b16 a[110:111], v237 offset:0
    v_fma_f32 v207, v207, v241, v240
    v_mfma_f32_16x16x32_bf16 v[112:115], a[112:115], v[188:191], v[112:115]
    ds_read_b64_tr_b16 a[112:113], v235 offset:1024
    v_cvt_pk_bf16_f32 v192, v192, v193
    v_mfma_f32_16x16x32_bf16 v[80:83], a[116:119], v[184:187], v[80:83]
    ds_read_b64_tr_b16 a[114:115], v237 offset:1024
    v_cvt_pk_bf16_f32 v193, v194, v195
    v_mfma_f32_16x16x32_bf16 v[116:119], a[116:119], v[188:191], v[116:119]
    ds_read_b64_tr_b16 a[116:117], v235 offset:2048
    v_cvt_pk_bf16_f32 v196, v196, v197
    v_mfma_f32_16x16x32_bf16 v[84:87], a[120:123], v[184:187], v[84:87]
    ds_read_b64_tr_b16 a[118:119], v237 offset:2048
    v_cvt_pk_bf16_f32 v197, v198, v199
    v_mfma_f32_16x16x32_bf16 v[120:123], a[120:123], v[188:191], v[120:123]
    ds_read_b64_tr_b16 a[120:121], v235 offset:3072
    v_cvt_pk_bf16_f32 v194, v200, v201
    v_mfma_f32_16x16x32_bf16 v[88:91], a[124:127], v[184:187], v[88:91]
    buffer_load_dwordx4 v239, s[8:11], s21 offen offset:3072 sc1 lds
    v_mfma_f32_16x16x32_bf16 v[124:127], a[124:127], v[188:191], v[124:127]
    ds_read_b64_tr_b16 a[122:123], v237 offset:3072
    v_cvt_pk_bf16_f32 v195, v202, v203
    v_mfma_f32_16x16x32_bf16 v[92:95], a[128:131], v[184:187], v[92:95]
    ds_read_b64_tr_b16 a[124:125], v235 offset:4096
    v_cvt_pk_bf16_f32 v198, v204, v205
    v_mfma_f32_16x16x32_bf16 v[128:131], a[128:131], v[188:191], v[128:131]
    ds_read_b64_tr_b16 a[126:127], v237 offset:4096
    v_cvt_pk_bf16_f32 v199, v206, v207
    v_mfma_f32_16x16x32_bf16 v[96:99], a[132:135], v[184:187], v[96:99]
    buffer_load_dwordx4 a[224:227], v239, s[52:55], s12 offen offset:2048 sc1
    v_mfma_f32_16x16x32_bf16 v[132:135], a[132:135], v[188:191], v[132:135]
    v_exp_f32 v144, v144
    v_mfma_f32_16x16x32_bf16 v[100:103], a[136:139], v[184:187], v[100:103]
    v_exp_f32 v145, v145
    v_mfma_f32_16x16x32_bf16 v[136:139], a[136:139], v[188:191], v[136:139]
    v_exp_f32 v152, v152
    v_mfma_f32_16x16x32_bf16 v[104:107], a[140:143], v[184:187], v[104:107]
    v_exp_f32 v153, v153
    v_mfma_f32_16x16x32_bf16 v[140:143], a[140:143], v[188:191], v[140:143]
    s_add_u32 m0, s64, 40960
    ds_read_b64_tr_b16 a[128:129], v235 offset:5120
    v_cvt_pk_bf16_f32 v176, v144, v145
    v_mfma_f32_32x32x16_bf16 v[160:175], a[72:75], a[36:39], 0
    buffer_load_dwordx4 v239, s[8:11], s22 offen offset:0 sc1 lds
    ds_read_b64_tr_b16 a[130:131], v237 offset:5120
    v_exp_f32 v146, v146
    v_exp_f32 v147, v147
    v_mfma_f32_32x32x16_bf16 v[160:175], a[76:79], a[40:43], v[160:175]
    ds_read_b64_tr_b16 a[132:133], v235 offset:6144
    v_cvt_pk_bf16_f32 v180, v152, v153
    v_exp_f32 v154, v154
    v_exp_f32 v155, v155
    v_cvt_pk_bf16_f32 v177, v146, v147
    v_mfma_f32_32x32x16_bf16 v[160:175], a[80:83], a[44:47], v[160:175]
    buffer_load_dwordx4 v239, s[8:11], s23 offen offset:1024 sc1 lds
    v_permlane16_swap_b32 v176, v180
    v_exp_f32 v148, v148
    v_exp_f32 v149, v149
    v_mfma_f32_32x32x16_bf16 v[160:175], a[84:87], a[48:51], v[160:175]
    ds_read_b64_tr_b16 a[134:135], v237 offset:6144
    v_cvt_pk_bf16_f32 v181, v154, v155
    v_exp_f32 v156, v156
    v_exp_f32 v157, v157
    v_cvt_pk_bf16_f32 v178, v148, v149
    v_mfma_f32_32x32x16_bf16 v[160:175], a[88:91], a[52:55], v[160:175]
L_padg2:
    s_cbranch_execz L_walked1
    ds_read_b64_tr_b16 a[136:137], v235 offset:7168
    v_permlane16_swap_b32 v177, v181
    v_exp_f32 v150, v150
    v_exp_f32 v151, v151
    v_mfma_f32_32x32x16_bf16 v[160:175], a[92:95], a[56:59], v[160:175]
    buffer_store_dwordx4 v[192:195], v248, s[44:47], s14 offen offset:0 sc1
    ds_read_b64_tr_b16 a[138:139], v237 offset:7168
    ds_read_b64_tr_b16 a[140:141], v235 offset:8192
    v_cvt_pk_bf16_f32 v182, v156, v157
    v_exp_f32 v158, v158
    v_mfma_f32_32x32x16_bf16 v[160:175], a[96:99], a[60:63], v[160:175]
    ds_read_b64_tr_b16 a[142:143], v237 offset:8192
    v_exp_f32 v159, v159
    v_cvt_pk_bf16_f32 v179, v150, v151
    v_permlane16_swap_b32 v178, v182
    v_cvt_pk_bf16_f32 v183, v158, v159
    v_mfma_f32_32x32x16_bf16 v[160:175], a[100:103], a[64:67], v[160:175]
    buffer_load_dwordx4 v239, s[8:11], s24 offen offset:2048 sc1 lds
    v_permlane16_swap_b32 v179, v183
    v_fma_f32 v208, v208, v243, v242
    v_fma_f32 v209, v209, v243, v242
    v_mfma_f32_32x32x16_bf16 v[160:175], a[104:107], a[68:71], v[160:175]
    s_waitcnt vmcnt(25) lgkmcnt(0)
    v_fma_f32 v210, v210, v243, v242
    v_fma_f32 v211, v211, v243, v242
    v_fma_f32 v212, v212, v243, v242
    v_fma_f32 v213, v213, v243, v242
    v_fma_f32 v214, v214, v243, v242
    v_mfma_f32_16x16x32_bf16 v[0:3], a[108:111], v[176:179], v[0:3]
    buffer_store_dwordx4 v[196:199], v248, s[44:47], s14 offen offset:512 sc1
    v_mfma_f32_16x16x32_bf16 v[36:39], a[108:111], v[180:183], v[36:39]
    ds_read_b128 a[72:75], v233 offset:36864
    v_mfma_f32_16x16x32_bf16 v[4:7], a[112:115], v[176:179], v[4:7]
    ds_read_b128 a[76:79], v233 offset:37888
    v_mfma_f32_16x16x32_bf16 v[40:43], a[112:115], v[180:183], v[40:43]
    ds_read_b128 a[80:83], v233 offset:38912
    v_mfma_f32_16x16x32_bf16 v[8:11], a[116:119], v[176:179], v[8:11]
    ds_read_b128 a[84:87], v233 offset:39936
    v_mfma_f32_16x16x32_bf16 v[44:47], a[116:119], v[180:183], v[44:47]
    ds_read_b128 a[88:91], v233 offset:40960
    v_fma_f32 v215, v215, v243, v242
    v_mfma_f32_16x16x32_bf16 v[12:15], a[120:123], v[176:179], v[12:15]
    ds_read_b128 a[92:95], v233 offset:41984
    v_fma_f32 v216, v216, v243, v242
    v_mfma_f32_16x16x32_bf16 v[48:51], a[120:123], v[180:183], v[48:51]
    ds_read_b128 a[96:99], v233 offset:43008
    v_fma_f32 v217, v217, v243, v242
    v_mfma_f32_16x16x32_bf16 v[16:19], a[124:127], v[176:179], v[16:19]
    buffer_load_dwordx4 v239, s[8:11], s25 offen offset:3072 sc1 lds
    v_mfma_f32_16x16x32_bf16 v[52:55], a[124:127], v[180:183], v[52:55]
    ds_read_b128 a[100:103], v233 offset:44032
    v_fma_f32 v218, v218, v243, v242
    v_mfma_f32_16x16x32_bf16 v[20:23], a[128:131], v[176:179], v[20:23]
    s_add_u32 m0, s64, 45056
    v_exp_f32 v160, v160
    v_mfma_f32_16x16x32_bf16 v[56:59], a[128:131], v[180:183], v[56:59]
    buffer_load_dwordx4 v239, s[8:11], s26 offen offset:0 sc1 lds
    ds_read_b128 a[104:107], v233 offset:45056
    v_mfma_f32_16x16x32_bf16 v[24:27], a[132:135], v[176:179], v[24:27]
    s_add_u32 s8, s8, 73728
    s_addc_u32 s9, s9, 0
    v_exp_f32 v161, v161
    v_mfma_f32_16x16x32_bf16 v[60:63], a[132:135], v[180:183], v[60:63]
    s_sub_u32 s10, s10, 73728
    v_exp_f32 v168, v168
    v_mfma_f32_16x16x32_bf16 v[28:31], a[136:139], v[176:179], v[28:31]
    s_max_i32 s10, s10, 0
    v_exp_f32 v169, v169
    v_mfma_f32_16x16x32_bf16 v[64:67], a[136:139], v[180:183], v[64:67]
    s_add_u32 m0, s64, 73728
    v_cvt_pk_bf16_f32 v184, v160, v161
    v_exp_f32 v162, v162
    v_mfma_f32_16x16x32_bf16 v[32:35], a[140:143], v[176:179], v[32:35]
    v_exp_f32 v163, v163
    v_mfma_f32_16x16x32_bf16 v[68:71], a[140:143], v[180:183], v[68:71]
    s_waitcnt lgkmcnt(0)
    v_fma_f32 v219, v219, v243, v242
    v_mfma_f32_32x32x16_bf16 v[144:159], a[72:75], a[0:3], 0
    v_cvt_pk_bf16_f32 v188, v168, v169
    v_exp_f32 v170, v170
    v_exp_f32 v171, v171
    v_cvt_pk_bf16_f32 v185, v162, v163
    v_mfma_f32_32x32x16_bf16 v[144:159], a[76:79], a[4:7], v[144:159]
    v_permlane16_swap_b32 v184, v188
    v_exp_f32 v164, v164
    v_exp_f32 v165, v165
    v_mfma_f32_32x32x16_bf16 v[144:159], a[80:83], a[8:11], v[144:159]
    buffer_load_dwordx4 v239, s[8:11], s18 offen offset:0 sc1 lds
    v_cvt_pk_bf16_f32 v189, v170, v171
    v_exp_f32 v172, v172
    v_fma_f32 v220, v220, v243, v242
    v_mfma_f32_32x32x16_bf16 v[144:159], a[84:87], a[12:15], v[144:159]
    v_exp_f32 v173, v173
    v_cvt_pk_bf16_f32 v186, v164, v165
    v_permlane16_swap_b32 v185, v189
    v_fma_f32 v221, v221, v243, v242
    v_mfma_f32_32x32x16_bf16 v[144:159], a[88:91], a[16:19], v[144:159]
    v_exp_f32 v166, v166
    v_exp_f32 v167, v167
    v_cvt_pk_bf16_f32 v190, v172, v173
    v_fma_f32 v222, v222, v243, v242
    v_mfma_f32_32x32x16_bf16 v[144:159], a[92:95], a[20:23], v[144:159]
    buffer_load_dwordx4 v239, s[8:11], s19 offen offset:1024 sc1 lds
    v_exp_f32 v174, v174
    v_exp_f32 v175, v175
    v_mfma_f32_32x32x16_bf16 v[144:159], a[96:99], a[24:27], v[144:159]
    v_cvt_pk_bf16_f32 v187, v166, v167
    v_permlane16_swap_b32 v186, v190
    v_cvt_pk_bf16_f32 v191, v174, v175
    v_fma_f32 v223, v223, v243, v242
    v_cvt_pk_bf16_f32 v200, v208, v209
    v_mfma_f32_32x32x16_bf16 v[144:159], a[100:103], a[28:31], v[144:159]
    buffer_load_dwordx4 v239, s[8:11], s20 offen offset:2048 sc1 lds
    v_permlane16_swap_b32 v187, v191
    v_cvt_pk_bf16_f32 v201, v210, v211
    v_cvt_pk_bf16_f32 v204, v212, v213
    v_mfma_f32_32x32x16_bf16 v[144:159], a[104:107], a[32:35], v[144:159]
    buffer_load_dwordx4 v239, s[8:11], s21 offen offset:3072 sc1 lds
    v_cvt_pk_bf16_f32 v205, v214, v215
    v_cvt_pk_bf16_f32 v202, v216, v217
    v_cvt_pk_bf16_f32 v203, v218, v219
    v_cvt_pk_bf16_f32 v206, v220, v221
    v_cvt_pk_bf16_f32 v207, v222, v223
    v_mfma_f32_16x16x32_bf16 v[72:75], a[108:111], v[184:187], v[72:75]
    v_fma_f32 v224, v224, v245, v244
    v_fma_f32 v225, v225, v245, v244
    v_fma_f32 v226, v226, v245, v244
    v_mfma_f32_16x16x32_bf16 v[108:111], a[108:111], v[188:191], v[108:111]
    ds_read_b64_tr_b16 a[108:109], v235 offset:36864
    v_fma_f32 v227, v227, v245, v244
    v_mfma_f32_16x16x32_bf16 v[76:79], a[112:115], v[184:187], v[76:79]
    ds_read_b64_tr_b16 a[110:111], v237 offset:36864
    v_cvt_pk_bf16_f32 v208, v224, v225
    v_mfma_f32_16x16x32_bf16 v[112:115], a[112:115], v[188:191], v[112:115]
    s_add_u32 m0, s64, 77824
    ds_read_b64_tr_b16 a[112:113], v235 offset:37888
    v_cvt_pk_bf16_f32 v209, v226, v227
    v_mfma_f32_16x16x32_bf16 v[80:83], a[116:119], v[184:187], v[80:83]
    buffer_load_dwordx4 v239, s[8:11], s22 offen offset:0 sc1 lds
    v_mfma_f32_16x16x32_bf16 v[116:119], a[116:119], v[188:191], v[116:119]
    v_exp_f32 v144, v144
    v_mfma_f32_16x16x32_bf16 v[84:87], a[120:123], v[184:187], v[84:87]
    v_exp_f32 v145, v145
    v_mfma_f32_16x16x32_bf16 v[120:123], a[120:123], v[188:191], v[120:123]
    v_exp_f32 v152, v152
    v_mfma_f32_16x16x32_bf16 v[88:91], a[124:127], v[184:187], v[88:91]
    v_exp_f32 v153, v153
    v_mfma_f32_16x16x32_bf16 v[124:127], a[124:127], v[188:191], v[124:127]
    ds_read_b64_tr_b16 a[114:115], v237 offset:37888
    v_cvt_pk_bf16_f32 v176, v144, v145
    v_mfma_f32_16x16x32_bf16 v[92:95], a[128:131], v[184:187], v[92:95]
    v_exp_f32 v146, v146
    v_mfma_f32_16x16x32_bf16 v[128:131], a[128:131], v[188:191], v[128:131]
    v_exp_f32 v147, v147
    v_mfma_f32_16x16x32_bf16 v[96:99], a[132:135], v[184:187], v[96:99]
    buffer_store_dwordx4 v[200:203], v248, s[44:47], s15 offen offset:0 sc1
    v_mfma_f32_16x16x32_bf16 v[132:135], a[132:135], v[188:191], v[132:135]
    v_cvt_pk_bf16_f32 v180, v152, v153
    v_exp_f32 v154, v154
    v_mfma_f32_16x16x32_bf16 v[100:103], a[136:139], v[184:187], v[100:103]
    v_exp_f32 v155, v155
    v_mfma_f32_16x16x32_bf16 v[136:139], a[136:139], v[188:191], v[136:139]
    ds_read_b64_tr_b16 a[116:117], v235 offset:38912
    v_cvt_pk_bf16_f32 v177, v146, v147
    v_mfma_f32_16x16x32_bf16 v[104:107], a[140:143], v[184:187], v[104:107]
    v_permlane16_swap_b32 v176, v180
    v_mfma_f32_16x16x32_bf16 v[140:143], a[140:143], v[188:191], v[140:143]
    v_exp_f32 v148, v148
    v_mfma_f32_32x32x16_bf16 v[160:175], a[72:75], a[36:39], 0
    buffer_load_dwordx4 v239, s[8:11], s23 offen offset:1024 sc1 lds
    ds_read_b64_tr_b16 a[118:119], v237 offset:38912
    v_exp_f32 v149, v149
    v_cvt_pk_bf16_f32 v181, v154, v155
    v_mfma_f32_32x32x16_bf16 v[160:175], a[76:79], a[40:43], v[160:175]
    ds_read_b64_tr_b16 a[120:121], v235 offset:39936
    ds_read_b64_tr_b16 a[122:123], v237 offset:39936
    v_exp_f32 v156, v156
    v_exp_f32 v157, v157
    v_mfma_f32_32x32x16_bf16 v[160:175], a[80:83], a[44:47], v[160:175]
    buffer_load_dwordx4 v239, s[8:11], s24 offen offset:2048 sc1 lds
    ds_read_b64_tr_b16 a[124:125], v235 offset:40960
    v_cvt_pk_bf16_f32 v178, v148, v149
    v_permlane16_swap_b32 v177, v181
    v_mfma_f32_32x32x16_bf16 v[160:175], a[84:87], a[48:51], v[160:175]
    ds_read_b64_tr_b16 a[126:127], v237 offset:40960
    ds_read_b64_tr_b16 a[128:129], v235 offset:41984
    v_exp_f32 v150, v150
    v_exp_f32 v151, v151
    v_mfma_f32_32x32x16_bf16 v[160:175], a[88:91], a[52:55], v[160:175]
    ds_read_b64_tr_b16 a[130:131], v237 offset:41984
    ds_read_b64_tr_b16 a[132:133], v235 offset:43008
    ds_read_b64_tr_b16 a[134:135], v237 offset:43008
    v_cvt_pk_bf16_f32 v182, v156, v157
    v_exp_f32 v158, v158
    v_mfma_f32_32x32x16_bf16 v[160:175], a[92:95], a[56:59], v[160:175]
    buffer_store_dwordx4 v[204:207], v248, s[44:47], s15 offen offset:512 sc1
    ds_read_b64_tr_b16 a[136:137], v235 offset:44032
    v_exp_f32 v159, v159
    v_cvt_pk_bf16_f32 v179, v150, v151
    v_mfma_f32_32x32x16_bf16 v[160:175], a[96:99], a[60:63], v[160:175]
    ds_read_b64_tr_b16 a[138:139], v237 offset:44032
    ds_read_b64_tr_b16 a[140:141], v235 offset:45056
    ds_read_b64_tr_b16 a[142:143], v237 offset:45056
    v_permlane16_swap_b32 v178, v182
    v_cvt_pk_bf16_f32 v183, v158, v159
    v_mfma_f32_32x32x16_bf16 v[160:175], a[100:103], a[64:67], v[160:175]
    buffer_load_dwordx4 v239, s[8:11], s25 offen offset:3072 sc1 lds
    v_permlane16_swap_b32 v179, v183
    v_mfma_f32_32x32x16_bf16 v[160:175], a[104:107], a[68:71], v[160:175]
    s_waitcnt vmcnt(23) lgkmcnt(0)
    v_mfma_f32_16x16x32_bf16 v[0:3], a[108:111], v[176:179], v[0:3]
    ds_read_b128 a[72:75], v232 offset:0
    v_mfma_f32_16x16x32_bf16 v[36:39], a[108:111], v[180:183], v[36:39]
    ds_read_b128 a[76:79], v232 offset:1024
    v_mfma_f32_16x16x32_bf16 v[4:7], a[112:115], v[176:179], v[4:7]
    s_add_u32 m0, s64, 81920
    ds_read_b128 a[80:83], v232 offset:2048
    v_mfma_f32_16x16x32_bf16 v[40:43], a[112:115], v[180:183], v[40:43]
    buffer_load_dwordx4 v239, s[8:11], s26 offen offset:0 sc1 lds
    v_mfma_f32_16x16x32_bf16 v[8:11], a[116:119], v[176:179], v[8:11]
    ds_read_b128 a[84:87], v232 offset:3072
    v_mfma_f32_16x16x32_bf16 v[44:47], a[116:119], v[180:183], v[44:47]
    ds_read_b128 a[88:91], v232 offset:4096
    v_mfma_f32_16x16x32_bf16 v[12:15], a[120:123], v[176:179], v[12:15]
    ds_read_b128 a[92:95], v232 offset:5120
    v_mfma_f32_16x16x32_bf16 v[48:51], a[120:123], v[180:183], v[48:51]
    ds_read_b128 a[96:99], v232 offset:6144
    v_mfma_f32_16x16x32_bf16 v[16:19], a[124:127], v[176:179], v[16:19]
    buffer_store_dwordx2 v[208:209], v231, s[44:47], s72 offen sc1
    v_mfma_f32_16x16x32_bf16 v[52:55], a[124:127], v[180:183], v[52:55]
    v_exp_f32 v160, v160
    v_mfma_f32_16x16x32_bf16 v[20:23], a[128:131], v[176:179], v[20:23]
    v_exp_f32 v161, v161
    v_mfma_f32_16x16x32_bf16 v[56:59], a[128:131], v[180:183], v[56:59]
    ds_read_b128 a[100:103], v232 offset:7168
    v_mfma_f32_16x16x32_bf16 v[24:27], a[132:135], v[176:179], v[24:27]
    s_add_u32 s8, s8, 73728
    s_addc_u32 s9, s9, 0
    ds_read_b128 a[104:107], v232 offset:8192
    v_mfma_f32_16x16x32_bf16 v[60:63], a[132:135], v[180:183], v[60:63]
    s_sub_u32 s10, s10, 73728
    v_exp_f32 v168, v168
    v_mfma_f32_16x16x32_bf16 v[28:31], a[136:139], v[176:179], v[28:31]
    s_max_i32 s10, s10, 0
    v_exp_f32 v169, v169
    v_mfma_f32_16x16x32_bf16 v[64:67], a[136:139], v[180:183], v[64:67]
    s_add_u32 m0, s64, 110592
    v_cvt_pk_bf16_f32 v184, v160, v161
    v_exp_f32 v162, v162
    v_mfma_f32_16x16x32_bf16 v[32:35], a[140:143], v[176:179], v[32:35]
    v_exp_f32 v163, v163
    v_mfma_f32_16x16x32_bf16 v[68:71], a[140:143], v[180:183], v[68:71]
    s_waitcnt lgkmcnt(0)
    v_mfma_f32_32x32x16_bf16 v[144:159], a[72:75], a[0:3], 0
    v_cvt_pk_bf16_f32 v188, v168, v169
    v_exp_f32 v170, v170
    v_exp_f32 v171, v171
    v_mov_b32 v228, s100
    v_mfma_f32_32x32x16_bf16 v[144:159], a[76:79], a[4:7], v[144:159]
    v_cvt_pk_bf16_f32 v185, v162, v163
    v_permlane16_swap_b32 v184, v188
    v_exp_f32 v164, v164
    v_mov_b32 v229, s101
    v_mfma_f32_32x32x16_bf16 v[144:159], a[80:83], a[8:11], v[144:159]
    buffer_load_dwordx4 v239, s[8:11], s18 offen offset:0 sc1 lds
    v_exp_f32 v165, v165
    v_cvt_pk_bf16_f32 v189, v170, v171
    v_bfe_u32 v247, v231, 3, 4
    v_mfma_f32_32x32x16_bf16 v[144:159], a[84:87], a[12:15], v[144:159]
    v_exp_f32 v172, v172
    v_exp_f32 v173, v173
    v_cvt_pk_bf16_f32 v186, v164, v165
    v_lshrrev_b32 v249, 7, v231
    v_mfma_f32_32x32x16_bf16 v[144:159], a[88:91], a[16:19], v[144:159]
    buffer_load_dwordx4 v239, s[8:11], s19 offen offset:1024 sc1 lds
    v_permlane16_swap_b32 v185, v189
    v_exp_f32 v166, v166
    v_mfma_f32_32x32x16_bf16 v[144:159], a[92:95], a[20:23], v[144:159]
    s_lshr_b32 s68, s3, 1
    v_exp_f32 v167, v167
    v_cvt_pk_bf16_f32 v190, v172, v173
    v_exp_f32 v174, v174
    v_mfma_f32_32x32x16_bf16 v[144:159], a[96:99], a[24:27], v[144:159]
    s_mul_i32 s69, s73, 4608
    v_exp_f32 v175, v175
    v_cvt_pk_bf16_f32 v187, v166, v167
    v_permlane16_swap_b32 v186, v190
    v_cvt_pk_bf16_f32 v191, v174, v175
    v_mfma_f32_32x32x16_bf16 v[144:159], a[100:103], a[28:31], v[144:159]
    buffer_load_dwordx4 v239, s[8:11], s20 offen offset:2048 sc1 lds
    v_permlane16_swap_b32 v187, v191
    v_add_u32 v217, s64, v239
    v_mfma_f32_32x32x16_bf16 v[144:159], a[104:107], a[32:35], v[144:159]
    buffer_load_dwordx4 v239, s[8:11], s21 offen offset:3072 sc1 lds
    s_add_u32 m0, s64, 114688
    s_add_u32 s70, s64, 40960
    v_add_u32 v218, s70, v231
    s_xor_b32 s70, s3, 1
    v_mfma_f32_16x16x32_bf16 v[72:75], a[108:111], v[184:187], v[72:75]
    s_mul_i32 s70, s70, 9216
    v_add_u32 v219, s70, v239
    v_mfma_f32_16x16x32_bf16 v[108:111], a[108:111], v[188:191], v[108:111]
    s_xor_b32 s70, s3, 2
    ds_read_b64_tr_b16 a[108:109], v234 offset:0
    v_mfma_f32_16x16x32_bf16 v[76:79], a[112:115], v[184:187], v[76:79]
    s_mul_i32 s70, s70, 9216
    v_add_u32 v212, s70, v239
    v_mfma_f32_16x16x32_bf16 v[112:115], a[112:115], v[188:191], v[112:115]
    s_xor_b32 s70, s3, 3
    ds_read_b64_tr_b16 a[110:111], v236 offset:0
    v_mfma_f32_16x16x32_bf16 v[80:83], a[116:119], v[184:187], v[80:83]
    s_mul_i32 s70, s70, 9216
    v_add_u32 v213, s70, v239
    v_mfma_f32_16x16x32_bf16 v[116:119], a[116:119], v[188:191], v[116:119]
    s_lshl_b32 s70, s73, 9
    ds_read_b64_tr_b16 a[112:113], v234 offset:1024
    ds_read_b64_tr_b16 a[114:115], v236 offset:1024
    v_mfma_f32_16x16x32_bf16 v[84:87], a[120:123], v[184:187], v[84:87]
    s_add_u32 s70, s70, 40960
    ds_read_b64_tr_b16 a[116:117], v234 offset:2048
    v_add_u32 v220, s70, v231
    v_mfma_f32_16x16x32_bf16 v[120:123], a[120:123], v[188:191], v[120:123]
    s_mul_i32 s70, s68, 6144
    ds_read_b64_tr_b16 a[118:119], v236 offset:2048
    ds_read_b64_tr_b16 a[120:121], v234 offset:3072
    v_mfma_f32_16x16x32_bf16 v[88:91], a[124:127], v[184:187], v[88:91]
    s_add_u32 s70, s70, 147456
    ds_read_b64_tr_b16 a[122:123], v236 offset:3072
    v_add_u32 v221, s70, v239
    v_mfma_f32_16x16x32_bf16 v[124:127], a[124:127], v[188:191], v[124:127]
    s_nop 0
    ds_read_b64_tr_b16 a[124:125], v234 offset:4096
    ds_read_b64_tr_b16 a[126:127], v236 offset:4096
    v_mfma_f32_16x16x32_bf16 v[92:95], a[128:131], v[184:187], v[92:95]
    buffer_load_dwordx4 v239, s[8:11], s22 offen offset:0 sc1 lds
    v_mfma_f32_16x16x32_bf16 v[128:131], a[128:131], v[188:191], v[128:131]
    ds_read_b64_tr_b16 a[128:129], v234 offset:5120
    v_add_u32 v223, 160776, v239
    v_mfma_f32_16x16x32_bf16 v[96:99], a[132:135], v[184:187], v[96:99]
    buffer_load_dwordx4 v239, s[8:11], s23 offen offset:1024 sc1 lds
    v_mfma_f32_16x16x32_bf16 v[132:135], a[132:135], v[188:191], v[132:135]
    v_exp_f32 v144, v144
    v_mfma_f32_16x16x32_bf16 v[100:103], a[136:139], v[184:187], v[100:103]
    v_exp_f32 v145, v145
    v_mfma_f32_16x16x32_bf16 v[136:139], a[136:139], v[188:191], v[136:139]
    v_exp_f32 v152, v152
    v_mfma_f32_16x16x32_bf16 v[104:107], a[140:143], v[184:187], v[104:107]
    v_exp_f32 v153, v153
    v_mfma_f32_16x16x32_bf16 v[140:143], a[140:143], v[188:191], v[140:143]
    ds_read_b64_tr_b16 a[130:131], v236 offset:5120
    v_cvt_pk_bf16_f32 v176, v144, v145
    v_mfma_f32_32x32x16_bf16 v[160:175], a[72:75], a[36:39], 0
    ds_read_b64_tr_b16 a[132:133], v234 offset:6144
    v_exp_f32 v146, v146
    v_exp_f32 v147, v147
    v_cvt_pk_bf16_f32 v180, v152, v153
    v_mfma_f32_32x32x16_bf16 v[160:175], a[76:79], a[40:43], v[160:175]
    buffer_load_dwordx4 v239, s[8:11], s24 offen offset:2048 sc1 lds
    v_exp_f32 v154, v154
    v_exp_f32 v155, v155
    v_mfma_f32_32x32x16_bf16 v[160:175], a[80:83], a[44:47], v[160:175]
    s_lshl_b32 s71, s68, 11
    v_cvt_pk_bf16_f32 v177, v146, v147
    v_permlane16_swap_b32 v176, v180
    v_exp_f32 v148, v148
    v_exp_f32 v149, v149
    v_mfma_f32_32x32x16_bf16 v[160:175], a[84:87], a[48:51], v[160:175]
    s_add_u32 s71, s71, s69
    ds_read_b64_tr_b16 a[134:135], v236 offset:6144
    ds_read_b64_tr_b16 a[136:137], v234 offset:7168
    v_cvt_pk_bf16_f32 v181, v154, v155
    v_exp_f32 v156, v156
    v_exp_f32 v157, v157
    v_mfma_f32_32x32x16_bf16 v[160:175], a[88:91], a[52:55], v[160:175]
    buffer_load_dwordx4 v239, s[8:11], s25 offen offset:3072 sc1 lds
    v_cvt_pk_bf16_f32 v178, v148, v149
    v_permlane16_swap_b32 v177, v181
    v_exp_f32 v150, v150
    v_mfma_f32_32x32x16_bf16 v[160:175], a[92:95], a[56:59], v[160:175]
    s_add_u32 s70, s71, 82944
    ds_read_b64_tr_b16 a[138:139], v236 offset:7168
    ds_read_b64_tr_b16 a[140:141], v234 offset:8192
    v_exp_f32 v151, v151
    v_cvt_pk_bf16_f32 v182, v156, v157
    v_exp_f32 v158, v158
    v_mfma_f32_32x32x16_bf16 v[160:175], a[96:99], a[60:63], v[160:175]
    s_add_u32 m0, s64, 118784
    ds_read_b64_tr_b16 a[142:143], v236 offset:8192
    v_exp_f32 v159, v159
    v_cvt_pk_bf16_f32 v179, v150, v151
    v_permlane16_swap_b32 v178, v182
    v_cvt_pk_bf16_f32 v183, v158, v159
    v_mfma_f32_32x32x16_bf16 v[160:175], a[100:103], a[64:67], v[160:175]
    buffer_load_dwordx4 v239, s[8:11], s26 offen offset:0 sc1 lds
    v_permlane16_swap_b32 v179, v183
    v_add_u32 v222, s70, v239
    v_mfma_f32_32x32x16_bf16 v[160:175], a[104:107], a[68:71], v[160:175]
    s_waitcnt vmcnt(21) lgkmcnt(0)
    s_add_u32 s70, s69, 77824
    v_add_u32 v251, s70, v231
    s_cmp_eq_u32 s68, 0
    s_cselect_b32 s70, 152576, s70
    v_add_u32 v227, s70, v231
    v_mfma_f32_16x16x32_bf16 v[0:3], a[108:111], v[176:179], v[0:3]
    ds_read_b128 a[72:75], v232 offset:36864
    v_mfma_f32_16x16x32_bf16 v[36:39], a[108:111], v[180:183], v[36:39]
    ds_read_b128 a[76:79], v232 offset:37888
    v_mfma_f32_16x16x32_bf16 v[4:7], a[112:115], v[176:179], v[4:7]
    ds_read_b128 a[80:83], v232 offset:38912
    v_mfma_f32_16x16x32_bf16 v[40:43], a[112:115], v[180:183], v[40:43]
    ds_read_b128 a[84:87], v232 offset:39936
    v_mfma_f32_16x16x32_bf16 v[8:11], a[116:119], v[176:179], v[8:11]
    ds_read_b128 a[88:91], v232 offset:40960
    v_mfma_f32_16x16x32_bf16 v[44:47], a[116:119], v[180:183], v[44:47]
    ds_read_b128 a[92:95], v232 offset:41984
    v_mfma_f32_16x16x32_bf16 v[12:15], a[120:123], v[176:179], v[12:15]
    ds_read_b128 a[96:99], v232 offset:43008
    v_mfma_f32_16x16x32_bf16 v[48:51], a[120:123], v[180:183], v[48:51]
    ds_read_b128 a[100:103], v232 offset:44032
    v_mfma_f32_16x16x32_bf16 v[16:19], a[124:127], v[176:179], v[16:19]
    v_exp_f32 v160, v160
    v_mfma_f32_16x16x32_bf16 v[52:55], a[124:127], v[180:183], v[52:55]
    v_exp_f32 v161, v161
    v_mfma_f32_16x16x32_bf16 v[20:23], a[128:131], v[176:179], v[20:23]
    v_exp_f32 v168, v168
    v_mfma_f32_16x16x32_bf16 v[56:59], a[128:131], v[180:183], v[56:59]
    v_exp_f32 v169, v169
    v_mfma_f32_16x16x32_bf16 v[24:27], a[132:135], v[176:179], v[24:27]
    ds_read_b128 a[104:107], v232 offset:45056
    v_cvt_pk_bf16_f32 v184, v160, v161
    v_mfma_f32_16x16x32_bf16 v[60:63], a[132:135], v[180:183], v[60:63]
    s_add_u32 s70, s69, 73728
    v_add_u32 v250, s70, v239
    v_mfma_f32_16x16x32_bf16 v[28:31], a[136:139], v[176:179], v[28:31]
    s_sub_u32 s70, 78336, s69
    v_exp_f32 v162, v162
    v_mfma_f32_16x16x32_bf16 v[64:67], a[136:139], v[180:183], v[64:67]
    s_waitcnt vmcnt(9)
    v_exp_f32 v163, v163
    v_mfma_f32_16x16x32_bf16 v[32:35], a[140:143], v[176:179], v[32:35]
    buffer_store_dwordx2 v[228:229], v238, s[52:55], s78 offen sc1
    v_mfma_f32_16x16x32_bf16 v[68:71], a[140:143], v[180:183], v[68:71]
    s_waitcnt lgkmcnt(0)
    v_add_u32 v252, s70, v239
    v_mfma_f32_32x32x16_bf16 v[144:159], a[72:75], a[0:3], 0
    s_add_u32 s70, s70, 4096
    v_cvt_pk_bf16_f32 v188, v168, v169
    v_exp_f32 v170, v170
    v_exp_f32 v171, v171
    v_add_u32 v253, s70, v231
    v_mfma_f32_32x32x16_bf16 v[144:159], a[76:79], a[4:7], v[144:159]
    s_lshl_b32 s70, s3, 10
    v_cvt_pk_bf16_f32 v185, v162, v163
    v_permlane16_swap_b32 v184, v188
    v_exp_f32 v164, v164
    v_mfma_f32_32x32x16_bf16 v[144:159], a[80:83], a[8:11], v[144:159]
    buffer_load_dwordx4 a[220:223], v239, s[52:55], s12 offen offset:1024 sc1
    v_exp_f32 v165, v165
    v_cvt_pk_bf16_f32 v189, v170, v171
    v_exp_f32 v172, v172
    v_mfma_f32_32x32x16_bf16 v[144:159], a[84:87], a[12:15], v[144:159]
    s_add_u32 s70, s70, 73728
    v_exp_f32 v173, v173
    v_cvt_pk_bf16_f32 v186, v164, v165
    v_permlane16_swap_b32 v185, v189
    v_add_u32 v226, s70, v239
    v_mfma_f32_32x32x16_bf16 v[144:159], a[88:91], a[16:19], v[144:159]
    buffer_load_dwordx4 a[216:219], v239, s[52:55], s12 offen offset:0 sc1
    v_exp_f32 v166, v166
    v_exp_f32 v167, v167
    v_mfma_f32_32x32x16_bf16 v[144:159], a[92:95], a[20:23], v[144:159]
    v_cvt_pk_bf16_f32 v190, v172, v173
    v_exp_f32 v174, v174
    v_exp_f32 v175, v175
    v_mul_u32_u24 v240, 288, v247
    v_mfma_f32_32x32x16_bf16 v[144:159], a[96:99], a[24:27], v[144:159]
    s_mov_b32 s12, 4801024
    v_cvt_pk_bf16_f32 v187, v166, v167
    v_permlane16_swap_b32 v186, v190
    v_cvt_pk_bf16_f32 v191, v174, v175
    s_lshl_b32 s70, s3, 6
    v_lshl_add_u32 v224, v249, 4, v240
    v_mfma_f32_32x32x16_bf16 v[144:159], a[100:103], a[28:31], v[144:159]
    buffer_load_dwordx2 a[250:251], v231, s[52:55], s12 offen sc1
    v_permlane16_swap_b32 v187, v191
    v_lshl_add_u32 v225, v249, 3, v240
    v_add_u32 v224, s70, v224
    v_mfma_f32_32x32x16_bf16 v[144:159], a[104:107], a[32:35], v[144:159]
    s_mov_b32 s12, 4796928
    buffer_load_dwordx4 a[246:249], v239, s[52:55], s12 offen offset:3072 sc1
    s_add_u32 s70, s69, 256
    v_add_u32 v225, s70, v225
    s_mul_i32 s70, s67, 9216
    v_mfma_f32_16x16x32_bf16 v[72:75], a[108:111], v[184:187], v[72:75]
    s_add_u32 s56, s71, s70
    s_add_u32 s70, s70, s69
    v_mfma_f32_16x16x32_bf16 v[108:111], a[108:111], v[188:191], v[108:111]
    s_add_u32 s70, s70, 4096
    ds_read_b64_tr_b16 a[108:109], v234 offset:36864
    ds_read_b64_tr_b16 a[110:111], v236 offset:36864
    v_mfma_f32_16x16x32_bf16 v[76:79], a[112:115], v[184:187], v[76:79]
    s_cmp_eq_u32 s68, 0
    s_cselect_b32 s57, 0x7fff0000, s70
    v_add_u32 v240, -1, v247
    v_mfma_f32_16x16x32_bf16 v[112:115], a[112:115], v[188:191], v[112:115]
    ds_read_b64_tr_b16 a[112:113], v234 offset:37888
    v_add_u32 v241, 1, v247
    v_mfma_f32_16x16x32_bf16 v[80:83], a[116:119], v[184:187], v[80:83]
    buffer_load_dwordx4 a[242:245], v239, s[52:55], s12 offen offset:2048 sc1
    v_mfma_f32_16x16x32_bf16 v[116:119], a[116:119], v[188:191], v[116:119]
    v_exp_f32 v144, v144
    v_mfma_f32_16x16x32_bf16 v[84:87], a[120:123], v[184:187], v[84:87]
    v_exp_f32 v145, v145
    v_mfma_f32_16x16x32_bf16 v[120:123], a[120:123], v[188:191], v[120:123]
    v_exp_f32 v152, v152
    v_mfma_f32_16x16x32_bf16 v[88:91], a[124:127], v[184:187], v[88:91]
    v_exp_f32 v153, v153
    v_mfma_f32_16x16x32_bf16 v[124:127], a[124:127], v[188:191], v[124:127]
    ds_read_b64_tr_b16 a[114:115], v236 offset:37888
    v_cvt_pk_bf16_f32 v176, v144, v145
    v_mfma_f32_16x16x32_bf16 v[92:95], a[128:131], v[184:187], v[92:95]
    v_exp_f32 v146, v146
    v_mfma_f32_16x16x32_bf16 v[128:131], a[128:131], v[188:191], v[128:131]
    v_exp_f32 v147, v147
    v_mfma_f32_16x16x32_bf16 v[96:99], a[132:135], v[184:187], v[96:99]
    buffer_load_dwordx4 a[238:241], v239, s[52:55], s12 offen offset:1024 sc1
    v_mfma_f32_16x16x32_bf16 v[132:135], a[132:135], v[188:191], v[132:135]
    v_cvt_pk_bf16_f32 v180, v152, v153
    v_exp_f32 v154, v154
    v_mfma_f32_16x16x32_bf16 v[100:103], a[136:139], v[184:187], v[100:103]
    v_exp_f32 v155, v155
    v_mfma_f32_16x16x32_bf16 v[136:139], a[136:139], v[188:191], v[136:139]
    ds_read_b64_tr_b16 a[116:117], v234 offset:38912
    v_cvt_pk_bf16_f32 v177, v146, v147
    v_mfma_f32_16x16x32_bf16 v[104:107], a[140:143], v[184:187], v[104:107]
    v_permlane16_swap_b32 v176, v180
    v_mfma_f32_16x16x32_bf16 v[140:143], a[140:143], v[188:191], v[140:143]
    v_exp_f32 v148, v148
    v_mfma_f32_32x32x16_bf16 v[160:175], a[72:75], a[36:39], 0
    buffer_load_dwordx4 a[234:237], v239, s[52:55], s12 offen offset:0 sc1
    ds_read_b64_tr_b16 a[118:119], v236 offset:38912
    v_exp_f32 v149, v149
    v_cvt_pk_bf16_f32 v181, v154, v155
    v_mfma_f32_32x32x16_bf16 v[160:175], a[76:79], a[40:43], v[160:175]
    s_mov_b32 s12, 4759552
    ds_read_b64_tr_b16 a[120:121], v234 offset:39936
    ds_read_b64_tr_b16 a[122:123], v236 offset:39936
    v_exp_f32 v156, v156
    v_exp_f32 v157, v157
    v_mfma_f32_32x32x16_bf16 v[160:175], a[80:83], a[44:47], v[160:175]
    buffer_load_dwordx2 a[196:197], v231, s[52:55], s12 offen sc1
    ds_read_b64_tr_b16 a[124:125], v234 offset:40960
    v_cvt_pk_bf16_f32 v178, v148, v149
    v_permlane16_swap_b32 v177, v181
    v_mfma_f32_32x32x16_bf16 v[160:175], a[84:87], a[48:51], v[160:175]
    ds_read_b64_tr_b16 a[126:127], v236 offset:40960
    ds_read_b64_tr_b16 a[128:129], v234 offset:41984
    v_exp_f32 v150, v150
    v_exp_f32 v151, v151
    v_mfma_f32_32x32x16_bf16 v[160:175], a[88:91], a[52:55], v[160:175]
    s_mov_b32 s12, 4755456
    ds_read_b64_tr_b16 a[130:131], v236 offset:41984
    ds_read_b64_tr_b16 a[132:133], v234 offset:43008
    ds_read_b64_tr_b16 a[134:135], v236 offset:43008
    v_cvt_pk_bf16_f32 v182, v156, v157
    v_exp_f32 v158, v158
    v_mfma_f32_32x32x16_bf16 v[160:175], a[92:95], a[56:59], v[160:175]
    buffer_load_dwordx4 a[192:195], v239, s[52:55], s12 offen offset:3072 sc1
    ds_read_b64_tr_b16 a[136:137], v234 offset:44032
    v_exp_f32 v159, v159
    v_cvt_pk_bf16_f32 v179, v150, v151
    v_mfma_f32_32x32x16_bf16 v[160:175], a[96:99], a[60:63], v[160:175]
    s_movk_i32 s68, 4352
    ds_read_b64_tr_b16 a[138:139], v236 offset:44032
    ds_read_b64_tr_b16 a[140:141], v234 offset:45056
    ds_read_b64_tr_b16 a[142:143], v236 offset:45056
    v_permlane16_swap_b32 v178, v182
    v_cvt_pk_bf16_f32 v183, v158, v159
    v_mfma_f32_32x32x16_bf16 v[160:175], a[100:103], a[64:67], v[160:175]
    buffer_load_dwordx4 a[188:191], v239, s[52:55], s12 offen offset:2048 sc1
    v_permlane16_swap_b32 v179, v183
    v_ashrrev_i32 v240, 4, v240
    v_lshrrev_b32 v241, 4, v241
    v_mfma_f32_32x32x16_bf16 v[160:175], a[104:107], a[68:71], v[160:175]
    s_waitcnt vmcnt(11) lgkmcnt(0)
    s_movk_i32 s69, 4480
    v_mad_i32_i24 v214, v240, s68, v239
    v_mad_i32_i24 v215, v241, s68, v239
    s_sub_u32 s70, s56, 16
    v_mad_i32_i24 v210, v240, s69, v231
    v_mad_i32_i24 v211, v241, s69, v231
    v_mfma_f32_16x16x32_bf16 v[0:3], a[108:111], v[176:179], v[0:3]
    s_sub_u32 s71, s57, 8
    ds_read_b128 a[72:75], v233 offset:0
    v_add_u32 v214, s70, v214
    v_mfma_f32_16x16x32_bf16 v[36:39], a[108:111], v[180:183], v[36:39]
    ds_read_b128 a[76:79], v233 offset:1024
    v_add_u32 v210, s71, v210
    v_mfma_f32_16x16x32_bf16 v[4:7], a[112:115], v[176:179], v[4:7]
L_padg3:
    s_cbranch_execz L_walked1
    s_lshl_b32 s68, s6, 6
    s_add_u32 s68, s68, s4
    s_lshl_b32 s68, s68, 10
    v_mfma_f32_16x16x32_bf16 v[40:43], a[112:115], v[180:183], v[40:43]
    buffer_load_dwordx4 a[184:187], v239, s[52:55], s12 offen offset:1024 sc1
    v_mfma_f32_16x16x32_bf16 v[8:11], a[116:119], v[176:179], v[8:11]
    s_add_u32 s68, s68, 7536640
    ds_read_b128 a[80:83], v233 offset:2048
    s_movk_i32 s70, 1408
    v_mfma_f32_16x16x32_bf16 v[44:47], a[116:119], v[180:183], v[44:47]
    s_cmp_eq_u32 s4, 0
    s_cselect_b32 s69, 896, s70
    ds_read_b128 a[84:87], v233 offset:3072
    v_mfma_f32_16x16x32_bf16 v[12:15], a[120:123], v[176:179], v[12:15]
    ds_read_b128 a[88:91], v233 offset:4096
    v_lshlrev_b32 v255, 3, v239
    v_mfma_f32_16x16x32_bf16 v[48:51], a[120:123], v[180:183], v[48:51]
    ds_read_b128 a[92:95], v233 offset:5120
    v_min_u32 v255, s69, v255
    v_mfma_f32_16x16x32_bf16 v[16:19], a[124:127], v[176:179], v[16:19]
    buffer_load_dwordx4 a[180:183], v239, s[52:55], s12 offen offset:0 sc1
    v_mfma_f32_16x16x32_bf16 v[52:55], a[124:127], v[180:183], v[52:55]
    ds_read_b128 a[96:99], v233 offset:6144
    v_and_b32 v240, 1024, v255
    v_mfma_f32_16x16x32_bf16 v[20:23], a[128:131], v[176:179], v[20:23]
    v_exp_f32 v160, v160
    v_mfma_f32_16x16x32_bf16 v[56:59], a[128:131], v[180:183], v[56:59]
    ds_read_b128 a[100:103], v233 offset:7168
    v_exp_f32 v161, v161
    v_mfma_f32_16x16x32_bf16 v[24:27], a[132:135], v[176:179], v[24:27]
    ds_read_b128 a[104:107], v233 offset:8192
    v_exp_f32 v168, v168
    v_mfma_f32_16x16x32_bf16 v[60:63], a[132:135], v[180:183], v[60:63]
    s_add_u32 s12, s64, 4727296
    v_exp_f32 v169, v169
    v_mfma_f32_16x16x32_bf16 v[28:31], a[136:139], v[176:179], v[28:31]
    buffer_load_dwordx2 a[178:179], v231, s[52:55], s12 offen sc1
    v_mfma_f32_16x16x32_bf16 v[64:67], a[136:139], v[180:183], v[64:67]
    v_cvt_pk_bf16_f32 v184, v160, v161
    v_exp_f32 v162, v162
    v_mfma_f32_16x16x32_bf16 v[32:35], a[140:143], v[176:179], v[32:35]
    v_exp_f32 v163, v163
    v_mfma_f32_16x16x32_bf16 v[68:71], a[140:143], v[180:183], v[68:71]
    s_waitcnt lgkmcnt(0)
    v_mad_i32_i24 v255, v240, -2, v255
    v_add_u32 v255, s68, v255
    v_mfma_f32_32x32x16_bf16 v[144:159], a[72:75], a[0:3], 0
    s_add_u32 s40, s16, s65
    s_addc_u32 s41, s17, 0
    v_cvt_pk_bf16_f32 v188, v168, v169
    v_exp_f32 v170, v170
    v_exp_f32 v171, v171
    v_mfma_f32_32x32x16_bf16 v[144:159], a[76:79], a[4:7], v[144:159]
    s_add_u32 s12, s64, 4723200
    v_cvt_pk_bf16_f32 v185, v162, v163
    v_permlane16_swap_b32 v184, v188
    v_exp_f32 v164, v164
    v_mfma_f32_32x32x16_bf16 v[144:159], a[80:83], a[8:11], v[144:159]
    buffer_load_dwordx4 a[174:177], v239, s[52:55], s12 offen offset:3072 sc1
    v_exp_f32 v165, v165
    v_cvt_pk_bf16_f32 v189, v170, v171
    v_mfma_f32_32x32x16_bf16 v[144:159], a[84:87], a[12:15], v[144:159]
    s_mov_b32 s42, 1152000
    v_exp_f32 v172, v172
    v_exp_f32 v173, v173
    v_cvt_pk_bf16_f32 v186, v164, v165
    v_permlane16_swap_b32 v185, v189
    v_mfma_f32_32x32x16_bf16 v[144:159], a[88:91], a[16:19], v[144:159]
    buffer_load_dwordx4 a[170:173], v239, s[52:55], s12 offen offset:2048 sc1
    v_exp_f32 v166, v166
    v_exp_f32 v167, v167
    v_mfma_f32_32x32x16_bf16 v[144:159], a[92:95], a[20:23], v[144:159]
    s_mov_b32 s43, 0x20000
    v_cvt_pk_bf16_f32 v190, v172, v173
    v_exp_f32 v174, v174
    v_exp_f32 v175, v175
    v_mfma_f32_32x32x16_bf16 v[144:159], a[96:99], a[24:27], v[144:159]
    buffer_load_dwordx4 a[166:169], v239, s[52:55], s12 offen offset:1024 sc1
    v_cvt_pk_bf16_f32 v187, v166, v167
    v_permlane16_swap_b32 v186, v190
    v_cvt_pk_bf16_f32 v191, v174, v175
    v_mfma_f32_32x32x16_bf16 v[144:159], a[100:103], a[28:31], v[144:159]
    s_lshl_b32 s60, s3, 12
    s_min_u32 s60, s60, 10240
    v_permlane16_swap_b32 v187, v191
    v_mfma_f32_32x32x16_bf16 v[144:159], a[104:107], a[32:35], v[144:159]
    s_add_u32 m0, s60, 147456
    s_add_u32 s60, s60, 4816896
    buffer_load_dwordx4 v239, s[52:55], s60 offen offset:0 sc1 lds
    v_mfma_f32_16x16x32_bf16 v[72:75], a[108:111], v[184:187], v[72:75]
    s_add_u32 s62, s65, 2359296
    ds_read_b128 a[72:75], v233 offset:36864
    v_mfma_f32_16x16x32_bf16 v[108:111], a[108:111], v[188:191], v[108:111]
    s_add_u32 s44, s38, s62
    s_addc_u32 s45, s39, 0
    ds_read_b128 a[76:79], v233 offset:37888
    v_mfma_f32_16x16x32_bf16 v[76:79], a[112:115], v[184:187], v[76:79]
    s_mov_b32 s46, 1152000
    ds_read_b128 a[80:83], v233 offset:38912
    v_mfma_f32_16x16x32_bf16 v[112:115], a[112:115], v[188:191], v[112:115]
    s_mov_b32 s47, 0x20000
    ds_read_b128 a[84:87], v233 offset:39936
    v_mfma_f32_16x16x32_bf16 v[80:83], a[116:119], v[184:187], v[80:83]
    s_add_u32 s62, s65, 7667712
    ds_read_b128 a[88:91], v233 offset:40960
    v_mfma_f32_16x16x32_bf16 v[116:119], a[116:119], v[188:191], v[116:119]
    s_add_u32 s48, s38, s62
    s_addc_u32 s49, s39, 0
    ds_read_b128 a[92:95], v233 offset:41984
    v_mfma_f32_16x16x32_bf16 v[84:87], a[120:123], v[184:187], v[84:87]
    s_mov_b32 s50, 1152000
    ds_read_b128 a[96:99], v233 offset:43008
    v_exp_f32 v144, v144
    v_mfma_f32_16x16x32_bf16 v[120:123], a[120:123], v[188:191], v[120:123]
    buffer_load_dwordx4 v239, s[52:55], s60 offen offset:1024 sc1 lds
    ds_read_b128 a[100:103], v233 offset:44032
    v_mfma_f32_16x16x32_bf16 v[88:91], a[124:127], v[184:187], v[88:91]
    buffer_load_dwordx4 v239, s[52:55], s60 offen offset:2048 sc1 lds
    ds_read_b128 a[104:107], v233 offset:45056
    v_mfma_f32_16x16x32_bf16 v[124:127], a[124:127], v[188:191], v[124:127]
    s_mov_b32 s51, 0x20000
    ds_read_b64_tr_b16 a[108:109], v235 offset:0
    ds_read_b64_tr_b16 a[110:111], v237 offset:0
    v_mfma_f32_16x16x32_bf16 v[92:95], a[128:131], v[184:187], v[92:95]
    s_xor_b32 s68, s2, 5
    ds_read_b64_tr_b16 a[112:113], v235 offset:1024
    ds_read_b64_tr_b16 a[114:115], v237 offset:1024
    v_mfma_f32_16x16x32_bf16 v[128:131], a[128:131], v[188:191], v[128:131]
    s_mul_i32 s68, s68, 10240
    ds_read_b64_tr_b16 a[116:117], v235 offset:2048
    ds_read_b64_tr_b16 a[118:119], v237 offset:2048
    v_mfma_f32_16x16x32_bf16 v[96:99], a[132:135], v[184:187], v[96:99]
    s_add_u32 s68, s68, 4849664
    ds_read_b64_tr_b16 a[120:121], v235 offset:3072
    ds_read_b64_tr_b16 a[122:123], v237 offset:3072
    v_mfma_f32_16x16x32_bf16 v[132:135], a[132:135], v[188:191], v[132:135]
    s_lshl_b32 s69, s73, 9
    v_exp_f32 v145, v145
    v_mfma_f32_16x16x32_bf16 v[100:103], a[136:139], v[184:187], v[100:103]
    s_add_u32 s71, s69, s76
    v_exp_f32 v152, v152
    v_mfma_f32_16x16x32_bf16 v[136:139], a[136:139], v[188:191], v[136:139]
    s_add_u32 s69, s69, s68
    v_exp_f32 v153, v153
    v_mfma_f32_16x16x32_bf16 v[104:107], a[140:143], v[184:187], v[104:107]
    s_add_u32 s69, s69, 8192
    v_cvt_pk_bf16_f32 v176, v144, v145
    v_exp_f32 v146, v146
    v_mfma_f32_16x16x32_bf16 v[140:143], a[140:143], v[188:191], v[140:143]
    buffer_load_dwordx4 v239, s[52:55], s60 offen offset:3072 sc1 lds
    s_waitcnt lgkmcnt(8)
    v_mfma_f32_32x32x16_bf16 v[160:175], a[72:75], a[0:3], 0
    s_add_u32 s71, s71, 8192
    ds_read_b64_tr_b16 a[124:125], v235 offset:4096
    v_exp_f32 v147, v147
    v_cvt_pk_bf16_f32 v180, v152, v153
    v_exp_f32 v154, v154
    v_mfma_f32_32x32x16_bf16 v[160:175], a[76:79], a[4:7], v[160:175]
    buffer_load_dwordx2 v[228:229], v255, s[52:55], 0 offen sc1
    ds_read_b64_tr_b16 a[126:127], v237 offset:4096
    ds_read_b64_tr_b16 a[128:129], v235 offset:5120
    v_exp_f32 v155, v155
    v_cvt_pk_bf16_f32 v177, v146, v147
    v_mfma_f32_32x32x16_bf16 v[160:175], a[80:83], a[8:11], v[160:175]
    buffer_load_dwordx4 a[162:165], v239, s[52:55], s12 offen offset:0 sc1
    v_permlane16_swap_b32 v176, v180
    v_exp_f32 v148, v148
    v_exp_f32 v149, v149
    v_mfma_f32_32x32x16_bf16 v[160:175], a[84:87], a[12:15], v[160:175]
    s_lshl_b32 s70, s3, 11
    ds_read_b64_tr_b16 a[130:131], v237 offset:5120
    ds_read_b64_tr_b16 a[132:133], v235 offset:6144
    v_cvt_pk_bf16_f32 v181, v154, v155
    v_exp_f32 v156, v156
    v_exp_f32 v157, v157
    v_mfma_f32_32x32x16_bf16 v[160:175], a[88:91], a[16:19], v[160:175]
    s_add_u32 s68, s68, s70
    ds_read_b64_tr_b16 a[134:135], v237 offset:6144
    ds_read_b64_tr_b16 a[136:137], v235 offset:7168
    v_cvt_pk_bf16_f32 v178, v148, v149
    v_permlane16_swap_b32 v177, v181
    v_exp_f32 v150, v150
    v_mfma_f32_32x32x16_bf16 v[160:175], a[92:95], a[20:23], v[160:175]
    s_add_u32 s70, s70, s76
    ds_read_b64_tr_b16 a[138:139], v237 offset:7168
    ds_read_b64_tr_b16 a[140:141], v235 offset:8192
    v_exp_f32 v151, v151
    v_cvt_pk_bf16_f32 v182, v156, v157
    v_exp_f32 v158, v158
    v_mfma_f32_32x32x16_bf16 v[160:175], a[96:99], a[24:27], v[160:175]
    s_add_u32 s12, s64, 4722688
    ds_read_b64_tr_b16 a[142:143], v237 offset:8192
    v_exp_f32 v159, v159
    v_cvt_pk_bf16_f32 v179, v150, v151
    v_permlane16_swap_b32 v178, v182
    v_cvt_pk_bf16_f32 v183, v158, v159
    v_mfma_f32_32x32x16_bf16 v[160:175], a[100:103], a[28:31], v[160:175]
    buffer_load_dwordx2 a[160:161], v231, s[52:55], s12 offen sc1
    s_add_u32 s12, s64, 4718592
    v_permlane16_swap_b32 v179, v183
    v_mfma_f32_32x32x16_bf16 v[160:175], a[104:107], a[32:35], v[160:175]
    s_waitcnt lgkmcnt(0)
    s_cmp_ge_u32 s3, 2
    s_cselect_b32 s69, 0x7fff0000, s69
    s_cselect_b32 s71, s71, 0x7fff0000
    s_mul_i32 s13, s67, 9216
    s_mul_i32 s15, s73, 4608
    s_add_u32 s14, s13, s15
    v_mfma_f32_16x16x32_bf16 v[0:3], a[108:111], v[176:179], v[0:3]
    buffer_load_dwordx4 a[156:159], v239, s[52:55], s12 offen offset:3072 sc1
    v_mfma_f32_16x16x32_bf16 v[36:39], a[108:111], v[180:183], v[36:39]
    buffer_load_dwordx4 a[152:155], v239, s[52:55], s12 offen offset:2048 sc1
    v_mfma_f32_16x16x32_bf16 v[4:7], a[112:115], v[176:179], v[4:7]
    s_sub_u32 s15, s13, s15
    ds_read_b64_tr_b16 a[0:1], v235 offset:36864
    v_mfma_f32_16x16x32_bf16 v[40:43], a[112:115], v[180:183], v[40:43]
    s_add_u32 s15, s15, 4608
    ds_read_b64_tr_b16 a[2:3], v237 offset:36864
    v_mfma_f32_16x16x32_bf16 v[8:11], a[116:119], v[176:179], v[8:11]
    s_cmp_ge_u32 s3, 2
    s_cselect_b32 s72, 0x7fff0000, s13
    ds_read_b64_tr_b16 a[4:5], v235 offset:37888
    v_mfma_f32_16x16x32_bf16 v[44:47], a[116:119], v[180:183], v[44:47]
    s_nop 0
    ds_read_b64_tr_b16 a[6:7], v237 offset:37888
    ds_read_b64_tr_b16 a[8:9], v235 offset:38912
    v_mfma_f32_16x16x32_bf16 v[12:15], a[120:123], v[176:179], v[12:15]
    s_nop 0
    ds_read_b64_tr_b16 a[10:11], v237 offset:38912
    ds_read_b64_tr_b16 a[12:13], v235 offset:39936
    v_mfma_f32_16x16x32_bf16 v[48:51], a[120:123], v[180:183], v[48:51]
    s_nop 0
    ds_read_b64_tr_b16 a[14:15], v237 offset:39936
    ds_read_b64_tr_b16 a[16:17], v235 offset:40960
    v_mfma_f32_16x16x32_bf16 v[16:19], a[124:127], v[176:179], v[16:19]
    s_nop 0
    ds_read_b64_tr_b16 a[18:19], v237 offset:40960
    ds_read_b64_tr_b16 a[20:21], v235 offset:41984
    v_mfma_f32_16x16x32_bf16 v[52:55], a[124:127], v[180:183], v[52:55]
    s_nop 0
    ds_read_b64_tr_b16 a[22:23], v237 offset:41984
    ds_read_b64_tr_b16 a[24:25], v235 offset:43008
    v_mfma_f32_16x16x32_bf16 v[20:23], a[128:131], v[176:179], v[20:23]
    v_exp_f32 v160, v160
    v_mfma_f32_16x16x32_bf16 v[56:59], a[128:131], v[180:183], v[56:59]
    buffer_load_dwordx4 a[148:151], v239, s[52:55], s12 offen offset:1024 sc1
    v_mfma_f32_16x16x32_bf16 v[24:27], a[132:135], v[176:179], v[24:27]
    v_exp_f32 v161, v161
    v_mfma_f32_16x16x32_bf16 v[60:63], a[132:135], v[180:183], v[60:63]
    v_exp_f32 v168, v168
    v_exp_f32 v169, v169
    v_mfma_f32_16x16x32_bf16 v[28:31], a[136:139], v[176:179], v[28:31]
    ds_read_b64_tr_b16 a[26:27], v237 offset:43008
    v_cvt_pk_bf16_f32 v184, v160, v161
    v_mfma_f32_16x16x32_bf16 v[64:67], a[136:139], v[180:183], v[64:67]
    buffer_load_dwordx4 a[144:147], v239, s[52:55], s12 offen offset:0 sc1
    v_mfma_f32_16x16x32_bf16 v[32:35], a[140:143], v[176:179], v[32:35]
    v_exp_f32 v162, v162
    v_exp_f32 v163, v163
    v_mfma_f32_16x16x32_bf16 v[68:71], a[140:143], v[180:183], v[68:71]
    s_nop 0
    ds_read_b64_tr_b16 a[28:29], v235 offset:44032
    ds_read_b64_tr_b16 a[30:31], v237 offset:44032
    s_branch L_b14
L_gend:
L_slow:
    s_cmp_eq_u32 s97, 7
    s_cbranch_scc1 L_fast
    s_mov_b32 s97, 7
    s_add_u32 s60, s65, 1024
    v_mov_b32 v176, 0xff800000
    s_mov_b32 s77, 0
    v_accvgpr_write_b32 a0, v144
    v_accvgpr_write_b32 a1, v145
    v_accvgpr_write_b32 a2, v146
    v_accvgpr_write_b32 a3, v147
    v_accvgpr_write_b32 a4, v148
    v_accvgpr_write_b32 a5, v149
    v_accvgpr_write_b32 a6, v150
    v_accvgpr_write_b32 a7, v151
    v_accvgpr_write_b32 a8, v152
    v_accvgpr_write_b32 a9, v153
    v_accvgpr_write_b32 a10, v154
    v_accvgpr_write_b32 a11, v155
    v_accvgpr_write_b32 a12, v156
    v_accvgpr_write_b32 a13, v157
    v_accvgpr_write_b32 a14, v158
    v_accvgpr_write_b32 a15, v159
    v_accvgpr_write_b32 a16, v160
    v_accvgpr_write_b32 a17, v161
    v_accvgpr_write_b32 a18, v162
    v_accvgpr_write_b32 a19, v163
L_spass:
    s_add_u32 s8, s38, s60
    s_addc_u32 s9, s39, 0
    s_mov_b32 s10, 1155072
L_stile:
    s_add_u32 m0, s64, 110592
    s_nop 0
    buffer_load_dwordx4 v239, s[8:11], s18 offen offset:0 sc1 lds
    buffer_load_dwordx4 v239, s[8:11], s19 offen offset:1024 sc1 lds
    buffer_load_dwordx4 v239, s[8:11], s20 offen offset:2048 sc1 lds
    buffer_load_dwordx4 v239, s[8:11], s21 offen offset:3072 sc1 lds
    s_add_u32 m0, s64, 114688
    s_nop 0
    buffer_load_dwordx4 v239, s[8:11], s22 offen offset:0 sc1 lds
    buffer_load_dwordx4 v239, s[8:11], s23 offen offset:1024 sc1 lds
    buffer_load_dwordx4 v239, s[8:11], s24 offen offset:2048 sc1 lds
    buffer_load_dwordx4 v239, s[8:11], s25 offen offset:3072 sc1 lds
    s_add_u32 m0, s64, 118784
    s_nop 0
    buffer_load_dwordx4 v239, s[8:11], s26 offen offset:0 sc1 lds
    s_add_u32 s8, s8, 9216
    s_addc_u32 s9, s9, 0
    s_sub_u32 s10, s10, 9216
    s_max_i32 s10, s10, 0
    s_waitcnt vmcnt(0)
    ds_read_b128 a[72:75], v233 offset:36864
    ds_read_b128 a[76:79], v233 offset:37888
    ds_read_b128 a[80:83], v233 offset:38912
    ds_read_b128 a[84:87], v233 offset:39936
    ds_read_b128 a[88:91], v233 offset:40960
    ds_read_b128 a[92:95], v233 offset:41984
    ds_read_b128 a[96:99], v233 offset:43008
    ds_read_b128 a[100:103], v233 offset:44032
    ds_read_b128 a[104:107], v233 offset:45056
    s_waitcnt lgkmcnt(0)
    v_mfma_f32_32x32x16_bf16 v[160:175], a[72:75], a[36:39], 0
    v_mfma_f32_32x32x16_bf16 v[160:175], a[76:79], a[40:43], v[160:175]
    v_mfma_f32_32x32x16_bf16 v[160:175], a[80:83], a[44:47], v[160:175]
    v_mfma_f32_32x32x16_bf16 v[160:175], a[84:87], a[48:51], v[160:175]
    v_mfma_f32_32x32x16_bf16 v[160:175], a[88:91], a[52:55], v[160:175]
    v_mfma_f32_32x32x16_bf16 v[160:175], a[92:95], a[56:59], v[160:175]
    v_mfma_f32_32x32x16_bf16 v[160:175], a[96:99], a[60:63], v[160:175]
    v_mfma_f32_32x32x16_bf16 v[160:175], a[100:103], a[64:67], v[160:175]
    v_mfma_f32_32x32x16_bf16 v[160:175], a[104:107], a[68:71], v[160:175]
    s_cmp_eq_u32 s77, 1
    s_cbranch_scc1 L_sacc
    s_nop 15
    v_max3_f32 v176, v176, v160, v161
    v_max3_f32 v176, v176, v162, v163
    v_max3_f32 v176, v176, v164, v165
    v_max3_f32 v176, v176, v166, v167
    v_max3_f32 v176, v176, v168, v169
    v_max3_f32 v176, v176, v170, v171
    v_max3_f32 v176, v176, v172, v173
    v_max3_f32 v176, v176, v174, v175
    s_branch L_snext
L_sacc:
    ds_read_b64_tr_b16 a[108:109], v235 offset:36864
    ds_read_b64_tr_b16 a[110:111], v237 offset:36864
    ds_read_b64_tr_b16 a[112:113], v235 offset:37888
    ds_read_b64_tr_b16 a[114:115], v237 offset:37888
    ds_read_b64_tr_b16 a[116:117], v235 offset:38912
    ds_read_b64_tr_b16 a[118:119], v237 offset:38912
    ds_read_b64_tr_b16 a[120:121], v235 offset:39936
    ds_read_b64_tr_b16 a[122:123], v237 offset:39936
    ds_read_b64_tr_b16 a[124:125], v235 offset:40960
    ds_read_b64_tr_b16 a[126:127], v237 offset:40960
    ds_read_b64_tr_b16 a[128:129], v235 offset:41984
    ds_read_b64_tr_b16 a[130:131], v237 offset:41984
    ds_read_b64_tr_b16 a[132:133], v235 offset:43008
    ds_read_b64_tr_b16 a[136:137], v235 offset:44032
    ds_read_b64_tr_b16 a[140:141], v235 offset:45056
    s_waitcnt lgkmcnt(0)
    ds_read_b64_tr_b16 a[134:135], v237 offset:43008
    ds_read_b64_tr_b16 a[138:139], v237 offset:44032
    ds_read_b64_tr_b16 a[142:143], v237 offset:45056
    v_sub_f32 v160, v160, v176
    v_sub_f32 v161, v161, v176
    v_sub_f32 v162, v162, v176
    v_sub_f32 v163, v163, v176
    v_sub_f32 v164, v164, v176
    v_sub_f32 v165, v165, v176
    v_sub_f32 v166, v166, v176
    v_sub_f32 v167, v167, v176
    v_sub_f32 v168, v168, v176
    v_sub_f32 v169, v169, v176
    v_sub_f32 v170, v170, v176
    v_sub_f32 v171, v171, v176
    v_sub_f32 v172, v172, v176
    v_sub_f32 v173, v173, v176
    v_sub_f32 v174, v174, v176
    v_sub_f32 v175, v175, v176
    v_exp_f32 v160, v160
    v_exp_f32 v161, v161
    v_exp_f32 v168, v168
    v_exp_f32 v169, v169
    v_cvt_pk_bf16_f32 v184, v160, v161
    v_exp_f32 v162, v162
    v_exp_f32 v163, v163
    v_cvt_pk_bf16_f32 v188, v168, v169
    v_exp_f32 v170, v170
    v_exp_f32 v171, v171
    v_cvt_pk_bf16_f32 v185, v162, v163
    v_permlane16_swap_b32 v184, v188
    v_exp_f32 v164, v164
    v_exp_f32 v165, v165
    v_cvt_pk_bf16_f32 v189, v170, v171
    v_exp_f32 v172, v172
    v_exp_f32 v173, v173
    v_cvt_pk_bf16_f32 v186, v164, v165
    v_permlane16_swap_b32 v185, v189
    v_exp_f32 v166, v166
    v_exp_f32 v167, v167
    v_cvt_pk_bf16_f32 v190, v172, v173
    v_exp_f32 v174, v174
    v_exp_f32 v175, v175
    v_cvt_pk_bf16_f32 v187, v166, v167
    v_permlane16_swap_b32 v186, v190
    v_cvt_pk_bf16_f32 v191, v174, v175
    s_nop 1
    v_permlane16_swap_b32 v187, v191
    s_waitcnt lgkmcnt(0)
    s_nop 0
    v_mfma_f32_16x16x32_bf16 v[72:75], a[108:111], v[184:187], v[72:75]
    v_mfma_f32_16x16x32_bf16 v[108:111], a[108:111], v[188:191], v[108:111]
    v_mfma_f32_16x16x32_bf16 v[76:79], a[112:115], v[184:187], v[76:79]
    v_mfma_f32_16x16x32_bf16 v[112:115], a[112:115], v[188:191], v[112:115]
    v_mfma_f32_16x16x32_bf16 v[80:83], a[116:119], v[184:187], v[80:83]
    v_mfma_f32_16x16x32_bf16 v[116:119], a[116:119], v[188:191], v[116:119]
    v_mfma_f32_16x16x32_bf16 v[84:87], a[120:123], v[184:187], v[84:87]
    v_mfma_f32_16x16x32_bf16 v[120:123], a[120:123], v[188:191], v[120:123]
    v_mfma_f32_16x16x32_bf16 v[88:91], a[124:127], v[184:187], v[88:91]
    v_mfma_f32_16x16x32_bf16 v[124:127], a[124:127], v[188:191], v[124:127]
    v_mfma_f32_16x16x32_bf16 v[92:95], a[128:131], v[184:187], v[92:95]
    v_mfma_f32_16x16x32_bf16 v[128:131], a[128:131], v[188:191], v[128:131]
    v_mfma_f32_16x16x32_bf16 v[96:99], a[132:135], v[184:187], v[96:99]
    v_mfma_f32_16x16x32_bf16 v[132:135], a[132:135], v[188:191], v[132:135]
    v_mfma_f32_16x16x32_bf16 v[100:103], a[136:139], v[184:187], v[100:103]
    v_mfma_f32_16x16x32_bf16 v[136:139], a[136:139], v[188:191], v[136:139]
    v_mfma_f32_16x16x32_bf16 v[104:107], a[140:143], v[184:187], v[104:107]
    v_mfma_f32_16x16x32_bf16 v[140:143], a[140:143], v[188:191], v[140:143]
L_snext:
    s_cmp_gt_u32 s10, 3072
    s_cbranch_scc1 L_stile
    s_cmp_eq_u32 s77, 1
    s_cbranch_scc1 L_sdone
    s_mov_b32 s77, 1
    v_mov_b32 v177, v176
    s_nop 1
    v_permlane32_swap_b32 v177, v176
    s_nop 1
    v_max_f32 v176, v176, v177
    v_mov_b32 v72, 0
    v_mov_b32 v73, 0
    v_mov_b32 v74, 0
    v_mov_b32 v75, 0
    v_mov_b32 v76, 0
    v_mov_b32 v77, 0
    v_mov_b32 v78, 0
    v_mov_b32 v79, 0
    v_mov_b32 v80, 0
    v_mov_b32 v81, 0
    v_mov_b32 v82, 0
    v_mov_b32 v83, 0
    v_mov_b32 v84, 0
    v_mov_b32 v85, 0
    v_mov_b32 v86, 0
    v_mov_b32 v87, 0
    v_mov_b32 v88, 0
    v_mov_b32 v89, 0
    v_mov_b32 v90, 0
    v_mov_b32 v91, 0
    v_mov_b32 v92, 0
    v_mov_b32 v93, 0
    v_mov_b32 v94, 0
    v_mov_b32 v95, 0
    v_mov_b32 v96, 0
    v_mov_b32 v97, 0
    v_mov_b32 v98, 0
    v_mov_b32 v99, 0
    v_mov_b32 v100, 0
    v_mov_b32 v101, 0
    v_mov_b32 v102, 0
    v_mov_b32 v103, 0
    v_mov_b32 v104, 0
    v_mov_b32 v105, 0
    v_mov_b32 v106, 0
    v_mov_b32 v107, 0
    v_mov_b32 v108, 0
    v_mov_b32 v109, 0
    v_mov_b32 v110, 0
    v_mov_b32 v111, 0
    v_mov_b32 v112, 0
    v_mov_b32 v113, 0
    v_mov_b32 v114, 0
    v_mov_b32 v115, 0
    v_mov_b32 v116, 0
    v_mov_b32 v117, 0
    v_mov_b32 v118, 0
    v_mov_b32 v119, 0
    v_mov_b32 v120, 0
    v_mov_b32 v121, 0
    v_mov_b32 v122, 0
    v_mov_b32 v123, 0
    v_mov_b32 v124, 0
    v_mov_b32 v125, 0
    v_mov_b32 v126, 0
    v_mov_b32 v127, 0
    v_mov_b32 v128, 0
    v_mov_b32 v129, 0
    v_mov_b32 v130, 0
    v_mov_b32 v131, 0
    v_mov_b32 v132, 0
    v_mov_b32 v133, 0
    v_mov_b32 v134, 0
    v_mov_b32 v135, 0
    v_mov_b32 v136, 0
    v_mov_b32 v137, 0
    v_mov_b32 v138, 0
    v_mov_b32 v139, 0
    v_mov_b32 v140, 0
    v_mov_b32 v141, 0
    v_mov_b32 v142, 0
    v_mov_b32 v143, 0
    s_branch L_spass
L_sdone:
    s_nop 15
    v_accvgpr_read_b32 v144, a0
    v_accvgpr_read_b32 v145, a1
    v_accvgpr_read_b32 v146, a2
    v_accvgpr_read_b32 v147, a3
    v_accvgpr_read_b32 v148, a4
    v_accvgpr_read_b32 v149, a5
    v_accvgpr_read_b32 v150, a6
    v_accvgpr_read_b32 v151, a7
    v_accvgpr_read_b32 v152, a8
    v_accvgpr_read_b32 v153, a9
    v_accvgpr_read_b32 v154, a10
    v_accvgpr_read_b32 v155, a11
    v_accvgpr_read_b32 v156, a12
    v_accvgpr_read_b32 v157, a13
    v_accvgpr_read_b32 v158, a14
    v_accvgpr_read_b32 v159, a15
    v_accvgpr_read_b32 v160, a16
    v_accvgpr_read_b32 v161, a17
    v_accvgpr_read_b32 v162, a18
    v_accvgpr_read_b32 v163, a19
    s_cmp_lg_u32 s3, 0
    s_cbranch_scc1 L_sback
    v_cvt_pk_bf16_f32 v164, v72, v73
    v_cvt_pk_bf16_f32 v165, v74, v75
    v_cvt_pk_bf16_f32 v166, v76, v77
    v_cvt_pk_bf16_f32 v167, v78, v79
    ds_write_b128 v250, v[164:167] offset:0
    s_waitcnt lgkmcnt(0)
    v_cvt_pk_bf16_f32 v166, v80, v81
    v_cvt_pk_bf16_f32 v167, v82, v83
    v_cvt_pk_bf16_f32 v164, v84, v85
    v_cvt_pk_bf16_f32 v165, v86, v87
    ds_write_b128 v250, v[164:167] offset:1024
    s_waitcnt lgkmcnt(0)
    v_cvt_pk_bf16_f32 v164, v88, v89
    v_cvt_pk_bf16_f32 v165, v90, v91
    v_cvt_pk_bf16_f32 v166, v92, v93
    v_cvt_pk_bf16_f32 v167, v94, v95
    ds_write_b128 v250, v[164:167] offset:2048
    s_waitcnt lgkmcnt(0)
    v_cvt_pk_bf16_f32 v166, v96, v97
    v_cvt_pk_bf16_f32 v167, v98, v99
    v_cvt_pk_bf16_f32 v164, v100, v101
    v_cvt_pk_bf16_f32 v165, v102, v103
    ds_write_b128 v250, v[164:167] offset:3072
    s_waitcnt lgkmcnt(0)
    v_cvt_pk_bf16_f32 v164, v104, v105
    v_cvt_pk_bf16_f32 v165, v106, v107
    ds_write_b64 v251, v[164:165] offset:0
    s_waitcnt lgkmcnt(0)
    v_cvt_pk_bf16_f32 v164, v108, v109
    v_cvt_pk_bf16_f32 v165, v110, v111
    v_cvt_pk_bf16_f32 v166, v112, v113
    v_cvt_pk_bf16_f32 v167, v114, v115
    ds_write_b128 v250, v[164:167] offset:4608
    s_waitcnt lgkmcnt(0)
    v_cvt_pk_bf16_f32 v166, v116, v117
    v_cvt_pk_bf16_f32 v167, v118, v119
    v_cvt_pk_bf16_f32 v164, v120, v121
    v_cvt_pk_bf16_f32 v165, v122, v123
    ds_write_b128 v250, v[164:167] offset:5632
    s_waitcnt lgkmcnt(0)
    v_cvt_pk_bf16_f32 v164, v124, v125
    v_cvt_pk_bf16_f32 v165, v126, v127
    v_cvt_pk_bf16_f32 v166, v128, v129
    v_cvt_pk_bf16_f32 v167, v130, v131
    ds_write_b128 v250, v[164:167] offset:6656
    s_waitcnt lgkmcnt(0)
    v_cvt_pk_bf16_f32 v166, v132, v133
    v_cvt_pk_bf16_f32 v167, v134, v135
    v_cvt_pk_bf16_f32 v164, v136, v137
    v_cvt_pk_bf16_f32 v165, v138, v139
    ds_write_b128 v250, v[164:167] offset:7680
    s_waitcnt lgkmcnt(0)
    v_cvt_pk_bf16_f32 v164, v140, v141
    v_cvt_pk_bf16_f32 v165, v142, v143
    ds_write_b64 v251, v[164:165] offset:4608
    s_waitcnt lgkmcnt(0)
    s_branch L_sback
L_roleW:
    v_lshlrev_b32 v239, 4, v3
    v_and_b32 v243, 3, v3
    s_getpc_b64 s[12:13]
    v_lshlrev_b32 v9, 7, v3
    v_min_u32 v9, L_end-L_roleW, v9
    global_load_dword v19, v9, s[12:13]
    s_lshl_b32 s4, s93, 2
    s_add_u32 s4, s4, s3
    s_mul_i32 s8, s6, 41472
    s_cmp_eq_u32 s6, 0
    s_cselect_b32 s10, s22, s30
    s_cselect_b32 s11, s23, s31
    s_lshl_b32 s61, s3, 10
    s_lshl1_add_u32 s78, s6, s93
    s_lshl_b32 s78, s78, 11
    s_add_u32 s78, s78, 4804608
    v_mov_b32 v9, v3
    v_lshrrev_b32 v5, 2, v9
    v_mul_u32_u24 v5, 288, v5
    v_lshl_add_u32 v5, v243, 3, v5
    v_lshlrev_b32 v238, 3, v9
    s_mov_b32 s40, s10
    s_mov_b32 s41, s11
    s_mov_b32 s42, 41472
    s_mov_b32 s43, 0x20000
    s_mov_b32 s44, s24
    s_mov_b32 s45, s25
    s_mov_b32 s46, 41472
    s_mov_b32 s47, 0x20000
    s_add_u32 s48, s32, s8
    s_addc_u32 s49, s33, 0
    s_mov_b32 s50, 41472
    s_mov_b32 s51, 0x20000
    s_mov_b32 s52, s38
    s_mov_b32 s53, s39
    s_mov_b32 s54, 10027008
    s_mov_b32 s55, 0x20000
    s_lshl_b32 s5, s4, 4
    v_add_u32 v3, s5, v1
    v_mul_u32_u24 v3, 288, v3
    v_lshl_add_u32 v3, v2, 3, v3
    buffer_load_dwordx2 v[148:149], v3, s[40:43], 0 offen offset:0
    buffer_load_dwordx2 v[150:151], v3, s[40:43], 0 offen offset:32
    buffer_load_dwordx2 v[152:153], v3, s[40:43], 0 offen offset:64
    buffer_load_dwordx2 v[154:155], v3, s[40:43], 0 offen offset:96
    buffer_load_dwordx2 v[156:157], v3, s[40:43], 0 offen offset:128
    buffer_load_dwordx2 v[158:159], v3, s[40:43], 0 offen offset:160
    buffer_load_dwordx2 v[160:161], v3, s[40:43], 0 offen offset:192
    buffer_load_dwordx2 v[162:163], v3, s[40:43], 0 offen offset:224
    buffer_load_dwordx2 v[164:165], v3, s[40:43], 0 offen offset:256
    s_cmp_lg_u32 s6, 0
    s_cbranch_scc1 L_w0
    v_lshlrev_b32 v3, 3, v2
    v_add_u32 v3, 41184, v3
    buffer_load_dwordx2 v[20:21], v3, s[40:43], 0 offen offset:0
    buffer_load_dwordx2 v[22:23], v3, s[40:43], 0 offen offset:32
    buffer_load_dwordx2 v[24:25], v3, s[40:43], 0 offen offset:64
    buffer_load_dwordx2 v[26:27], v3, s[40:43], 0 offen offset:96
    buffer_load_dwordx2 v[28:29], v3, s[40:43], 0 offen offset:128
    buffer_load_dwordx2 v[30:31], v3, s[40:43], 0 offen offset:160
    buffer_load_dwordx2 v[32:33], v3, s[40:43], 0 offen offset:192
    buffer_load_dwordx2 v[34:35], v3, s[40:43], 0 offen offset:224
    buffer_load_dwordx2 v[36:37], v3, s[40:43], 0 offen offset:256
    s_add_u32 m0, s61, 0
    s_add_u32 s62, s61, 0
    buffer_load_dwordx4 v239, s[44:47], s62 offen lds
    s_add_u32 m0, s61, 4096
    s_add_u32 s62, s61, 4096
    buffer_load_dwordx4 v239, s[44:47], s62 offen lds
    s_add_u32 m0, s61, 8192
    s_add_u32 s62, s61, 8192
    buffer_load_dwordx4 v239, s[44:47], s62 offen lds
    s_add_u32 m0, s61, 12288
    s_add_u32 s62, s61, 12288
    buffer_load_dwordx4 v239, s[44:47], s62 offen lds
    s_add_u32 m0, s61, 16384
    s_add_u32 s62, s61, 16384
    buffer_load_dwordx4 v239, s[44:47], s62 offen lds
    s_add_u32 m0, s61, 20480
    s_add_u32 s62, s61, 20480
    buffer_load_dwordx4 v239, s[44:47], s62 offen lds
    s_add_u32 m0, s61, 24576
    s_add_u32 s62, s61, 24576
    buffer_load_dwordx4 v239, s[44:47], s62 offen lds
    s_add_u32 m0, s61, 28672
    s_add_u32 s62, s61, 28672
    buffer_load_dwordx4 v239, s[44:47], s62 offen lds
    s_add_u32 m0, s61, 32768
    s_add_u32 s62, s61, 32768
    buffer_load_dwordx4 v239, s[44:47], s62 offen lds
    s_add_u32 m0, s61, 36864
    s_add_u32 s62, s61, 36864
    buffer_load_dwordx4 v239, s[44:47], s62 offen lds
    s_add_u32 m0, s61, 40960
    s_add_u32 s62, s61, 40960
    buffer_load_dwordx4 v239, s[44:47], s62 offen lds
L_w0:
    s_add_u32 m0, s61, 45056
    s_add_u32 s62, s61, 0
    buffer_load_dwordx4 v239, s[48:51], s62 offen lds
    s_add_u32 m0, s61, 49152
    s_add_u32 s62, s61, 4096
    buffer_load_dwordx4 v239, s[48:51], s62 offen lds
    s_add_u32 m0, s61, 53248
    s_add_u32 s62, s61, 8192
    buffer_load_dwordx4 v239, s[48:51], s62 offen lds
    s_add_u32 m0, s61, 57344
    s_add_u32 s62, s61, 12288
    buffer_load_dwordx4 v239, s[48:51], s62 offen lds
    s_add_u32 m0, s61, 61440
    s_add_u32 s62, s61, 16384
    buffer_load_dwordx4 v239, s[48:51], s62 offen lds
    s_add_u32 m0, s61, 65536
    s_add_u32 s62, s61, 20480
    buffer_load_dwordx4 v239, s[48:51], s62 offen lds
    s_add_u32 m0, s61, 69632
    s_add_u32 s62, s61, 24576
    buffer_load_dwordx4 v239, s[48:51], s62 offen lds
    s_add_u32 m0, s61, 73728
    s_add_u32 s62, s61, 28672
    buffer_load_dwordx4 v239, s[48:51], s62 offen lds
    s_add_u32 m0, s61, 77824
    s_add_u32 s62, s61, 32768
    buffer_load_dwordx4 v239, s[48:51], s62 offen lds
    s_add_u32 m0, s61, 81920
    s_add_u32 s62, s61, 36864
    buffer_load_dwordx4 v239, s[48:51], s62 offen lds
    s_add_u32 m0, s61, 86016
    s_add_u32 s62, s61, 40960
    buffer_load_dwordx4 v239, s[48:51], s62 offen lds
    s_cmp_lg_u32 s4, 0
    s_cbranch_scc1 L_w1
    v_mul_u32_u24 v3, 288, v1
    v_lshl_add_u32 v3, v2, 3, v3
    v_add_u32 v3, 36864, v3
    buffer_load_dwordx2 v[204:205], v3, s[40:43], 0 offen offset:0
    buffer_load_dwordx2 v[206:207], v3, s[40:43], 0 offen offset:32
    buffer_load_dwordx2 v[208:209], v3, s[40:43], 0 offen offset:64
    buffer_load_dwordx2 v[210:211], v3, s[40:43], 0 offen offset:96
    buffer_load_dwordx2 v[212:213], v3, s[40:43], 0 offen offset:128
    buffer_load_dwordx2 v[214:215], v3, s[40:43], 0 offen offset:160
    buffer_load_dwordx2 v[216:217], v3, s[40:43], 0 offen offset:192
    buffer_load_dwordx2 v[218:219], v3, s[40:43], 0 offen offset:224
    buffer_load_dwordx2 v[220:221], v3, s[40:43], 0 offen offset:256
L_w1:
    s_mov_b32 s56, s28
    s_mov_b32 s57, s29
    s_mov_b32 s58, 864
    s_mov_b32 s59, 0x20000
    s_cmp_eq_u32 s6, 0
    s_cbranch_scc1 L_w3
    v_lshlrev_b32 v3, 1, v1
    s_lshl_b32 s5, s4, 1
    s_add_u32 s5, s5, 0
    s_mul_i32 s60, s5, 11
    s_lshr_b32 s60, s60, 5
    s_mul_i32 s5, s5, 288
    s_mul_i32 s60, s60, 832
    s_sub_u32 s5, s5, s60
    buffer_load_ushort v222, v3, s[56:59], s5 offen
    s_lshl_b32 s5, s4, 1
    s_add_u32 s5, s5, 1
    s_mul_i32 s60, s5, 11
    s_lshr_b32 s60, s60, 5
    s_mul_i32 s5, s5, 288
    s_mul_i32 s60, s60, 832
    s_sub_u32 s5, s5, s60
    buffer_load_ushort v223, v3, s[56:59], s5 offen
    s_lshl_b32 s5, s4, 1
    s_add_u32 s5, s5, 16
    s_mul_i32 s60, s5, 11
    s_lshr_b32 s60, s60, 5
    s_mul_i32 s5, s5, 288
    s_mul_i32 s60, s60, 832
    s_sub_u32 s5, s5, s60
    buffer_load_ushort v224, v3, s[56:59], s5 offen
    s_lshl_b32 s5, s4, 1
    s_add_u32 s5, s5, 17
    s_mul_i32 s60, s5, 11
    s_lshr_b32 s60, s60, 5
    s_mul_i32 s5, s5, 288
    s_mul_i32 s60, s60, 832
    s_sub_u32 s5, s5, s60
    buffer_load_ushort v225, v3, s[56:59], s5 offen
    v_and_b32 v234, 1, v1
    v_lshlrev_b32 v234, 4, v234
    v_lshrrev_b32 v235, 1, v1
    v_lshlrev_b32 v236, 1, v2
    v_cmp_eq_u32 s[12:13], v235, v236
    v_add_u32 v236, 1, v236
    v_cmp_eq_u32 s[14:15], v235, v236
    s_lshl_b32 s5, s4, 10
    s_add_u32 s5, s5, 4816896
    s_add_u32 s60, s5, 8192
    s_cmp_eq_u32 s4, 5
    s_cselect_b64 vcc, -1, 0
    v_mov_b32 v235, 0x3f80
    s_waitcnt vmcnt(0)
    v_cndmask_b32 v225, v225, v235, vcc
    v_lshlrev_b32 v222, v234, v222
    v_cndmask_b32 v226, 0, v222, s[12:13]
    v_cndmask_b32 v227, 0, v222, s[14:15]
    v_lshlrev_b32 v223, v234, v223
    v_cndmask_b32 v228, 0, v223, s[12:13]
    v_cndmask_b32 v229, 0, v223, s[14:15]
    v_lshlrev_b32 v224, v234, v224
    v_cndmask_b32 v230, 0, v224, s[12:13]
    v_cndmask_b32 v231, 0, v224, s[14:15]
    v_lshlrev_b32 v225, v234, v225
    v_cndmask_b32 v232, 0, v225, s[12:13]
    v_cndmask_b32 v233, 0, v225, s[14:15]
    buffer_store_dwordx4 v[226:229], v239, s[52:55], s5 offen sc1
    buffer_store_dwordx4 v[230:233], v239, s[52:55], s60 offen sc1
L_w3:
    s_waitcnt vmcnt(0)
    v_add_u32 v17, 45056, v5
    v_and_b32 v8, 3, v9
    v_lshl_add_u32 v16, v8, 3, v17
    v_mov_b32 v0, v9
    s_barrier
L_wtile:
    s_cmp_lg_u32 s6, 0
    s_cbranch_scc1 L_w2
    v_lshlrev_b32 v8, 16, v148
    v_and_b32 v9, 0xffff0000, v148
    v_lshlrev_b32 v10, 16, v20
    v_and_b32 v11, 0xffff0000, v20
    v_pk_add_f32 v[8:9], v[8:9], v[10:11] neg_lo:[0,1] neg_hi:[0,1]
    v_cvt_pk_bf16_f32 v40, v8, v9
    v_lshlrev_b32 v8, 16, v149
    v_and_b32 v9, 0xffff0000, v149
    v_lshlrev_b32 v10, 16, v21
    v_and_b32 v11, 0xffff0000, v21
    v_pk_add_f32 v[8:9], v[8:9], v[10:11] neg_lo:[0,1] neg_hi:[0,1]
    v_cvt_pk_bf16_f32 v41, v8, v9
    v_lshlrev_b32 v8, 16, v150
    v_and_b32 v9, 0xffff0000, v150
    v_lshlrev_b32 v10, 16, v22
    v_and_b32 v11, 0xffff0000, v22
    v_pk_add_f32 v[8:9], v[8:9], v[10:11] neg_lo:[0,1] neg_hi:[0,1]
    v_cvt_pk_bf16_f32 v42, v8, v9
    v_lshlrev_b32 v8, 16, v151
    v_and_b32 v9, 0xffff0000, v151
    v_lshlrev_b32 v10, 16, v23
    v_and_b32 v11, 0xffff0000, v23
    v_pk_add_f32 v[8:9], v[8:9], v[10:11] neg_lo:[0,1] neg_hi:[0,1]
    v_cvt_pk_bf16_f32 v43, v8, v9
    v_lshlrev_b32 v8, 16, v152
    v_and_b32 v9, 0xffff0000, v152
    v_lshlrev_b32 v10, 16, v24
    v_and_b32 v11, 0xffff0000, v24
    v_pk_add_f32 v[8:9], v[8:9], v[10:11] neg_lo:[0,1] neg_hi:[0,1]
    v_cvt_pk_bf16_f32 v44, v8, v9
    v_lshlrev_b32 v8, 16, v153
    v_and_b32 v9, 0xffff0000, v153
    v_lshlrev_b32 v10, 16, v25
    v_and_b32 v11, 0xffff0000, v25
    v_pk_add_f32 v[8:9], v[8:9], v[10:11] neg_lo:[0,1] neg_hi:[0,1]
    v_cvt_pk_bf16_f32 v45, v8, v9
    v_lshlrev_b32 v8, 16, v154
    v_and_b32 v9, 0xffff0000, v154
    v_lshlrev_b32 v10, 16, v26
    v_and_b32 v11, 0xffff0000, v26
    v_pk_add_f32 v[8:9], v[8:9], v[10:11] neg_lo:[0,1] neg_hi:[0,1]
    v_cvt_pk_bf16_f32 v46, v8, v9
    v_lshlrev_b32 v8, 16, v155
    v_and_b32 v9, 0xffff0000, v155
    v_lshlrev_b32 v10, 16, v27
    v_and_b32 v11, 0xffff0000, v27
    v_pk_add_f32 v[8:9], v[8:9], v[10:11] neg_lo:[0,1] neg_hi:[0,1]
    v_cvt_pk_bf16_f32 v47, v8, v9
    v_lshlrev_b32 v8, 16, v156
    v_and_b32 v9, 0xffff0000, v156
    v_lshlrev_b32 v10, 16, v28
    v_and_b32 v11, 0xffff0000, v28
    v_pk_add_f32 v[8:9], v[8:9], v[10:11] neg_lo:[0,1] neg_hi:[0,1]
    v_cvt_pk_bf16_f32 v48, v8, v9
    v_lshlrev_b32 v8, 16, v157
    v_and_b32 v9, 0xffff0000, v157
    v_lshlrev_b32 v10, 16, v29
    v_and_b32 v11, 0xffff0000, v29
    v_pk_add_f32 v[8:9], v[8:9], v[10:11] neg_lo:[0,1] neg_hi:[0,1]
    v_cvt_pk_bf16_f32 v49, v8, v9
    v_lshlrev_b32 v8, 16, v158
    v_and_b32 v9, 0xffff0000, v158
    v_lshlrev_b32 v10, 16, v30
    v_and_b32 v11, 0xffff0000, v30
    v_pk_add_f32 v[8:9], v[8:9], v[10:11] neg_lo:[0,1] neg_hi:[0,1]
    v_cvt_pk_bf16_f32 v50, v8, v9
    v_lshlrev_b32 v8, 16, v159
    v_and_b32 v9, 0xffff0000, v159
    v_lshlrev_b32 v10, 16, v31
    v_and_b32 v11, 0xffff0000, v31
    v_pk_add_f32 v[8:9], v[8:9], v[10:11] neg_lo:[0,1] neg_hi:[0,1]
    v_cvt_pk_bf16_f32 v51, v8, v9
    v_lshlrev_b32 v8, 16, v160
    v_and_b32 v9, 0xffff0000, v160
    v_lshlrev_b32 v10, 16, v32
    v_and_b32 v11, 0xffff0000, v32
    v_pk_add_f32 v[8:9], v[8:9], v[10:11] neg_lo:[0,1] neg_hi:[0,1]
    v_cvt_pk_bf16_f32 v52, v8, v9
    v_lshlrev_b32 v8, 16, v161
    v_and_b32 v9, 0xffff0000, v161
    v_lshlrev_b32 v10, 16, v33
    v_and_b32 v11, 0xffff0000, v33
    v_pk_add_f32 v[8:9], v[8:9], v[10:11] neg_lo:[0,1] neg_hi:[0,1]
    v_cvt_pk_bf16_f32 v53, v8, v9
    v_lshlrev_b32 v8, 16, v162
    v_and_b32 v9, 0xffff0000, v162
    v_lshlrev_b32 v10, 16, v34
    v_and_b32 v11, 0xffff0000, v34
    v_pk_add_f32 v[8:9], v[8:9], v[10:11] neg_lo:[0,1] neg_hi:[0,1]
    v_cvt_pk_bf16_f32 v54, v8, v9
    v_lshlrev_b32 v8, 16, v163
    v_and_b32 v9, 0xffff0000, v163
    v_lshlrev_b32 v10, 16, v35
    v_and_b32 v11, 0xffff0000, v35
    v_pk_add_f32 v[8:9], v[8:9], v[10:11] neg_lo:[0,1] neg_hi:[0,1]
    v_cvt_pk_bf16_f32 v55, v8, v9
    v_lshlrev_b32 v8, 16, v164
    v_and_b32 v9, 0xffff0000, v164
    v_lshlrev_b32 v10, 16, v36
    v_and_b32 v11, 0xffff0000, v36
    v_pk_add_f32 v[8:9], v[8:9], v[10:11] neg_lo:[0,1] neg_hi:[0,1]
    v_cvt_pk_bf16_f32 v56, v8, v9
    v_lshlrev_b32 v8, 16, v165
    v_and_b32 v9, 0xffff0000, v165
    v_lshlrev_b32 v10, 16, v37
    v_and_b32 v11, 0xffff0000, v37
    v_pk_add_f32 v[8:9], v[8:9], v[10:11] neg_lo:[0,1] neg_hi:[0,1]
    v_cvt_pk_bf16_f32 v57, v8, v9
    ds_read_b64_tr_b16 v[74:75], v5 offset:36864
    ds_read_b64_tr_b16 v[58:59], v5 offset:0
    ds_read_b64_tr_b16 v[60:61], v5 offset:4608
    ds_read_b64_tr_b16 v[92:93], v5 offset:36896
    ds_read_b64_tr_b16 v[62:63], v5 offset:9216
    ds_read_b64_tr_b16 v[64:65], v5 offset:13824
    ds_read_b64_tr_b16 v[66:67], v5 offset:18432
    ds_read_b64_tr_b16 v[68:69], v5 offset:23040
    ds_read_b64_tr_b16 v[70:71], v5 offset:27648
    ds_read_b64_tr_b16 v[72:73], v5 offset:32256
    ds_read_b64_tr_b16 v[76:77], v5 offset:32
    ds_read_b64_tr_b16 v[78:79], v5 offset:4640
    ds_read_b64_tr_b16 v[110:111], v5 offset:36928
    ds_read_b64_tr_b16 v[80:81], v5 offset:9248
    ds_read_b64_tr_b16 v[82:83], v5 offset:13856
    s_waitcnt lgkmcnt(14)
    v_mfma_f32_16x16x16_bf16 v[112:115], v[74:75], v[56:57], 0
    ds_read_b64_tr_b16 v[84:85], v5 offset:18464
    s_waitcnt lgkmcnt(12)
    s_nop 3
    v_mfma_f32_16x16x32_bf16 v[112:115], v[58:61], v[40:43], v[112:115]
    ds_read_b64_tr_b16 v[86:87], v5 offset:23072
    ds_read_b64_tr_b16 v[88:89], v5 offset:27680
    v_mfma_f32_16x16x16_bf16 v[116:119], v[92:93], v[56:57], 0
    ds_read_b64_tr_b16 v[90:91], v5 offset:32288
    s_waitcnt lgkmcnt(11)
    v_mfma_f32_16x16x32_bf16 v[112:115], v[62:65], v[44:47], v[112:115]
    ds_read_b64_tr_b16 v[94:95], v5 offset:64
    ds_read_b64_tr_b16 v[96:97], v5 offset:4672
    v_mfma_f32_16x16x32_bf16 v[112:115], v[66:69], v[48:51], v[112:115]
    ds_read_b64_tr_b16 v[74:75], v5 offset:36960
    ds_read_b64_tr_b16 v[98:99], v5 offset:9280
    s_waitcnt lgkmcnt(11)
    v_mfma_f32_16x16x32_bf16 v[112:115], v[70:73], v[52:55], v[112:115]
    ds_read_b64_tr_b16 v[100:101], v5 offset:13888
    ds_read_b64_tr_b16 v[102:103], v5 offset:18496
    v_mfma_f32_16x16x32_bf16 v[116:119], v[76:79], v[40:43], v[116:119]
    ds_read_b64_tr_b16 v[104:105], v5 offset:23104
    ds_read_b64_tr_b16 v[106:107], v5 offset:27712
    s_waitcnt lgkmcnt(12)
    v_mfma_f32_16x16x16_bf16 v[120:123], v[110:111], v[56:57], 0
    ds_read_b64_tr_b16 v[108:109], v5 offset:32320
    v_mfma_f32_16x16x32_bf16 v[116:119], v[80:83], v[44:47], v[116:119]
    ds_read_b64_tr_b16 v[58:59], v5 offset:96
    ds_read_b64_tr_b16 v[60:61], v5 offset:4704
    s_waitcnt lgkmcnt(11)
    v_mfma_f32_16x16x32_bf16 v[116:119], v[84:87], v[48:51], v[116:119]
    ds_read_b64_tr_b16 v[92:93], v5 offset:36992
    ds_read_b64_tr_b16 v[62:63], v5 offset:9312
    v_mfma_f32_16x16x32_bf16 v[116:119], v[88:91], v[52:55], v[116:119]
    ds_read_b64_tr_b16 v[64:65], v5 offset:13920
    ds_read_b64_tr_b16 v[66:67], v5 offset:18528
    s_waitcnt lgkmcnt(12)
    v_mfma_f32_16x16x32_bf16 v[120:123], v[94:97], v[40:43], v[120:123]
    ds_read_b64_tr_b16 v[68:69], v5 offset:23136
    ds_read_b64_tr_b16 v[70:71], v5 offset:27744
    v_mfma_f32_16x16x16_bf16 v[124:127], v[74:75], v[56:57], 0
    ds_read_b64_tr_b16 v[72:73], v5 offset:32352
    s_waitcnt lgkmcnt(11)
    v_mfma_f32_16x16x32_bf16 v[120:123], v[98:101], v[44:47], v[120:123]
    ds_read_b64_tr_b16 v[76:77], v5 offset:128
    ds_read_b64_tr_b16 v[78:79], v5 offset:4736
    v_mfma_f32_16x16x32_bf16 v[120:123], v[102:105], v[48:51], v[120:123]
    ds_read_b64_tr_b16 v[110:111], v5 offset:37024
    ds_read_b64_tr_b16 v[80:81], v5 offset:9344
    s_waitcnt lgkmcnt(11)
    v_mfma_f32_16x16x32_bf16 v[120:123], v[106:109], v[52:55], v[120:123]
    ds_read_b64_tr_b16 v[82:83], v5 offset:13952
    ds_read_b64_tr_b16 v[84:85], v5 offset:18560
    v_mfma_f32_16x16x32_bf16 v[124:127], v[58:61], v[40:43], v[124:127]
    ds_read_b64_tr_b16 v[86:87], v5 offset:23168
    ds_read_b64_tr_b16 v[88:89], v5 offset:27776
    s_waitcnt lgkmcnt(12)
    v_mfma_f32_16x16x16_bf16 v[128:131], v[92:93], v[56:57], 0
    ds_read_b64_tr_b16 v[90:91], v5 offset:32384
    v_mfma_f32_16x16x32_bf16 v[124:127], v[62:65], v[44:47], v[124:127]
    ds_read_b64_tr_b16 v[94:95], v5 offset:160
    ds_read_b64_tr_b16 v[96:97], v5 offset:4768
    s_waitcnt lgkmcnt(11)
    v_mfma_f32_16x16x32_bf16 v[124:127], v[66:69], v[48:51], v[124:127]
    ds_read_b64_tr_b16 v[74:75], v5 offset:37056
    ds_read_b64_tr_b16 v[98:99], v5 offset:9376
    v_mfma_f32_16x16x32_bf16 v[124:127], v[70:73], v[52:55], v[124:127]
    ds_read_b64_tr_b16 v[100:101], v5 offset:13984
    ds_read_b64_tr_b16 v[102:103], v5 offset:18592
    s_waitcnt lgkmcnt(12)
    v_mfma_f32_16x16x32_bf16 v[128:131], v[76:79], v[40:43], v[128:131]
    ds_read_b64_tr_b16 v[104:105], v5 offset:23200
    ds_read_b64_tr_b16 v[106:107], v5 offset:27808
    v_mfma_f32_16x16x16_bf16 v[132:135], v[110:111], v[56:57], 0
    ds_read_b64_tr_b16 v[108:109], v5 offset:32416
    s_waitcnt lgkmcnt(11)
    v_mfma_f32_16x16x32_bf16 v[128:131], v[80:83], v[44:47], v[128:131]
    ds_read_b64_tr_b16 v[58:59], v5 offset:192
    ds_read_b64_tr_b16 v[60:61], v5 offset:4800
    v_mfma_f32_16x16x32_bf16 v[128:131], v[84:87], v[48:51], v[128:131]
    ds_read_b64_tr_b16 v[92:93], v5 offset:37088
    ds_read_b64_tr_b16 v[62:63], v5 offset:9408
    s_waitcnt lgkmcnt(11)
    v_mfma_f32_16x16x32_bf16 v[128:131], v[88:91], v[52:55], v[128:131]
    ds_read_b64_tr_b16 v[64:65], v5 offset:14016
    ds_read_b64_tr_b16 v[66:67], v5 offset:18624
    v_mfma_f32_16x16x32_bf16 v[132:135], v[94:97], v[40:43], v[132:135]
    ds_read_b64_tr_b16 v[68:69], v5 offset:23232
    ds_read_b64_tr_b16 v[70:71], v5 offset:27840
    s_waitcnt lgkmcnt(12)
    v_mfma_f32_16x16x16_bf16 v[136:139], v[74:75], v[56:57], 0
    ds_read_b64_tr_b16 v[72:73], v5 offset:32448
    v_mfma_f32_16x16x32_bf16 v[132:135], v[98:101], v[44:47], v[132:135]
    ds_read_b64_tr_b16 v[76:77], v5 offset:224
    ds_read_b64_tr_b16 v[78:79], v5 offset:4832
    s_waitcnt lgkmcnt(11)
    v_mfma_f32_16x16x32_bf16 v[132:135], v[102:105], v[48:51], v[132:135]
    ds_read_b64_tr_b16 v[110:111], v5 offset:37120
    ds_read_b64_tr_b16 v[80:81], v5 offset:9440
    v_mfma_f32_16x16x32_bf16 v[132:135], v[106:109], v[52:55], v[132:135]
    ds_read_b64_tr_b16 v[82:83], v5 offset:14048
    ds_read_b64_tr_b16 v[84:85], v5 offset:18656
    s_waitcnt lgkmcnt(12)
    v_mfma_f32_16x16x32_bf16 v[136:139], v[58:61], v[40:43], v[136:139]
    ds_read_b64_tr_b16 v[86:87], v5 offset:23264
    ds_read_b64_tr_b16 v[88:89], v5 offset:27872
    v_mfma_f32_16x16x16_bf16 v[140:143], v[92:93], v[56:57], 0
    ds_read_b64_tr_b16 v[90:91], v5 offset:32480
    s_waitcnt lgkmcnt(11)
    v_mfma_f32_16x16x32_bf16 v[136:139], v[62:65], v[44:47], v[136:139]
    ds_read_b64_tr_b16 v[94:95], v5 offset:256
    ds_read_b64_tr_b16 v[96:97], v5 offset:4864
    v_mfma_f32_16x16x32_bf16 v[136:139], v[66:69], v[48:51], v[136:139]
    ds_read_b64_tr_b16 v[98:99], v5 offset:9472
    ds_read_b64_tr_b16 v[100:101], v5 offset:14080
    s_waitcnt lgkmcnt(11)
    v_mfma_f32_16x16x32_bf16 v[136:139], v[70:73], v[52:55], v[136:139]
    ds_read_b64_tr_b16 v[102:103], v5 offset:18688
    ds_read_b64_tr_b16 v[104:105], v5 offset:23296
    v_mfma_f32_16x16x32_bf16 v[140:143], v[76:79], v[40:43], v[140:143]
    ds_read_b64_tr_b16 v[106:107], v5 offset:27904
    ds_read_b64_tr_b16 v[108:109], v5 offset:32512
    s_waitcnt lgkmcnt(12)
    v_mfma_f32_16x16x16_bf16 v[144:147], v[110:111], v[56:57], 0
    v_mfma_f32_16x16x32_bf16 v[140:143], v[80:83], v[44:47], v[140:143]
    s_waitcnt lgkmcnt(8)
    v_mfma_f32_16x16x32_bf16 v[140:143], v[84:87], v[48:51], v[140:143]
    v_mfma_f32_16x16x32_bf16 v[140:143], v[88:91], v[52:55], v[140:143]
    s_waitcnt lgkmcnt(4)
    s_nop 0
    v_mfma_f32_16x16x32_bf16 v[144:147], v[94:97], v[40:43], v[144:147]
    v_mfma_f32_16x16x32_bf16 v[144:147], v[98:101], v[44:47], v[144:147]
    s_waitcnt lgkmcnt(0)
    v_mfma_f32_16x16x32_bf16 v[144:147], v[102:105], v[48:51], v[144:147]
    v_mfma_f32_16x16x32_bf16 v[144:147], v[106:109], v[52:55], v[144:147]
    v_cvt_pk_bf16_f32 v148, v112, v113
    v_cvt_pk_bf16_f32 v149, v114, v115
    v_cvt_pk_bf16_f32 v150, v116, v117
    v_cvt_pk_bf16_f32 v151, v118, v119
    v_cvt_pk_bf16_f32 v152, v120, v121
    v_cvt_pk_bf16_f32 v153, v122, v123
    v_cvt_pk_bf16_f32 v154, v124, v125
    v_cvt_pk_bf16_f32 v155, v126, v127
    v_cvt_pk_bf16_f32 v156, v128, v129
    v_cvt_pk_bf16_f32 v157, v130, v131
    v_cvt_pk_bf16_f32 v158, v132, v133
    v_cvt_pk_bf16_f32 v159, v134, v135
    v_cvt_pk_bf16_f32 v160, v136, v137
    v_cvt_pk_bf16_f32 v161, v138, v139
    v_cvt_pk_bf16_f32 v162, v140, v141
    v_cvt_pk_bf16_f32 v163, v142, v143
    v_cvt_pk_bf16_f32 v164, v144, v145
    v_cvt_pk_bf16_f32 v165, v146, v147
L_w2:
    ds_read_b64_tr_b16 v[74:75], v16 offset:36864
    ds_read_b64_tr_b16 v[58:59], v16 offset:0
    ds_read_b64_tr_b16 v[60:61], v16 offset:4608
    ds_read_b64_tr_b16 v[92:93], v16 offset:36872
    ds_read_b64_tr_b16 v[62:63], v16 offset:9216
    ds_read_b64_tr_b16 v[64:65], v16 offset:13824
    ds_read_b64_tr_b16 v[66:67], v16 offset:18432
    ds_read_b64_tr_b16 v[68:69], v16 offset:23040
    ds_read_b64_tr_b16 v[70:71], v16 offset:27648
    ds_read_b64_tr_b16 v[72:73], v16 offset:32256
    ds_read_b64_tr_b16 v[76:77], v16 offset:8
    ds_read_b64_tr_b16 v[78:79], v16 offset:4616
    ds_read_b64_tr_b16 v[110:111], v16 offset:36928
    ds_read_b64_tr_b16 v[80:81], v16 offset:9224
    ds_read_b64_tr_b16 v[82:83], v16 offset:13832
    s_waitcnt lgkmcnt(14)
    v_mfma_f32_16x16x16_bf16 v[168:171], v[164:165], v[74:75], 0
    ds_read_b64_tr_b16 v[84:85], v16 offset:18440
    s_waitcnt lgkmcnt(12)
    s_nop 3
    v_mfma_f32_16x16x32_bf16 v[168:171], v[148:151], v[58:61], v[168:171]
    ds_read_b64_tr_b16 v[86:87], v16 offset:23048
    ds_read_b64_tr_b16 v[88:89], v16 offset:27656
    v_mfma_f32_16x16x16_bf16 v[172:175], v[164:165], v[92:93], 0
    ds_read_b64_tr_b16 v[90:91], v16 offset:32264
    s_waitcnt lgkmcnt(11)
    v_mfma_f32_16x16x32_bf16 v[168:171], v[152:155], v[62:65], v[168:171]
    ds_read_b64_tr_b16 v[94:95], v16 offset:64
    ds_read_b64_tr_b16 v[96:97], v16 offset:4672
    v_mfma_f32_16x16x32_bf16 v[168:171], v[156:159], v[66:69], v[168:171]
    ds_read_b64_tr_b16 v[74:75], v16 offset:36936
    ds_read_b64_tr_b16 v[98:99], v16 offset:9280
    s_waitcnt lgkmcnt(11)
    v_mfma_f32_16x16x32_bf16 v[168:171], v[160:163], v[70:73], v[168:171]
    ds_read_b64_tr_b16 v[100:101], v16 offset:13888
    ds_read_b64_tr_b16 v[102:103], v16 offset:18496
    v_mfma_f32_16x16x32_bf16 v[172:175], v[148:151], v[76:79], v[172:175]
    ds_read_b64_tr_b16 v[104:105], v16 offset:23104
    ds_read_b64_tr_b16 v[106:107], v16 offset:27712
    s_waitcnt lgkmcnt(12)
    v_mfma_f32_16x16x16_bf16 v[176:179], v[164:165], v[110:111], 0
    ds_read_b64_tr_b16 v[108:109], v16 offset:32320
    v_mfma_f32_16x16x32_bf16 v[172:175], v[152:155], v[80:83], v[172:175]
    ds_read_b64_tr_b16 v[58:59], v16 offset:72
    ds_read_b64_tr_b16 v[60:61], v16 offset:4680
    s_waitcnt lgkmcnt(11)
    v_mfma_f32_16x16x32_bf16 v[172:175], v[156:159], v[84:87], v[172:175]
    ds_read_b64_tr_b16 v[92:93], v16 offset:36992
    ds_read_b64_tr_b16 v[62:63], v16 offset:9288
    v_mfma_f32_16x16x32_bf16 v[172:175], v[160:163], v[88:91], v[172:175]
    ds_read_b64_tr_b16 v[64:65], v16 offset:13896
    ds_read_b64_tr_b16 v[66:67], v16 offset:18504
    s_waitcnt lgkmcnt(12)
    v_mfma_f32_16x16x32_bf16 v[176:179], v[148:151], v[94:97], v[176:179]
    ds_read_b64_tr_b16 v[68:69], v16 offset:23112
    ds_read_b64_tr_b16 v[70:71], v16 offset:27720
    v_mfma_f32_16x16x16_bf16 v[180:183], v[164:165], v[74:75], 0
    ds_read_b64_tr_b16 v[72:73], v16 offset:32328
    s_waitcnt lgkmcnt(11)
    v_mfma_f32_16x16x32_bf16 v[176:179], v[152:155], v[98:101], v[176:179]
    ds_read_b64_tr_b16 v[76:77], v16 offset:128
    ds_read_b64_tr_b16 v[78:79], v16 offset:4736
    v_mfma_f32_16x16x32_bf16 v[176:179], v[156:159], v[102:105], v[176:179]
    ds_read_b64_tr_b16 v[110:111], v16 offset:37000
    ds_read_b64_tr_b16 v[80:81], v16 offset:9344
    s_waitcnt lgkmcnt(11)
    v_mfma_f32_16x16x32_bf16 v[176:179], v[160:163], v[106:109], v[176:179]
    ds_read_b64_tr_b16 v[82:83], v16 offset:13952
    ds_read_b64_tr_b16 v[84:85], v16 offset:18560
    v_mfma_f32_16x16x32_bf16 v[180:183], v[148:151], v[58:61], v[180:183]
    ds_read_b64_tr_b16 v[86:87], v16 offset:23168
    ds_read_b64_tr_b16 v[88:89], v16 offset:27776
    s_waitcnt lgkmcnt(12)
    v_mfma_f32_16x16x16_bf16 v[184:187], v[164:165], v[92:93], 0
    ds_read_b64_tr_b16 v[90:91], v16 offset:32384
    v_mfma_f32_16x16x32_bf16 v[180:183], v[152:155], v[62:65], v[180:183]
    ds_read_b64_tr_b16 v[94:95], v16 offset:136
    ds_read_b64_tr_b16 v[96:97], v16 offset:4744
    s_waitcnt lgkmcnt(11)
    v_mfma_f32_16x16x32_bf16 v[180:183], v[156:159], v[66:69], v[180:183]
    ds_read_b64_tr_b16 v[74:75], v16 offset:37056
    ds_read_b64_tr_b16 v[98:99], v16 offset:9352
    v_mfma_f32_16x16x32_bf16 v[180:183], v[160:163], v[70:73], v[180:183]
    ds_read_b64_tr_b16 v[100:101], v16 offset:13960
    ds_read_b64_tr_b16 v[102:103], v16 offset:18568
    s_waitcnt lgkmcnt(12)
    v_mfma_f32_16x16x32_bf16 v[184:187], v[148:151], v[76:79], v[184:187]
    ds_read_b64_tr_b16 v[104:105], v16 offset:23176
    ds_read_b64_tr_b16 v[106:107], v16 offset:27784
    v_mfma_f32_16x16x16_bf16 v[188:191], v[164:165], v[110:111], 0
    ds_read_b64_tr_b16 v[108:109], v16 offset:32392
    s_waitcnt lgkmcnt(11)
    v_mfma_f32_16x16x32_bf16 v[184:187], v[152:155], v[80:83], v[184:187]
    ds_read_b64_tr_b16 v[58:59], v16 offset:192
    ds_read_b64_tr_b16 v[60:61], v16 offset:4800
    v_mfma_f32_16x16x32_bf16 v[184:187], v[156:159], v[84:87], v[184:187]
    ds_read_b64_tr_b16 v[92:93], v16 offset:37064
    ds_read_b64_tr_b16 v[62:63], v16 offset:9408
    s_waitcnt lgkmcnt(11)
    v_mfma_f32_16x16x32_bf16 v[184:187], v[160:163], v[88:91], v[184:187]
    ds_read_b64_tr_b16 v[64:65], v16 offset:14016
    ds_read_b64_tr_b16 v[66:67], v16 offset:18624
    v_mfma_f32_16x16x32_bf16 v[188:191], v[148:151], v[94:97], v[188:191]
    ds_read_b64_tr_b16 v[68:69], v16 offset:23232
    ds_read_b64_tr_b16 v[70:71], v16 offset:27840
    s_waitcnt lgkmcnt(12)
    v_mfma_f32_16x16x16_bf16 v[192:195], v[164:165], v[74:75], 0
    ds_read_b64_tr_b16 v[72:73], v16 offset:32448
    v_mfma_f32_16x16x32_bf16 v[188:191], v[152:155], v[98:101], v[188:191]
    ds_read_b64_tr_b16 v[76:77], v16 offset:200
    ds_read_b64_tr_b16 v[78:79], v16 offset:4808
    s_waitcnt lgkmcnt(11)
    v_mfma_f32_16x16x32_bf16 v[188:191], v[156:159], v[102:105], v[188:191]
    ds_read_b64_tr_b16 v[110:111], v17 offset:37120
    ds_read_b64_tr_b16 v[80:81], v16 offset:9416
    v_mfma_f32_16x16x32_bf16 v[188:191], v[160:163], v[106:109], v[188:191]
    ds_read_b64_tr_b16 v[82:83], v16 offset:14024
    ds_read_b64_tr_b16 v[84:85], v16 offset:18632
    s_waitcnt lgkmcnt(12)
    v_mfma_f32_16x16x32_bf16 v[192:195], v[148:151], v[58:61], v[192:195]
    ds_read_b64_tr_b16 v[86:87], v16 offset:23240
    ds_read_b64_tr_b16 v[88:89], v16 offset:27848
    v_mfma_f32_16x16x16_bf16 v[196:199], v[164:165], v[92:93], 0
    ds_read_b64_tr_b16 v[90:91], v16 offset:32456
    s_waitcnt lgkmcnt(11)
    v_mfma_f32_16x16x32_bf16 v[192:195], v[152:155], v[62:65], v[192:195]
    ds_read_b64_tr_b16 v[94:95], v17 offset:256
    ds_read_b64_tr_b16 v[96:97], v17 offset:4864
    v_mfma_f32_16x16x32_bf16 v[192:195], v[156:159], v[66:69], v[192:195]
    ds_read_b64_tr_b16 v[98:99], v17 offset:9472
    ds_read_b64_tr_b16 v[100:101], v17 offset:14080
    s_waitcnt lgkmcnt(11)
    v_mfma_f32_16x16x32_bf16 v[192:195], v[160:163], v[70:73], v[192:195]
    ds_read_b64_tr_b16 v[102:103], v17 offset:18688
    ds_read_b64_tr_b16 v[104:105], v17 offset:23296
    v_mfma_f32_16x16x32_bf16 v[196:199], v[148:151], v[76:79], v[196:199]
    ds_read_b64_tr_b16 v[106:107], v17 offset:27904
    ds_read_b64_tr_b16 v[108:109], v17 offset:32512
    s_waitcnt lgkmcnt(12)
    v_mfma_f32_16x16x16_bf16 v[200:203], v[164:165], v[110:111], 0
    v_mfma_f32_16x16x32_bf16 v[196:199], v[152:155], v[80:83], v[196:199]
    s_waitcnt lgkmcnt(8)
    v_mfma_f32_16x16x32_bf16 v[196:199], v[156:159], v[84:87], v[196:199]
    v_mfma_f32_16x16x32_bf16 v[196:199], v[160:163], v[88:91], v[196:199]
    s_waitcnt lgkmcnt(4)
    s_nop 0
    v_mfma_f32_16x16x32_bf16 v[200:203], v[148:151], v[94:97], v[200:203]
    v_mfma_f32_16x16x32_bf16 v[200:203], v[152:155], v[98:101], v[200:203]
    s_waitcnt lgkmcnt(0)
    v_mfma_f32_16x16x32_bf16 v[200:203], v[156:159], v[102:105], v[200:203]
    v_mfma_f32_16x16x32_bf16 v[200:203], v[160:163], v[106:109], v[200:203]
    s_lshr_b32 s5, s4, 1
    s_lshl_b32 s5, s5, 10
    s_lshr_b32 s60, s4, 1
    s_andn2_b32 s60, s60, s6
    s_xor_b32 s60, s60, s4
    s_and_b32 s60, s60, 1
    s_lshl_b32 s60, s60, 3
    s_add_u32 s5, s5, s60
    s_add_u32 s5, s5, s8
    s_add_u32 s5, s5, 4718592
    s_cmp_eq_u32 s4, 8
    s_cselect_b32 s60, 3, 4
    v_lshlrev_b32 v8, s60, v0
    v_cvt_pk_bf16_f32 v40, v168, v169
    v_cvt_pk_bf16_f32 v41, v170, v171
    s_add_u32 s60, s5, 0
    buffer_store_dwordx2 v[40:41], v8, s[52:55], s60 offen sc1
    v_cvt_pk_bf16_f32 v42, v172, v173
    v_cvt_pk_bf16_f32 v43, v174, v175
    s_add_u32 s60, s5, 4608
    buffer_store_dwordx2 v[42:43], v8, s[52:55], s60 offen sc1
    v_cvt_pk_bf16_f32 v44, v176, v177
    v_cvt_pk_bf16_f32 v45, v178, v179
    s_add_u32 s60, s5, 9216
    buffer_store_dwordx2 v[44:45], v8, s[52:55], s60 offen sc1
    v_cvt_pk_bf16_f32 v46, v180, v181
    v_cvt_pk_bf16_f32 v47, v182, v183
    s_add_u32 s60, s5, 13824
    buffer_store_dwordx2 v[46:47], v8, s[52:55], s60 offen sc1
    v_cvt_pk_bf16_f32 v48, v184, v185
    v_cvt_pk_bf16_f32 v49, v186, v187
    s_add_u32 s60, s5, 18432
    buffer_store_dwordx2 v[48:49], v8, s[52:55], s60 offen sc1
    v_cvt_pk_bf16_f32 v50, v188, v189
    v_cvt_pk_bf16_f32 v51, v190, v191
    s_add_u32 s60, s5, 23040
    buffer_store_dwordx2 v[50:51], v8, s[52:55], s60 offen sc1
    v_cvt_pk_bf16_f32 v52, v192, v193
    v_cvt_pk_bf16_f32 v53, v194, v195
    s_add_u32 s60, s5, 27648
    buffer_store_dwordx2 v[52:53], v8, s[52:55], s60 offen sc1
    v_cvt_pk_bf16_f32 v54, v196, v197
    v_cvt_pk_bf16_f32 v55, v198, v199
    s_add_u32 s60, s5, 32256
    buffer_store_dwordx2 v[54:55], v8, s[52:55], s60 offen sc1
    v_cvt_pk_bf16_f32 v56, v200, v201
    v_cvt_pk_bf16_f32 v57, v202, v203
    s_add_u32 s60, s5, 36864
    buffer_store_dwordx2 v[56:57], v8, s[52:55], s60 offen sc1
    v_mov_b32 v148, v204
    v_mov_b32 v149, v205
    v_mov_b32 v150, v206
    v_mov_b32 v151, v207
    v_mov_b32 v152, v208
    v_mov_b32 v153, v209
    v_mov_b32 v154, v210
    v_mov_b32 v155, v211
    v_mov_b32 v156, v212
    v_mov_b32 v157, v213
    v_mov_b32 v158, v214
    v_mov_b32 v159, v215
    v_mov_b32 v160, v216
    v_mov_b32 v161, v217
    v_mov_b32 v162, v218
    v_mov_b32 v163, v219
    v_mov_b32 v164, v220
    v_mov_b32 v165, v221
    s_add_u32 s4, s4, 8
    s_cmp_lt_u32 s4, 9
    s_cbranch_scc1 L_wtile
    s_waitcnt vmcnt(0)
    s_barrier
    s_lshl_b32 s5, s3, 9
    s_add_u32 s5, s5, s78
    v_mov_b32 v8, s100
    v_mov_b32 v9, s101
    buffer_store_dwordx2 v[8:9], v238, s[52:55], s5 offen sc1
    s_mov_b64 exec, 1
    s_not_b32 s60, s100
    s_not_b32 s61, s101
    v_mov_b32 v10, s60
    v_mov_b32 v11, s61
    v_mov_b32 v12, 128
    global_atomic_umax_x2 v12, v[10:11], s[36:37] sc1
    s_waitcnt vmcnt(0)
L_end:
    s_endpgm
.section .rodata,"a"
.p2align 6
.amdhsa_kernel standalone__conformer_family_branchformer__speech_kernel
  .amdhsa_next_free_vgpr 512
  .amdhsa_next_free_sgpr 102
  .amdhsa_accum_offset 256
  .amdhsa_group_segment_fixed_size 0
  .amdhsa_kernarg_size 96
  .amdhsa_user_sgpr_count 2
  .amdhsa_user_sgpr_kernarg_segment_ptr 1
  .amdhsa_system_sgpr_workgroup_id_x 1
.end_amdhsa_kernel
```
